```python
import torch

def _softmax(x, axis=-1):
    return torch.softmax(x, dim=axis)
def _gelu(x):
    return torch.nn.functional.gelu(x, approximate="tanh")
def _silu(x):
    return torch.nn.functional.silu(x)
def _sigmoid(x):
    return torch.sigmoid(x)
def _layernorm(x, axis=-1, eps=1e-5):
    m = x.mean(dim=axis, keepdim=True)
    v = x.var(dim=axis, keepdim=True, unbiased=False)
    return (x - m) / torch.sqrt(v + eps)
def _scatter_add(tgt, idx, src, axis=0):
    return tgt.clone().index_add_(axis, idx, src)
def _segment_sum(src, seg, n):
    out = torch.zeros((n,) + src.shape[1:], dtype=src.dtype)
    return out.index_add_(0, seg, src)
def _pad(x, pw):
    flat = tuple(v for pair in reversed(pw) for v in pair)
    return torch.nn.functional.pad(x, flat)

kernel_name = 'recurrent_scan__linear_kernel_hedgehog__glu_gated_swiglu__prompt'

def setup_inputs():

    _w = (lambda a: (lambda t: t.to(torch.bfloat16) if t.is_floating_point() else t)(torch.as_tensor(a)))
    def _A_setup():
        B, S, D, H = 1, 2048, 448, 16
        Dh = D // H
        return {
            "x": _w((lambda *s: torch.randn(*s, dtype=torch.bfloat16) * 0.05)(B, S, D)),
            "wqkv": _w((lambda *s: torch.randn(*s, dtype=torch.bfloat16) * 0.8)(D, 3 * D)),
            "w_phi": _w((lambda *s: torch.randn(*s, dtype=torch.bfloat16) * 0.8)(H, Dh, Dh) * (Dh ** -0.5)),
            "wo": _w((lambda *s: torch.randn(*s, dtype=torch.bfloat16) * 0.8)(D, D)),
        }
    _A_in = _A_setup()

    def _B_setup():
        B, S, D, F = 1, 2048, 448, 1792
        return {
            "x": _w((lambda *s: torch.randn(*s, dtype=torch.bfloat16) * 0.05)(B, S, D)),
            "w1": _w((lambda *s: torch.randn(*s, dtype=torch.bfloat16) * 0.2)(D, F) * (2.0 / D) ** 0.5),
            "w3": _w((lambda *s: torch.randn(*s, dtype=torch.bfloat16) * 0.2)(D, F) * (2.0 / D) ** 0.5),
            "w2": _w((lambda *s: torch.randn(*s, dtype=torch.bfloat16) * 0.2)(F, D) * (2.0 / F) ** 0.5),
        }
    _B_in = _B_setup()

    return {
        "A_x": _A_in["x"],
        "A_wqkv": _A_in["wqkv"],
        "A_w_phi": _A_in["w_phi"],
        "A_wo": _A_in["wo"],
        "B_x": _B_in["x"],
        "B_w1": _B_in["w1"],
        "B_w3": _B_in["w3"],
        "B_w2": _B_in["w2"],
    }

def reference(A_x, A_wqkv, A_w_phi, A_wo, B_x, B_w1, B_w3, B_w2):
    def _A_ref(x, wqkv, w_phi, wo):
        B, S, D = x.shape
        H = 16; Dh = D // H
        qkv = (lambda x, *d: x.permute(*d))((x @ wqkv).reshape(B, S, 3, H, Dh), 2, 0, 3, 1, 4)
        q, k, v = qkv[0], qkv[1], qkv[2]
        pq = torch.einsum("bhsd,hdf->bhsf", q, w_phi)
        pk = torch.einsum("bhsd,hdf->bhsf", k, w_phi)
        phi_q = torch.concatenate([_softmax(pq, axis=-1), _softmax(-pq, axis=-1)], axis=-1)
        phi_k = torch.concatenate([_softmax(pk, axis=-1), _softmax(-pk, axis=-1)], axis=-1)
        kv = torch.einsum("bhsf,bhsd->bhfd", phi_k, v)
        z  = torch.einsum("bhsf->bhf", phi_k)
        num = torch.einsum("bhqf,bhfd->bhqd", phi_q, kv)
        den = torch.einsum("bhqf,bhf->bhq", phi_q, z)[..., None] + 1e-6
        o = num / den
        return (lambda x, *d: x.permute(*d))(o, 0, 2, 1, 3).reshape(B, S, D) @ wo

    def _B_ref(x, w1, w3, w2):
        gate = torch.einsum("bsd,df->bsf", x, w1)
        up = torch.einsum("bsd,df->bsf", x, w3)
        h = _silu(gate) * up
        out = torch.einsum("bsf,fd->bsd", h, w2)
        return out

    x = A_x
    xn = _layernorm(x, axis=-1)
    s = _A_ref(xn, A_wqkv, A_w_phi, A_wo)
    g = _silu(_B_ref(xn, B_w1, B_w3, B_w2))
    return x + s * g
```

```asm
; @launch grid=(256,1,1) block=(512,1,1) lds=163840
.amdgcn_target "amdgcn-amd-amdhsa--gfx950"
.text
.globl recurrent_scan__linear_kernel_hedgehog__glu_gated_swiglu__prompt_kernel
.p2align 8
.type recurrent_scan__linear_kernel_hedgehog__glu_gated_swiglu__prompt_kernel,@function
recurrent_scan__linear_kernel_hedgehog__glu_gated_swiglu__prompt_kernel:
    s_cmp_ge_u32 s2, 0x100
    s_cbranch_scc1 L_END
    s_load_dwordx2 s[28:29], s[0:1], 0
    s_load_dwordx2 s[32:33], s[0:1], 8
    s_load_dwordx2 s[52:53], s[0:1], 16
    s_load_dwordx2 s[48:49], s[0:1], 24
    s_load_dwordx2 s[36:37], s[0:1], 40
    s_load_dwordx2 s[40:41], s[0:1], 48
    s_load_dwordx2 s[44:45], s[0:1], 56
    s_load_dwordx2 s[56:57], s[0:1], 64
    s_load_dwordx2 s[64:65], s[0:1], 72
    s_load_dwordx2 s[60:61], s[0:1], 80
    v_and_b32 v1, 63, v0
    v_lshrrev_b32 v20, 6, v0
    v_lshlrev_b32 v2, 4, v1
    v_readfirstlane_b32 s68, v20
    v_lshlrev_b32 v19, 2, v1
    s_and_b32 s92, s2, 7
    s_lshr_b32 s101, s2, 3
    s_lshr_b32 s93, s92, 2
    s_lshl_b32 s93, s93, 3
    s_lshr_b32 s94, s101, 2
    s_add_u32 s71, s93, s94
    s_and_b32 s95, s101, 3
    s_lshl_b32 s95, s95, 1
    s_add_u32 s94, s94, s95
    s_cmp_ge_u32 s94, 7
    s_cselect_b32 s95, 7, 0
    s_sub_u32 s94, s94, s95
    s_lshl_b32 s94, s94, 2
    s_mov_b32 s20, 0x6543210
    s_mov_b32 s21, 0x654321
    s_lshr_b64 s[20:21], s[20:21], s94
    s_bfe_u32 s74, s20, 0x40000
    s_bfe_u32 s75, s20, 0x40004
    s_bfe_u32 s76, s20, 0x40008
    s_bfe_u32 s77, s20, 0x4000c
    s_bfe_u32 s78, s20, 0x40010
    s_bfe_u32 s79, s20, 0x40014
    s_bfe_u32 s80, s20, 0x40018
    s_lshl_b32 s93, s71, 7
    s_lshl_b32 s94, s68, 4
    s_add_u32 s93, s93, s94
    v_lshrrev_b32 v20, 3, v1
    v_add_u32 v21, s93, v20
    v_mul_u32_u24 v21, 0x380, v21
    v_and_b32 v22, 7, v1
    v_lshl_add_u32 v90, v22, 4, v21
    v_add_u32 v91, 0x1c00, v90
    s_mov_b32 s84, 0x3f803f80
    s_mov_b32 s30, 0x1c0000
    s_mov_b32 s31, 0x20000
    s_mov_b32 s34, 0x126000
    s_mov_b32 s35, 0x20000
    s_mov_b32 s54, 0x6200
    s_mov_b32 s55, 0x20000
    s_mov_b32 s50, 0x62000
    s_mov_b32 s51, 0x20000
    s_mov_b32 s38, 0x188000
    s_mov_b32 s39, 0x20000
    s_mov_b32 s42, 0x188000
    s_mov_b32 s43, 0x20000
    s_mov_b32 s46, 0x188000
    s_mov_b32 s47, 0x20000
    s_mov_b32 s58, 0x1c0000
    s_mov_b32 s59, 0x20000
    s_mov_b32 s66, 0x100
    s_mov_b32 s67, 0x20000
    s_mov_b32 s62, 0x10000000
    s_mov_b32 s63, 0x20000
    s_and_b32 s93, s92, 3
    s_lshl_b32 s93, s93, 1
    s_bfe_u32 s95, s101, 0x10001
    s_add_u32 s72, s93, s95
    s_and_b32 s73, s101, 1
    s_and_b32 s69, s68, 3
    s_lshr_b32 s70, s68, 2
    s_lshl_b32 s87, s68, 10
    s_mul_i32 s93, s101, 37
    s_lshr_b32 s93, s93, 8
    s_mul_i32 s94, s93, 7
    s_sub_u32 s98, s101, s94
    s_waitcnt lgkmcnt(0)
    v_mov_b32 v128, 0
    v_mov_b32 v130, 0
    v_mov_b32 v129, 0
    v_mov_b32 v131, 0
    s_lshl_b32 s27, s74, 7
    buffer_load_dwordx4 v[24:27], v90, s[28:31], s27 offen
    s_lshl_b32 s94, s92, 2
    s_add_u32 s97, s94, s93
    s_cmp_lt_u32 s101, 28
    s_cselect_b32 s96, 1, 0
    s_cselect_b32 s97, s97, s94
    s_mov_b32 s81, 0xffff0000
    s_mov_b32 s82, 0xbf317218
    s_mov_b32 s83, 0xc0402d8f
    s_lshl_b32 s93, s71, 3
    s_add_u32 s93, s93, s72
    buffer_load_dwordx4 v[52:55], v91, s[28:31], s27 offen
    s_lshl_b32 s93, s93, 1
    s_add_u32 s93, s93, s73
    s_lshl_b32 s93, s93, 7
    s_add_u32 s91, s93, 0x920000
    s_lshl_b32 s93, s71, 2
    s_add_u32 s93, s93, s69
    s_mul_i32 s90, s93, 0x1c000
    s_mul_i32 s85, s69, 0x62000
    s_mul_i32 s86, s69, 0x18800
    s_lshl_b32 s93, s69, 11
    s_lshl_b32 s27, s75, 7
    buffer_load_dwordx4 v[28:31], v90, s[28:31], s27 offen
    s_lshl_b32 s94, s70, 10
    s_add_u32 s99, s93, s94
    v_lshrrev_b32 v80, 3, v1
    v_and_b32 v81, 7, v1
    v_lshrrev_b32 v82, 5, v1
    v_bfe_u32 v83, v1, 2, 2
    v_and_b32 v84, 3, v1
    v_bfe_u32 v85, v1, 4, 1
    s_lshr_b32 s93, s68, 1
    s_lshl_b32 s93, s93, 12
    buffer_load_dwordx4 v[56:59], v91, s[28:31], s27 offen
    s_and_b32 s94, s68, 1
    s_lshl_b32 s94, s94, 8
    s_add_u32 s93, s93, s94
    v_xor_b32 v20, v80, v81
    v_lshlrev_b32 v20, 4, v20
    v_and_b32 v21, 1, v81
    v_lshl_add_u32 v20, v21, 9, v20
    v_lshrrev_b32 v21, 1, v81
    v_lshl_add_u32 v20, v21, 10, v20
    v_add_u32 v3, s93, v20
    s_lshl_b32 s27, s76, 7
    buffer_load_dwordx4 v[32:35], v90, s[28:31], s27 offen
    s_lshl_b32 s93, s69, 12
    v_xor_b32 v20, v82, v1
    v_lshlrev_b32 v20, 4, v20
    v_add_u32 v4, s93, v20
    v_xor_b32 v21, 32, v20
    v_add_u32 v21, s93, v21
    v_add_u32 v5, 0x400, v21
    v_xor_b32 v21, 64, v20
    v_add_u32 v21, s93, v21
    v_add_u32 v6, 0x800, v21
    buffer_load_dwordx4 v[60:63], v91, s[28:31], s27 offen
    v_xor_b32 v21, 0x60, v20
    v_add_u32 v21, s93, v21
    v_add_u32 v7, 0xc00, v21
    v_lshl_add_u32 v86, v82, 3, v83
    v_lshrrev_b32 v87, 1, v83
    v_xor_b32 v20, s70, v87
    v_lshlrev_b32 v20, 6, v20
    v_lshl_add_u32 v20, v86, 7, v20
    v_lshl_add_u32 v20, v85, 5, v20
    v_lshl_add_u32 v8, v84, 3, v20
    s_waitcnt vmcnt(5)
    v_dot2c_f32_bf16 v128, s84, v24
    v_dot2c_f32_bf16 v130, v24, v24
    s_waitcnt vmcnt(4)
    v_dot2c_f32_bf16 v129, s84, v52
    v_dot2c_f32_bf16 v131, v52, v52
    v_dot2c_f32_bf16 v128, s84, v25
    v_dot2c_f32_bf16 v130, v25, v25
    v_dot2c_f32_bf16 v129, s84, v53
    v_dot2c_f32_bf16 v131, v53, v53
    v_dot2c_f32_bf16 v128, s84, v26
    v_dot2c_f32_bf16 v130, v26, v26
    v_dot2c_f32_bf16 v129, s84, v54
    v_dot2c_f32_bf16 v131, v54, v54
    v_dot2c_f32_bf16 v128, s84, v27
    v_dot2c_f32_bf16 v130, v27, v27
    v_dot2c_f32_bf16 v129, s84, v55
    v_dot2c_f32_bf16 v131, v55, v55
    s_lshl_b32 s27, s77, 7
    buffer_load_dwordx4 v[36:39], v90, s[28:31], s27 offen
    v_lshl_or_b32 v21, v85, 1, v87
    s_lshl_b32 s93, s70, 1
    v_xor_b32 v20, s93, v21
    v_lshlrev_b32 v20, 5, v20
    v_lshl_add_u32 v20, v86, 7, v20
    v_lshl_add_u32 v20, v85, 13, v20
    v_lshl_add_u32 v12, v84, 3, v20
    v_xor_b32 v13, 32, v12
    v_xor_b32 v20, s70, v85
    v_lshlrev_b32 v20, 5, v20
    buffer_load_dwordx4 v[64:67], v91, s[28:31], s27 offen
    v_lshl_add_u32 v20, v86, 6, v20
    v_lshl_add_u32 v20, v85, 12, v20
    v_lshl_add_u32 v15, v84, 3, v20
    v_bfe_u32 v88, v80, 1, 1
    s_lshl_b32 s93, s68, 3
    v_add_u32 v20, s93, v80
    v_mul_u32_u24 v22, 0xa80, v20
    v_bfe_u32 v21, v1, 2, 1
    v_xor_b32 v21, v21, v88
    v_mul_u32_u24 v21, 56, v21
    s_waitcnt vmcnt(5)
    v_dot2c_f32_bf16 v128, s84, v28
    v_dot2c_f32_bf16 v130, v28, v28
    s_waitcnt vmcnt(4)
    v_dot2c_f32_bf16 v129, s84, v56
    v_dot2c_f32_bf16 v131, v56, v56
    v_dot2c_f32_bf16 v128, s84, v29
    v_dot2c_f32_bf16 v130, v29, v29
    v_dot2c_f32_bf16 v129, s84, v57
    v_dot2c_f32_bf16 v131, v57, v57
    v_dot2c_f32_bf16 v128, s84, v30
    v_dot2c_f32_bf16 v130, v30, v30
    v_dot2c_f32_bf16 v129, s84, v58
    v_dot2c_f32_bf16 v131, v58, v58
    v_dot2c_f32_bf16 v128, s84, v31
    v_dot2c_f32_bf16 v130, v31, v31
    v_dot2c_f32_bf16 v129, s84, v59
    v_dot2c_f32_bf16 v131, v59, v59
    s_lshl_b32 s27, s78, 7
    buffer_load_dwordx4 v[40:43], v90, s[28:31], s27 offen
    v_add_u32 v22, v22, v21
    v_lshl_add_u32 v22, v84, 4, v22
    s_mul_i32 s94, s72, 0x70
    v_add_u32 v9, s94, v22
    v_mul_u32_u24 v22, 0xe00, v20
    v_lshlrev_b32 v21, 1, v88
    v_xor_b32 v21, v21, v81
    v_lshl_add_u32 v10, v21, 4, v22
    v_xor_b32 v11, 64, v10
    s_lshl_b32 s93, s69, 4
    buffer_load_dwordx4 v[68:71], v91, s[28:31], s27 offen
    v_lshrrev_b32 v20, 2, v1
    v_add_u32 v20, s93, v20
    v_mul_u32_u24 v20, 0xe00, v20
    s_lshl_b32 s93, s70, 1
    v_xor_b32 v21, s93, v84
    v_lshl_add_u32 v14, v21, 4, v20
    v_add_u32 v16, -1, v82
    v_and_b32 v17, 1.0, v16
    v_lshl_or_b32 v20, v85, 2, v84
    v_min_u32 v20, 6, v20
    s_waitcnt vmcnt(5)
    v_dot2c_f32_bf16 v128, s84, v32
    v_dot2c_f32_bf16 v130, v32, v32
    s_waitcnt vmcnt(4)
    v_dot2c_f32_bf16 v129, s84, v60
    v_dot2c_f32_bf16 v131, v60, v60
    v_dot2c_f32_bf16 v128, s84, v33
    v_dot2c_f32_bf16 v130, v33, v33
    v_dot2c_f32_bf16 v129, s84, v61
    v_dot2c_f32_bf16 v131, v61, v61
    v_dot2c_f32_bf16 v128, s84, v34
    v_dot2c_f32_bf16 v130, v34, v34
    v_dot2c_f32_bf16 v129, s84, v62
    v_dot2c_f32_bf16 v131, v62, v62
    v_dot2c_f32_bf16 v128, s84, v35
    v_dot2c_f32_bf16 v130, v35, v35
    v_dot2c_f32_bf16 v129, s84, v63
    v_dot2c_f32_bf16 v131, v63, v63
    s_lshl_b32 s27, s79, 7
    buffer_load_dwordx4 v[44:47], v90, s[28:31], s27 offen
    v_lshlrev_b32 v20, 3, v20
    v_lshl_add_u32 v21, v82, 2, v83
    v_mul_u32_u24 v21, 56, v21
    v_add_u32 v20, v20, v21
    s_mul_i32 s93, s70, 0x620
    s_add_u32 s93, s93, 0x8000
    v_add_u32 v143, s93, v20
    s_cmp_eq_u32 s96, 0
    s_cselect_b32 s46, 0, s46
    s_cselect_b32 s50, 0, s50
    buffer_load_dwordx4 v[72:75], v91, s[28:31], s27 offen
    s_waitcnt vmcnt(5)
    v_dot2c_f32_bf16 v128, s84, v36
    v_dot2c_f32_bf16 v130, v36, v36
    s_waitcnt vmcnt(4)
    v_dot2c_f32_bf16 v129, s84, v64
    v_dot2c_f32_bf16 v131, v64, v64
    v_dot2c_f32_bf16 v128, s84, v37
    v_dot2c_f32_bf16 v130, v37, v37
    v_dot2c_f32_bf16 v129, s84, v65
    v_dot2c_f32_bf16 v131, v65, v65
    v_dot2c_f32_bf16 v128, s84, v38
    v_dot2c_f32_bf16 v130, v38, v38
    v_dot2c_f32_bf16 v129, s84, v66
    v_dot2c_f32_bf16 v131, v66, v66
    v_dot2c_f32_bf16 v128, s84, v39
    v_dot2c_f32_bf16 v130, v39, v39
    v_dot2c_f32_bf16 v129, s84, v67
    v_dot2c_f32_bf16 v131, v67, v67
    s_lshl_b32 s27, s80, 7
    buffer_load_dwordx4 v[48:51], v90, s[28:31], s27 offen
    buffer_load_dwordx4 v[76:79], v91, s[28:31], s27 offen
    s_waitcnt vmcnt(5)
    v_dot2c_f32_bf16 v128, s84, v40
    v_dot2c_f32_bf16 v130, v40, v40
    s_waitcnt vmcnt(4)
    v_dot2c_f32_bf16 v129, s84, v68
    v_dot2c_f32_bf16 v131, v68, v68
    v_dot2c_f32_bf16 v128, s84, v41
    v_dot2c_f32_bf16 v130, v41, v41
    v_dot2c_f32_bf16 v129, s84, v69
    v_dot2c_f32_bf16 v131, v69, v69
    v_dot2c_f32_bf16 v128, s84, v42
    v_dot2c_f32_bf16 v130, v42, v42
    v_dot2c_f32_bf16 v129, s84, v70
    v_dot2c_f32_bf16 v131, v70, v70
    v_dot2c_f32_bf16 v128, s84, v43
    v_dot2c_f32_bf16 v130, v43, v43
    v_dot2c_f32_bf16 v129, s84, v71
    v_dot2c_f32_bf16 v131, v71, v71
    s_lshl_b32 s93, s73, 1
    s_add_u32 s93, s93, s70
    s_cmp_eq_u32 s93, 1
    s_cbranch_scc1 L_PROG1
    s_cmp_eq_u32 s93, 2
    s_cbranch_scc1 L_PROG2
    s_cmp_eq_u32 s93, 3
    s_cbranch_scc1 L_PROG3
    s_waitcnt vmcnt(3)
    v_dot2c_f32_bf16 v128, s84, v44
    v_dot2c_f32_bf16 v130, v44, v44
    s_waitcnt vmcnt(2)
    v_dot2c_f32_bf16 v129, s84, v72
    s_mul_i32 s92, s74, 0x2a000
    s_add_u32 m0, s87, 0xc000
    s_add_u32 s92, s92, 0x380
    buffer_load_dwordx4 v9, s[32:35], s92 offen lds
    v_dot2c_f32_bf16 v131, v72, v72
    v_dot2c_f32_bf16 v128, s84, v45
    v_dot2c_f32_bf16 v130, v45, v45
    v_dot2c_f32_bf16 v129, s84, v73
    s_mul_i32 s92, s74, 0x2a000
    s_add_u32 m0, s87, 0xe000
    s_add_u32 s92, s92, 0x700
    buffer_load_dwordx4 v9, s[32:35], s92 offen lds
    v_dot2c_f32_bf16 v131, v73, v73
    v_dot2c_f32_bf16 v128, s84, v46
    v_dot2c_f32_bf16 v130, v46, v46
    v_dot2c_f32_bf16 v129, s84, v74
    v_dot2c_f32_bf16 v131, v74, v74
    s_and_b32 s93, s68, 3
    s_lshl_b32 s27, s93, 10
    v_add_u32 v22, s27, v2
    s_mul_i32 s92, s72, 0xc40
    s_add_u32 m0, s27, 0x8000
    s_nop 0
    buffer_load_dwordx4 v22, s[52:55], s92 offen lds
    v_dot2c_f32_bf16 v128, s84, v47
    v_dot2c_f32_bf16 v130, v47, v47
    v_dot2c_f32_bf16 v129, s84, v75
    v_dot2c_f32_bf16 v131, v75, v75
    s_mul_i32 s93, s72, 0x1c0
    s_bitcmp1_b32 s72, 0
    s_cselect_b32 s88, 64, 0x100
    s_cselect_b32 s89, 0, 0x180
    s_add_u32 s88, s88, s93
    s_add_u32 s89, s89, s93
    s_waitcnt vmcnt(4)
    v_dot2c_f32_bf16 v128, s84, v48
    v_dot2c_f32_bf16 v130, v48, v48
    s_waitcnt vmcnt(3)
    v_dot2c_f32_bf16 v129, s84, v76
    v_dot2c_f32_bf16 v131, v76, v76
    v_dot2c_f32_bf16 v128, s84, v49
    s_sub_u32 s93, s91, 0x920000
    s_lshl_b32 s93, s93, 2
    s_add_u32 s16, s93, 0x930000
    v_dot2c_f32_bf16 v130, v49, v49
    v_dot2c_f32_bf16 v129, s84, v77
    v_dot2c_f32_bf16 v131, v77, v77
    v_dot2c_f32_bf16 v128, s84, v50
    v_dot2c_f32_bf16 v130, v50, v50
    s_cmp_lg_u32 s68, 0
    s_cbranch_scc1 L_zero_1001
    v_mov_b32 v92, 0
    v_mov_b32 v93, 0
    v_mov_b32 v94, 0
    v_mov_b32 v95, 0
    s_mov_b32 exec_lo, -1
    s_mov_b32 exec_hi, 0
    buffer_store_dwordx4 v[92:95], v2, s[60:63], s16 offen sc1
    s_mov_b64 exec, -1
    v_lshrrev_b32 v20, 5, v1
    v_lshlrev_b32 v20, 13, v20
    v_and_b32 v21, 31, v1
    v_lshl_add_u32 v20, v21, 4, v20
    s_lshl_b32 s93, s72, 14
    s_lshl_b32 s94, s71, 9
    s_add_u32 s93, s93, s94
    s_add_u32 s93, s93, 0x900000
    buffer_store_dwordx4 v[92:95], v20, s[60:63], s93 offen sc1
L_zero_1001:
    v_dot2c_f32_bf16 v129, s84, v78
    v_dot2c_f32_bf16 v131, v78, v78
    v_dot2c_f32_bf16 v128, s84, v51
    v_dot2c_f32_bf16 v130, v51, v51
    s_cmp_eq_u32 s70, 0
    s_cselect_b32 s4, s36, s40
    s_cselect_b32 s5, s37, s41
    s_cselect_b32 s6, s38, s42
    s_mov_b32 s7, 0x20000
    v_dot2c_f32_bf16 v129, s84, v79
    v_dot2c_f32_bf16 v131, v79, v79
    v_add_f32_dpp v128, v128, v128 quad_perm:[1,0,3,2] row_mask:0xf bank_mask:0xf
    v_add_f32_dpp v130, v130, v130 quad_perm:[1,0,3,2] row_mask:0xf bank_mask:0xf
    v_add_f32_dpp v129, v129, v129 quad_perm:[1,0,3,2] row_mask:0xf bank_mask:0xf
    v_add_f32_dpp v131, v131, v131 quad_perm:[1,0,3,2] row_mask:0xf bank_mask:0xf
    v_add_f32_dpp v128, v128, v128 quad_perm:[2,3,0,1] row_mask:0xf bank_mask:0xf
    v_add_f32_dpp v130, v130, v130 quad_perm:[2,3,0,1] row_mask:0xf bank_mask:0xf
    v_add_f32_dpp v129, v129, v129 quad_perm:[2,3,0,1] row_mask:0xf bank_mask:0xf
    v_add_f32_dpp v131, v131, v131 quad_perm:[2,3,0,1] row_mask:0xf bank_mask:0xf
    v_add_f32_dpp v128, v128, v128 row_half_mirror row_mask:0xf bank_mask:0xf
    v_add_f32_dpp v130, v130, v130 row_half_mirror row_mask:0xf bank_mask:0xf
    v_add_f32_dpp v129, v129, v129 row_half_mirror row_mask:0xf bank_mask:0xf
    v_add_f32_dpp v131, v131, v131 row_half_mirror row_mask:0xf bank_mask:0xf
    v_mul_f32 v128, 0xbb124925, v128
    v_mul_f32 v130, 0x3b124925, v130
    v_mul_f32 v129, 0xbb124925, v129
    v_mul_f32 v131, 0x3b124925, v131
    v_fma_f32 v130, -v128, v128, v130
    v_fma_f32 v131, -v129, v129, v131
    v_max_f32 v130, 0, v130
    v_max_f32 v131, 0, v131
    v_add_f32 v130, 0x3727c5ac, v130
    v_add_f32 v131, 0x3727c5ac, v131
    v_rsq_f32 v130, v130
    v_rsq_f32 v131, v131
    s_nop 0
    v_mul_f32 v130, 0xbfb8aa3b, v130
    v_mul_f32 v131, 0xbfb8aa3b, v131
    v_mul_f32 v128, v128, v130
    v_mul_f32 v129, v129, v131
    v_lshlrev_b32 v120, 16, v24
    v_and_b32 v121, s81, v24
    v_lshlrev_b32 v122, 16, v25
    v_and_b32 v123, s81, v25
    v_lshlrev_b32 v124, 16, v26
    v_and_b32 v125, s81, v26
    v_lshlrev_b32 v126, 16, v27
    v_and_b32 v127, s81, v27
    v_fma_f32 v120, v120, v130, v128
    v_fma_f32 v121, v121, v130, v128
    v_fma_f32 v122, v122, v130, v128
    v_fma_f32 v123, v123, v130, v128
    v_fma_f32 v124, v124, v130, v128
    v_fma_f32 v125, v125, v130, v128
    v_fma_f32 v126, v126, v130, v128
    v_fma_f32 v127, v127, v130, v128
    v_cvt_pk_bf16_f32 v24, v120, v121
    v_cvt_pk_bf16_f32 v25, v122, v123
    v_cvt_pk_bf16_f32 v26, v124, v125
    v_cvt_pk_bf16_f32 v27, v126, v127
    ds_write_b128 v3, v[24:27]
    v_lshlrev_b32 v120, 16, v52
    v_and_b32 v121, s81, v52
    v_lshlrev_b32 v122, 16, v53
    v_and_b32 v123, s81, v53
    v_lshlrev_b32 v124, 16, v54
    v_and_b32 v125, s81, v54
    v_lshlrev_b32 v126, 16, v55
    v_and_b32 v127, s81, v55
    v_fma_f32 v120, v120, v131, v129
    v_fma_f32 v121, v121, v131, v129
    v_fma_f32 v122, v122, v131, v129
    v_fma_f32 v123, v123, v131, v129
    v_fma_f32 v124, v124, v131, v129
    v_fma_f32 v125, v125, v131, v129
    v_fma_f32 v126, v126, v131, v129
    v_fma_f32 v127, v127, v131, v129
    v_cvt_pk_bf16_f32 v52, v120, v121
    v_cvt_pk_bf16_f32 v53, v122, v123
    v_cvt_pk_bf16_f32 v54, v124, v125
    v_cvt_pk_bf16_f32 v55, v126, v127
    ds_write_b128 v3, v[52:55] offset:128
    s_waitcnt lgkmcnt(0)
    s_barrier
    ds_read_b128 a[0:3], v4
    ds_read_b128 a[4:7], v5
    ds_read_b128 a[8:11], v6
    ds_read_b128 a[12:15], v7
    v_lshlrev_b32 v120, 16, v28
    v_and_b32 v121, s81, v28
    s_mul_i32 s92, s75, 0x2a000
    s_add_u32 m0, s87, 0x10000
    s_add_u32 s92, s92, 0x380
    buffer_load_dwordx4 v9, s[32:35], s92 offen lds
    v_lshlrev_b32 v122, 16, v29
    v_and_b32 v123, s81, v29
    v_lshlrev_b32 v124, 16, v30
    v_and_b32 v125, s81, v30
    v_lshlrev_b32 v126, 16, v31
    v_and_b32 v127, s81, v31
    v_fma_f32 v120, v120, v130, v128
    v_fma_f32 v121, v121, v130, v128
    v_fma_f32 v122, v122, v130, v128
    v_fma_f32 v123, v123, v130, v128
    v_fma_f32 v124, v124, v130, v128
    v_fma_f32 v125, v125, v130, v128
    v_fma_f32 v126, v126, v130, v128
    v_fma_f32 v127, v127, v130, v128
    v_cvt_pk_bf16_f32 v28, v120, v121
    v_cvt_pk_bf16_f32 v29, v122, v123
    v_cvt_pk_bf16_f32 v30, v124, v125
    v_cvt_pk_bf16_f32 v31, v126, v127
    s_mul_i32 s92, s75, 0x2a000
    s_add_u32 m0, s87, 0x12000
    s_add_u32 s92, s92, 0x700
    buffer_load_dwordx4 v9, s[32:35], s92 offen lds
    ds_write_b128 v3, v[28:31] offset:16384
    v_lshlrev_b32 v120, 16, v56
    v_and_b32 v121, s81, v56
    v_lshlrev_b32 v122, 16, v57
    v_and_b32 v123, s81, v57
    v_lshlrev_b32 v124, 16, v58
    v_and_b32 v125, s81, v58
    v_lshlrev_b32 v126, 16, v59
    v_and_b32 v127, s81, v59
    v_fma_f32 v120, v120, v131, v129
    v_fma_f32 v121, v121, v131, v129
    v_fma_f32 v122, v122, v131, v129
    v_fma_f32 v123, v123, v131, v129
    v_fma_f32 v124, v124, v131, v129
    v_fma_f32 v125, v125, v131, v129
    v_fma_f32 v126, v126, v131, v129
    v_fma_f32 v127, v127, v131, v129
    v_cvt_pk_bf16_f32 v56, v120, v121
    v_cvt_pk_bf16_f32 v57, v122, v123
    v_cvt_pk_bf16_f32 v58, v124, v125
    v_cvt_pk_bf16_f32 v59, v126, v127
    ds_write_b128 v3, v[56:59] offset:16512
    s_waitcnt vmcnt(2)
    s_waitcnt lgkmcnt(0)
    s_barrier
    ds_read_b64_tr_b16 v[132:133], v143
    ds_read_b64_tr_b16 v[134:135], v143 offset:448
    ds_read_b64_tr_b16 v[136:137], v143 offset:896
    ds_read_b64_tr_b16 v[138:139], v143 offset:1344
    v_add_u32 v22, 0xc000, v8
    ds_read_b64_tr_b16 v[112:113], v22
    ds_read_b64_tr_b16 v[114:115], v22 offset:512
    ds_read_b64_tr_b16 v[116:117], v22 offset:8192
    ds_read_b64_tr_b16 v[118:119], v22 offset:8704
    ds_read_b64_tr_b16 v[24:25], v22 offset:2048
    ds_read_b64_tr_b16 v[26:27], v22 offset:2560
    ds_read_b64_tr_b16 v[52:53], v22 offset:10240
    ds_read_b64_tr_b16 v[54:55], v22 offset:10752
    s_waitcnt lgkmcnt(6)
    v_mfma_f32_32x32x16_bf16 v[80:95], v[112:115], a[0:3], 0
    ds_read_b128 a[16:19], v4 offset:16384
    ds_read_b128 a[20:23], v5 offset:16384
    s_mul_i32 s92, s76, 0x2a000
    s_add_u32 m0, s87, 0x14000
    s_add_u32 s92, s92, 0x380
    buffer_load_dwordx4 v9, s[32:35], s92 offen lds
    ds_read_b128 a[24:27], v6 offset:16384
    ds_read_b128 a[28:31], v7 offset:16384
    ds_read_b64_tr_b16 v[112:113], v22 offset:4096
    ds_read_b64_tr_b16 v[114:115], v22 offset:4608
    s_waitcnt lgkmcnt(10)
    v_mfma_f32_32x32x16_bf16 v[96:111], v[116:119], a[0:3], 0
    v_lshlrev_b32 v120, 16, v32
    v_and_b32 v121, s81, v32
    v_lshlrev_b32 v122, 16, v33
    v_and_b32 v123, s81, v33
    v_lshlrev_b32 v124, 16, v34
    s_mul_i32 s92, s76, 0x2a000
    s_add_u32 m0, s87, 0x16000
    s_add_u32 s92, s92, 0x700
    buffer_load_dwordx4 v9, s[32:35], s92 offen lds
    ds_read_b64_tr_b16 v[116:117], v22 offset:12288
    ds_read_b64_tr_b16 v[118:119], v22 offset:12800
    s_waitcnt lgkmcnt(10)
    v_mfma_f32_32x32x16_bf16 v[80:95], v[24:27], a[4:7], v[80:95]
    v_and_b32 v125, s81, v34
    v_lshlrev_b32 v126, 16, v35
    v_and_b32 v127, s81, v35
    v_fma_f32 v120, v120, v130, v128
    v_fma_f32 v121, v121, v130, v128
    v_fma_f32 v122, v122, v130, v128
    v_fma_f32 v123, v123, v130, v128
    ds_read_b64_tr_b16 v[24:25], v22 offset:6144
    ds_read_b64_tr_b16 v[26:27], v22 offset:6656
    s_waitcnt lgkmcnt(10)
    v_mfma_f32_32x32x16_bf16 v[96:111], v[52:55], a[4:7], v[96:111]
    s_mul_i32 s92, s77, 0x2a000
    s_add_u32 m0, s87, 0x18000
    s_add_u32 s92, s92, 0x380
    buffer_load_dwordx4 v9, s[32:35], s92 offen lds
    v_fma_f32 v124, v124, v130, v128
    v_fma_f32 v125, v125, v130, v128
    v_fma_f32 v126, v126, v130, v128
    v_fma_f32 v127, v127, v130, v128
    ds_read_b64_tr_b16 v[52:53], v22 offset:14336
    ds_read_b64_tr_b16 v[54:55], v22 offset:14848
    s_waitcnt lgkmcnt(6)
    v_mfma_f32_32x32x16_bf16 v[80:95], v[112:115], a[8:11], v[80:95]
    v_cvt_pk_bf16_f32 v32, v120, v121
    v_cvt_pk_bf16_f32 v33, v122, v123
    v_cvt_pk_bf16_f32 v34, v124, v125
    s_mul_i32 s92, s77, 0x2a000
    s_add_u32 m0, s87, 0x1a000
    s_add_u32 s92, s92, 0x700
    buffer_load_dwordx4 v9, s[32:35], s92 offen lds
    v_cvt_pk_bf16_f32 v35, v126, v127
    s_waitcnt lgkmcnt(4)
    v_mfma_f32_32x32x16_bf16 v[96:111], v[116:119], a[8:11], v[96:111]
    ds_write_b128 v3, v[32:35]
    v_lshlrev_b32 v120, 16, v60
    v_and_b32 v121, s81, v60
    v_lshlrev_b32 v122, 16, v61
    v_and_b32 v123, s81, v61
    v_lshlrev_b32 v124, 16, v62
    v_and_b32 v125, s81, v62
    v_lshlrev_b32 v126, 16, v63
    s_waitcnt lgkmcnt(3)
    v_mfma_f32_32x32x16_bf16 v[80:95], v[24:27], a[12:15], v[80:95]
    v_and_b32 v127, s81, v63
    v_fma_f32 v120, v120, v131, v129
    v_fma_f32 v121, v121, v131, v129
    v_fma_f32 v122, v122, v131, v129
    v_fma_f32 v123, v123, v131, v129
    v_fma_f32 v124, v124, v131, v129
    v_fma_f32 v125, v125, v131, v129
    v_fma_f32 v126, v126, v131, v129
    s_waitcnt lgkmcnt(1)
    v_mfma_f32_32x32x16_bf16 v[96:111], v[52:55], a[12:15], v[96:111]
    v_fma_f32 v127, v127, v131, v129
    v_cvt_pk_bf16_f32 v60, v120, v121
    v_cvt_pk_bf16_f32 v61, v122, v123
    v_cvt_pk_bf16_f32 v62, v124, v125
    v_cvt_pk_bf16_f32 v63, v126, v127
    ds_write_b128 v3, v[60:63] offset:128
    v_and_b32 v138, v16, v138
    v_and_b32 v139, v16, v139
    s_waitcnt vmcnt(4)
    s_waitcnt lgkmcnt(0)
    s_barrier
    v_add_u32 v23, 0x10000, v8
    ds_read_b64_tr_b16 v[112:113], v23
    ds_read_b64_tr_b16 v[114:115], v23 offset:512
    ds_read_b64_tr_b16 v[116:117], v23 offset:8192
    ds_read_b64_tr_b16 v[118:119], v23 offset:8704
    ds_read_b64_tr_b16 v[24:25], v23 offset:2048
    ds_read_b64_tr_b16 v[26:27], v23 offset:2560
    ds_read_b64_tr_b16 v[52:53], v23 offset:10240
    ds_read_b64_tr_b16 v[54:55], v23 offset:10752
    s_waitcnt lgkmcnt(6)
    v_mfma_f32_32x32x16_bf16 v[80:95], v[112:115], a[16:19], v[80:95]
    ds_read_b128 a[32:35], v4
    ds_read_b128 a[36:39], v5
    s_mul_i32 s92, s78, 0x2a000
    s_add_u32 m0, s87, 0x1c000
    s_add_u32 s92, s92, 0x380
    buffer_load_dwordx4 v9, s[32:35], s92 offen lds
    ds_read_b128 a[40:43], v6
    ds_read_b128 a[44:47], v7
    ds_read_b64_tr_b16 v[112:113], v23 offset:4096
    ds_read_b64_tr_b16 v[114:115], v23 offset:4608
    s_waitcnt lgkmcnt(10)
    v_mfma_f32_32x32x16_bf16 v[96:111], v[116:119], a[16:19], v[96:111]
    v_lshlrev_b32 v120, 16, v36
    v_and_b32 v121, s81, v36
    v_lshlrev_b32 v122, 16, v37
    v_and_b32 v123, s81, v37
    v_lshlrev_b32 v124, 16, v38
    v_and_b32 v125, s81, v38
    v_lshlrev_b32 v126, 16, v39
    ds_read_b64_tr_b16 v[116:117], v23 offset:12288
    ds_read_b64_tr_b16 v[118:119], v23 offset:12800
    s_waitcnt lgkmcnt(10)
    v_mfma_f32_32x32x16_bf16 v[80:95], v[24:27], a[20:23], v[80:95]
    v_and_b32 v127, s81, v39
    s_mul_i32 s92, s78, 0x2a000
    s_add_u32 m0, s87, 0x1e000
    s_add_u32 s92, s92, 0x700
    buffer_load_dwordx4 v9, s[32:35], s92 offen lds
    v_fma_f32 v120, v120, v130, v128
    v_fma_f32 v121, v121, v130, v128
    v_fma_f32 v122, v122, v130, v128
    ds_read_b64_tr_b16 v[24:25], v23 offset:6144
    ds_read_b64_tr_b16 v[26:27], v23 offset:6656
    s_waitcnt lgkmcnt(10)
    v_mfma_f32_32x32x16_bf16 v[96:111], v[52:55], a[20:23], v[96:111]
    v_fma_f32 v123, v123, v130, v128
    v_fma_f32 v124, v124, v130, v128
    v_fma_f32 v125, v125, v130, v128
    v_fma_f32 v126, v126, v130, v128
    v_fma_f32 v127, v127, v130, v128
    v_cvt_pk_bf16_f32 v36, v120, v121
    v_cvt_pk_bf16_f32 v37, v122, v123
    ds_read_b64_tr_b16 v[52:53], v23 offset:14336
    ds_read_b64_tr_b16 v[54:55], v23 offset:14848
    s_waitcnt lgkmcnt(6)
    v_mfma_f32_32x32x16_bf16 v[80:95], v[112:115], a[24:27], v[80:95]
    s_cmp_lg_u32 s68, 0
    s_cbranch_scc1 L_zsig_1002
    v_mov_b32 v20, 1
    v_mov_b32 v21, 0
    s_and_b32 s93, s2, 3
    s_lshl_b32 s93, s93, 6
    s_mov_b64 exec, 1
    buffer_atomic_add v20, v21, s[64:67], s93 offen
    s_mov_b64 exec, -1
L_zsig_1002:
    v_cvt_pk_bf16_f32 v38, v124, v125
    s_waitcnt lgkmcnt(4)
    v_mfma_f32_32x32x16_bf16 v[96:111], v[116:119], a[24:27], v[96:111]
    v_cvt_pk_bf16_f32 v39, v126, v127
    ds_write_b128 v3, v[36:39] offset:16384
    v_lshlrev_b32 v120, 16, v64
    v_and_b32 v121, s81, v64
    v_lshlrev_b32 v122, 16, v65
    v_and_b32 v123, s81, v65
    v_lshlrev_b32 v124, 16, v66
    v_and_b32 v125, s81, v66
    s_waitcnt lgkmcnt(3)
    v_mfma_f32_32x32x16_bf16 v[80:95], v[24:27], a[28:31], v[80:95]
    v_lshlrev_b32 v126, 16, v67
    v_and_b32 v127, s81, v67
    v_fma_f32 v120, v120, v131, v129
    v_fma_f32 v121, v121, v131, v129
    v_fma_f32 v122, v122, v131, v129
    v_fma_f32 v123, v123, v131, v129
    v_fma_f32 v124, v124, v131, v129
    s_waitcnt lgkmcnt(1)
    v_mfma_f32_32x32x16_bf16 v[96:111], v[52:55], a[28:31], v[96:111]
    v_fma_f32 v125, v125, v131, v129
    v_fma_f32 v126, v126, v131, v129
    v_fma_f32 v127, v127, v131, v129
    v_cvt_pk_bf16_f32 v64, v120, v121
    v_cvt_pk_bf16_f32 v65, v122, v123
    v_cvt_pk_bf16_f32 v66, v124, v125
    v_cvt_pk_bf16_f32 v67, v126, v127
    ds_write_b128 v3, v[64:67] offset:16512
    s_waitcnt vmcnt(4)
    s_waitcnt vmcnt(2)
    s_waitcnt lgkmcnt(0)
    s_barrier
    v_add_u32 v22, 0x14000, v8
    ds_read_b64_tr_b16 v[112:113], v22
    ds_read_b64_tr_b16 v[114:115], v22 offset:512
    ds_read_b64_tr_b16 v[116:117], v22 offset:8192
    ds_read_b64_tr_b16 v[118:119], v22 offset:8704
    ds_read_b64_tr_b16 v[24:25], v22 offset:2048
    ds_read_b64_tr_b16 v[26:27], v22 offset:2560
    ds_read_b64_tr_b16 v[52:53], v22 offset:10240
    ds_read_b64_tr_b16 v[54:55], v22 offset:10752
    s_waitcnt lgkmcnt(6)
    v_mfma_f32_32x32x16_bf16 v[80:95], v[112:115], a[32:35], v[80:95]
    ds_read_b128 a[48:51], v4 offset:16384
    ds_read_b128 a[52:55], v5 offset:16384
    s_mul_i32 s92, s79, 0x2a000
    s_add_u32 m0, s87, 0x20000
    s_add_u32 s92, s92, 0x380
    buffer_load_dwordx4 v9, s[32:35], s92 offen lds
    ds_read_b128 a[56:59], v6 offset:16384
    ds_read_b64_tr_b16 v[112:113], v22 offset:4096
    ds_read_b64_tr_b16 v[114:115], v22 offset:4608
    s_waitcnt lgkmcnt(9)
    v_mfma_f32_32x32x16_bf16 v[96:111], v[116:119], a[32:35], v[96:111]
    ds_read_b128 a[60:63], v7 offset:16384
    v_lshlrev_b32 v120, 16, v40
    v_and_b32 v121, s81, v40
    v_lshlrev_b32 v122, 16, v41
    v_and_b32 v123, s81, v41
    v_lshlrev_b32 v124, 16, v42
    v_and_b32 v125, s81, v42
    ds_read_b64_tr_b16 v[116:117], v22 offset:12288
    ds_read_b64_tr_b16 v[118:119], v22 offset:12800
    s_waitcnt lgkmcnt(10)
    v_mfma_f32_32x32x16_bf16 v[80:95], v[24:27], a[36:39], v[80:95]
    v_lshlrev_b32 v126, 16, v43
    v_and_b32 v127, s81, v43
    v_fma_f32 v120, v120, v130, v128
    v_fma_f32 v121, v121, v130, v128
    v_fma_f32 v122, v122, v130, v128
    v_fma_f32 v123, v123, v130, v128
    ds_read_b64_tr_b16 v[24:25], v22 offset:6144
    ds_read_b64_tr_b16 v[26:27], v22 offset:6656
    s_waitcnt lgkmcnt(10)
    v_mfma_f32_32x32x16_bf16 v[96:111], v[52:55], a[36:39], v[96:111]
    v_fma_f32 v124, v124, v130, v128
    v_fma_f32 v125, v125, v130, v128
    v_fma_f32 v126, v126, v130, v128
    v_fma_f32 v127, v127, v130, v128
    v_cvt_pk_bf16_f32 v40, v120, v121
    v_cvt_pk_bf16_f32 v41, v122, v123
    ds_read_b64_tr_b16 v[52:53], v22 offset:14336
    ds_read_b64_tr_b16 v[54:55], v22 offset:14848
    s_waitcnt lgkmcnt(7)
    v_mfma_f32_32x32x16_bf16 v[80:95], v[112:115], a[40:43], v[80:95]
    s_mul_i32 s92, s79, 0x2a000
    s_add_u32 m0, s87, 0x22000
    s_add_u32 s92, s92, 0x700
    buffer_load_dwordx4 v9, s[32:35], s92 offen lds
    v_cvt_pk_bf16_f32 v42, v124, v125
    v_cvt_pk_bf16_f32 v43, v126, v127
    ds_write_b128 v3, v[40:43]
    v_lshlrev_b32 v120, 16, v68
    v_add_u32 v23, 0x18000, v8
    ds_read_b64_tr_b16 v[112:113], v23
    ds_read_b64_tr_b16 v[114:115], v23 offset:512
    s_waitcnt lgkmcnt(7)
    v_mfma_f32_32x32x16_bf16 v[96:111], v[116:119], a[40:43], v[96:111]
    v_and_b32 v121, s81, v68
    v_lshlrev_b32 v122, 16, v69
    v_and_b32 v123, s81, v69
    v_lshlrev_b32 v124, 16, v70
    v_and_b32 v125, s81, v70
    v_lshlrev_b32 v126, 16, v71
    v_and_b32 v127, s81, v71
    ds_read_b64_tr_b16 v[116:117], v23 offset:8192
    ds_read_b64_tr_b16 v[118:119], v23 offset:8704
    s_waitcnt lgkmcnt(7)
    v_mfma_f32_32x32x16_bf16 v[80:95], v[24:27], a[44:47], v[80:95]
    v_fma_f32 v120, v120, v131, v129
    v_fma_f32 v121, v121, v131, v129
    v_fma_f32 v122, v122, v131, v129
    v_fma_f32 v123, v123, v131, v129
    v_fma_f32 v124, v124, v131, v129
    v_fma_f32 v125, v125, v131, v129
    ds_read_b64_tr_b16 v[24:25], v23 offset:2048
    ds_read_b64_tr_b16 v[26:27], v23 offset:2560
    s_waitcnt lgkmcnt(7)
    v_mfma_f32_32x32x16_bf16 v[96:111], v[52:55], a[44:47], v[96:111]
    v_fma_f32 v126, v126, v131, v129
    v_fma_f32 v127, v127, v131, v129
    v_cvt_pk_bf16_f32 v68, v120, v121
    v_cvt_pk_bf16_f32 v69, v122, v123
    v_cvt_pk_bf16_f32 v70, v124, v125
    v_cvt_pk_bf16_f32 v71, v126, v127
    ds_write_b128 v3, v[68:71] offset:128
    s_waitcnt vmcnt(2)
    s_waitcnt lgkmcnt(0)
    s_barrier
    ds_read_b64_tr_b16 v[52:53], v23 offset:10240
    ds_read_b64_tr_b16 v[54:55], v23 offset:10752
    v_mfma_f32_32x32x16_bf16 v[80:95], v[112:115], a[48:51], v[80:95]
    ds_read_b128 a[64:67], v4
    ds_read_b128 a[68:71], v5
    s_mul_i32 s92, s80, 0x2a000
    s_add_u32 m0, s87, 0x24000
    s_add_u32 s92, s92, 0x380
    buffer_load_dwordx4 v9, s[32:35], s92 offen lds
    ds_read_b128 a[72:75], v6
    ds_read_b64_tr_b16 v[112:113], v23 offset:4096
    ds_read_b64_tr_b16 v[114:115], v23 offset:4608
    v_mfma_f32_32x32x16_bf16 v[96:111], v[116:119], a[48:51], v[96:111]
    ds_read_b128 a[76:79], v7
    v_lshlrev_b32 v120, 16, v44
    v_and_b32 v121, s81, v44
    v_lshlrev_b32 v122, 16, v45
    v_and_b32 v123, s81, v45
    v_lshlrev_b32 v124, 16, v46
    v_and_b32 v125, s81, v46
    ds_read_b64_tr_b16 v[116:117], v23 offset:12288
    ds_read_b64_tr_b16 v[118:119], v23 offset:12800
    v_mfma_f32_32x32x16_bf16 v[80:95], v[24:27], a[52:55], v[80:95]
    v_lshlrev_b32 v126, 16, v47
    v_and_b32 v127, s81, v47
    v_fma_f32 v120, v120, v130, v128
    v_fma_f32 v121, v121, v130, v128
    v_fma_f32 v122, v122, v130, v128
    v_fma_f32 v123, v123, v130, v128
    ds_read_b64_tr_b16 v[24:25], v23 offset:6144
    ds_read_b64_tr_b16 v[26:27], v23 offset:6656
    s_waitcnt lgkmcnt(10)
    v_mfma_f32_32x32x16_bf16 v[96:111], v[52:55], a[52:55], v[96:111]
    v_fma_f32 v124, v124, v130, v128
    v_fma_f32 v125, v125, v130, v128
    v_fma_f32 v126, v126, v130, v128
    v_fma_f32 v127, v127, v130, v128
    v_cvt_pk_bf16_f32 v44, v120, v121
    v_cvt_pk_bf16_f32 v45, v122, v123
    ds_read_b64_tr_b16 v[52:53], v23 offset:14336
    ds_read_b64_tr_b16 v[54:55], v23 offset:14848
    s_waitcnt lgkmcnt(7)
    v_mfma_f32_32x32x16_bf16 v[80:95], v[112:115], a[56:59], v[80:95]
    s_mul_i32 s92, s80, 0x2a000
    s_add_u32 m0, s87, 0x26000
    s_add_u32 s92, s92, 0x700
    buffer_load_dwordx4 v9, s[32:35], s92 offen lds
    v_cvt_pk_bf16_f32 v46, v124, v125
    v_cvt_pk_bf16_f32 v47, v126, v127
    ds_write_b128 v3, v[44:47] offset:16384
    v_lshlrev_b32 v120, 16, v72
    v_add_u32 v22, 0x1c000, v8
    ds_read_b64_tr_b16 v[112:113], v22
    ds_read_b64_tr_b16 v[114:115], v22 offset:512
    s_waitcnt lgkmcnt(7)
    v_mfma_f32_32x32x16_bf16 v[96:111], v[116:119], a[56:59], v[96:111]
    v_and_b32 v121, s81, v72
    v_lshlrev_b32 v122, 16, v73
    v_and_b32 v123, s81, v73
    v_lshlrev_b32 v124, 16, v74
    v_and_b32 v125, s81, v74
    v_lshlrev_b32 v126, 16, v75
    v_and_b32 v127, s81, v75
    ds_read_b64_tr_b16 v[116:117], v22 offset:8192
    ds_read_b64_tr_b16 v[118:119], v22 offset:8704
    s_waitcnt lgkmcnt(7)
    v_mfma_f32_32x32x16_bf16 v[80:95], v[24:27], a[60:63], v[80:95]
    v_fma_f32 v120, v120, v131, v129
    v_fma_f32 v121, v121, v131, v129
    v_fma_f32 v122, v122, v131, v129
    v_fma_f32 v123, v123, v131, v129
    v_fma_f32 v124, v124, v131, v129
    v_fma_f32 v125, v125, v131, v129
    ds_read_b64_tr_b16 v[24:25], v22 offset:2048
    ds_read_b64_tr_b16 v[26:27], v22 offset:2560
    s_waitcnt lgkmcnt(7)
    v_mfma_f32_32x32x16_bf16 v[96:111], v[52:55], a[60:63], v[96:111]
    v_fma_f32 v126, v126, v131, v129
    v_fma_f32 v127, v127, v131, v129
    v_cvt_pk_bf16_f32 v72, v120, v121
    v_cvt_pk_bf16_f32 v73, v122, v123
    v_cvt_pk_bf16_f32 v74, v124, v125
    v_cvt_pk_bf16_f32 v75, v126, v127
    ds_write_b128 v3, v[72:75] offset:16512
    s_waitcnt vmcnt(2)
    s_waitcnt lgkmcnt(0)
    s_barrier
    ds_read_b64_tr_b16 v[52:53], v22 offset:10240
    ds_read_b64_tr_b16 v[54:55], v22 offset:10752
    v_mfma_f32_32x32x16_bf16 v[80:95], v[112:115], a[64:67], v[80:95]
    ds_read_b128 a[80:83], v4 offset:16384
    ds_read_b128 a[84:87], v5 offset:16384
    s_mul_i32 s92, s74, 0x38000
    s_add_u32 m0, s87, 0xc000
    s_add_u32 s92, s92, s88
    buffer_load_dwordx4 v10, s[36:39], s92 offen lds
    ds_read_b128 a[88:91], v6 offset:16384
    ds_read_b64_tr_b16 v[112:113], v22 offset:4096
    ds_read_b64_tr_b16 v[114:115], v22 offset:4608
    v_mfma_f32_32x32x16_bf16 v[96:111], v[116:119], a[64:67], v[96:111]
    ds_read_b128 a[92:95], v7 offset:16384
    v_lshlrev_b32 v120, 16, v48
    v_and_b32 v121, s81, v48
    v_lshlrev_b32 v122, 16, v49
    v_and_b32 v123, s81, v49
    v_lshlrev_b32 v124, 16, v50
    v_and_b32 v125, s81, v50
    ds_read_b64_tr_b16 v[116:117], v22 offset:12288
    ds_read_b64_tr_b16 v[118:119], v22 offset:12800
    v_mfma_f32_32x32x16_bf16 v[80:95], v[24:27], a[68:71], v[80:95]
    v_lshlrev_b32 v126, 16, v51
    v_and_b32 v127, s81, v51
    v_fma_f32 v120, v120, v130, v128
    v_fma_f32 v121, v121, v130, v128
    v_fma_f32 v122, v122, v130, v128
    v_fma_f32 v123, v123, v130, v128
    ds_read_b64_tr_b16 v[24:25], v22 offset:6144
    ds_read_b64_tr_b16 v[26:27], v22 offset:6656
    s_waitcnt lgkmcnt(10)
    v_mfma_f32_32x32x16_bf16 v[96:111], v[52:55], a[68:71], v[96:111]
    v_fma_f32 v124, v124, v130, v128
    v_fma_f32 v125, v125, v130, v128
    v_fma_f32 v126, v126, v130, v128
    v_fma_f32 v127, v127, v130, v128
    v_cvt_pk_bf16_f32 v48, v120, v121
    v_cvt_pk_bf16_f32 v49, v122, v123
    ds_read_b64_tr_b16 v[52:53], v22 offset:14336
    ds_read_b64_tr_b16 v[54:55], v22 offset:14848
    s_waitcnt lgkmcnt(7)
    v_mfma_f32_32x32x16_bf16 v[80:95], v[112:115], a[72:75], v[80:95]
    s_mul_i32 s92, s74, 0x38000
    s_add_u32 m0, s87, 0xe000
    s_add_u32 s92, s92, s88
    buffer_load_dwordx4 v11, s[40:43], s92 offen lds
    v_cvt_pk_bf16_f32 v50, v124, v125
    v_cvt_pk_bf16_f32 v51, v126, v127
    ds_write_b128 v3, v[48:51]
    v_lshlrev_b32 v120, 16, v76
    v_add_u32 v23, 0x20000, v8
    ds_read_b64_tr_b16 v[112:113], v23
    ds_read_b64_tr_b16 v[114:115], v23 offset:512
    s_waitcnt lgkmcnt(7)
    v_mfma_f32_32x32x16_bf16 v[96:111], v[116:119], a[72:75], v[96:111]
    v_and_b32 v121, s81, v76
    v_lshlrev_b32 v122, 16, v77
    v_and_b32 v123, s81, v77
    v_lshlrev_b32 v124, 16, v78
    v_and_b32 v125, s81, v78
    v_lshlrev_b32 v126, 16, v79
    v_and_b32 v127, s81, v79
    ds_read_b64_tr_b16 v[116:117], v23 offset:8192
    ds_read_b64_tr_b16 v[118:119], v23 offset:8704
    s_waitcnt lgkmcnt(7)
    v_mfma_f32_32x32x16_bf16 v[80:95], v[24:27], a[76:79], v[80:95]
    v_fma_f32 v120, v120, v131, v129
    v_fma_f32 v121, v121, v131, v129
    v_fma_f32 v122, v122, v131, v129
    v_fma_f32 v123, v123, v131, v129
    v_fma_f32 v124, v124, v131, v129
    v_fma_f32 v125, v125, v131, v129
    ds_read_b64_tr_b16 v[24:25], v23 offset:2048
    ds_read_b64_tr_b16 v[26:27], v23 offset:2560
    s_waitcnt lgkmcnt(7)
    v_mfma_f32_32x32x16_bf16 v[96:111], v[52:55], a[76:79], v[96:111]
    v_fma_f32 v126, v126, v131, v129
    v_fma_f32 v127, v127, v131, v129
    v_cvt_pk_bf16_f32 v76, v120, v121
    v_cvt_pk_bf16_f32 v77, v122, v123
    v_cvt_pk_bf16_f32 v78, v124, v125
    v_cvt_pk_bf16_f32 v79, v126, v127
    ds_write_b128 v3, v[76:79] offset:128
    s_waitcnt vmcnt(2)
    s_waitcnt lgkmcnt(0)
    s_barrier
    ds_read_b64_tr_b16 v[52:53], v23 offset:10240
    ds_read_b64_tr_b16 v[54:55], v23 offset:10752
    v_mfma_f32_32x32x16_bf16 v[80:95], v[112:115], a[80:83], v[80:95]
    ds_read_b128 a[96:99], v4
    v_lshlrev_b32 v141, 6, v1
    s_cmp_lg_u32 s68, 0
    s_cbranch_scc1 L_pi_1003
    buffer_load_dword v142, v141, s[64:67], 0 offen sc1
L_pi_1003:
    ds_read_b64_tr_b16 v[112:113], v23 offset:4096
    ds_read_b64_tr_b16 v[114:115], v23 offset:4608
    v_mfma_f32_32x32x16_bf16 v[96:111], v[116:119], a[80:83], v[96:111]
    ds_read_b128 a[100:103], v5
    ds_read_b128 a[104:107], v6
    ds_read_b64_tr_b16 v[116:117], v23 offset:12288
    ds_read_b64_tr_b16 v[118:119], v23 offset:12800
    v_mfma_f32_32x32x16_bf16 v[80:95], v[24:27], a[84:87], v[80:95]
    ds_read_b128 a[108:111], v7
    v_lshrrev_b32 v20, 3, v1
    ds_read_b64_tr_b16 v[24:25], v23 offset:6144
    ds_read_b64_tr_b16 v[26:27], v23 offset:6656
    s_waitcnt lgkmcnt(10)
    v_mfma_f32_32x32x16_bf16 v[96:111], v[52:55], a[84:87], v[96:111]
    s_mul_i32 s92, s75, 0x38000
    s_add_u32 m0, s87, 0x10000
    s_add_u32 s92, s92, s88
    buffer_load_dwordx4 v10, s[36:39], s92 offen lds
    v_bfe_u32 v21, v20, 1, 1
    ds_read_b64_tr_b16 v[52:53], v23 offset:14336
    ds_read_b64_tr_b16 v[54:55], v23 offset:14848
    s_waitcnt lgkmcnt(9)
    v_mfma_f32_32x32x16_bf16 v[80:95], v[112:115], a[88:91], v[80:95]
    v_lshlrev_b32 v21, 2, v21
    v_and_b32 v18, 7, v1
    v_add_u32 v22, 0x24000, v8
    ds_read_b64_tr_b16 v[112:113], v22
    ds_read_b64_tr_b16 v[114:115], v22 offset:512
    s_waitcnt lgkmcnt(7)
    v_mfma_f32_32x32x16_bf16 v[96:111], v[116:119], a[88:91], v[96:111]
    s_mul_i32 s92, s75, 0x38000
    s_add_u32 m0, s87, 0x12000
    s_add_u32 s92, s92, s88
    buffer_load_dwordx4 v11, s[40:43], s92 offen lds
    v_xor_b32 v21, v21, v18
    s_lshl_b32 s93, s70, 3
    ds_read_b64_tr_b16 v[116:117], v22 offset:8192
    ds_read_b64_tr_b16 v[118:119], v22 offset:8704
    s_waitcnt lgkmcnt(6)
    v_mfma_f32_32x32x16_bf16 v[80:95], v[24:27], a[92:95], v[80:95]
    v_add_u32 v20, s93, v20
    v_mul_u32_u24 v20, 0x380, v20
    v_lshl_add_u32 v20, v21, 4, v20
    s_lshl_b32 s93, s98, 7
    v_add_u32 v9, s93, v20
    ds_read_b64_tr_b16 v[24:25], v22 offset:2048
    ds_read_b64_tr_b16 v[26:27], v22 offset:2560
    s_waitcnt lgkmcnt(6)
    v_mfma_f32_32x32x16_bf16 v[96:111], v[52:55], a[92:95], v[96:111]
    s_and_b32 s93, s97, 3
    s_add_u32 s93, s93, s98
    s_bitcmp1_b32 s93, 0
    s_cselect_b32 s8, 20, 0
    s_cselect_b32 s9, 0, 20
    s_cselect_b32 s24, 24, 4
    s_cselect_b32 s23, 4, 24
    s_bitcmp1_b32 s93, 1
    s_cselect_b32 s19, 16, 8
    s_cselect_b32 s22, 8, 16
    s_mov_b32 s25, 12
    s_and_b32 s94, s93, 1
    s_lshl_b32 s26, s94, 1
    s_xor_b32 s27, s26, 2
    s_barrier
    ds_read_b64_tr_b16 v[52:53], v22 offset:10240
    ds_read_b64_tr_b16 v[54:55], v22 offset:10752
    s_waitcnt lgkmcnt(6)
    v_mfma_f32_32x32x16_bf16 v[80:95], v[112:115], a[96:99], v[80:95]
    ds_read_b64_tr_b16 v[112:113], v22 offset:4096
    ds_read_b64_tr_b16 v[114:115], v22 offset:4608
    s_waitcnt lgkmcnt(6)
    v_mfma_f32_32x32x16_bf16 v[96:111], v[116:119], a[96:99], v[96:111]
    s_mul_i32 s92, s76, 0x38000
    s_add_u32 m0, s87, 0x14000
    s_add_u32 s92, s92, s88
    buffer_load_dwordx4 v10, s[36:39], s92 offen lds
    ds_read_b64_tr_b16 v[116:117], v22 offset:12288
    ds_read_b64_tr_b16 v[118:119], v22 offset:12800
    s_waitcnt lgkmcnt(6)
    v_mfma_f32_32x32x16_bf16 v[80:95], v[24:27], a[100:103], v[80:95]
    ds_read_b64_tr_b16 v[24:25], v22 offset:6144
    ds_read_b64_tr_b16 v[26:27], v22 offset:6656
    s_waitcnt lgkmcnt(6)
    v_mfma_f32_32x32x16_bf16 v[96:111], v[52:55], a[100:103], v[96:111]
    ds_read_b64_tr_b16 v[52:53], v22 offset:14336
    ds_read_b64_tr_b16 v[54:55], v22 offset:14848
    s_waitcnt lgkmcnt(6)
    v_mfma_f32_32x32x16_bf16 v[80:95], v[112:115], a[104:107], v[80:95]
    s_mul_i32 s92, s76, 0x38000
    s_add_u32 m0, s87, 0x16000
    s_add_u32 s92, s92, s88
    buffer_load_dwordx4 v11, s[40:43], s92 offen lds
    s_waitcnt lgkmcnt(4)
    v_mfma_f32_32x32x16_bf16 v[96:111], v[116:119], a[104:107], v[96:111]
    s_waitcnt lgkmcnt(2)
    v_mfma_f32_32x32x16_bf16 v[80:95], v[24:27], a[108:111], v[80:95]
    s_waitcnt lgkmcnt(0)
    v_mfma_f32_32x32x16_bf16 v[96:111], v[52:55], a[108:111], v[96:111]
    s_cmp_lg_u32 s68, 0
    s_cbranch_scc1 L_pc_1004
    s_waitcnt vmcnt(4)
    v_cmp_le_u32 vcc, 64, v142
    s_nop 0
    s_and_b32 s93, vcc_lo, 0xf
    s_cmp_eq_u32 s93, 15
    s_cbranch_scc1 L_poll_1005_done
    s_mov_b32 s100, 0x186a0
L_poll_1005:
    s_sleep 2
    buffer_load_dword v142, v141, s[64:67], 0 offen sc1
    s_waitcnt vmcnt(0)
    v_cmp_le_u32 vcc, 64, v142
    s_nop 0
    s_and_b32 s93, vcc_lo, 0xf
    s_cmp_eq_u32 s93, 15
    s_cbranch_scc1 L_poll_1005_done
    s_sub_u32 s100, s100, 1
    s_cmp_lg_u32 s100, 0
    s_cbranch_scc1 L_poll_1005
L_poll_1005_done:
L_pc_1004:
    s_waitcnt vmcnt(2)
    s_barrier
    s_nop 5
    v_cvt_pk_bf16_f32 v72, v80, v81
    v_cvt_pk_bf16_f32 v73, v82, v83
    v_cvt_pk_bf16_f32 v74, v84, v85
    v_cvt_pk_bf16_f32 v75, v86, v87
    v_cvt_pk_bf16_f32 v76, v88, v89
    v_cvt_pk_bf16_f32 v77, v90, v91
    v_cvt_pk_bf16_f32 v78, v92, v93
    v_cvt_pk_bf16_f32 v79, v94, v95
    v_mfma_f32_32x32x16_bf16 v[112:127], v[132:135], v[72:75], 0
    s_nop 0
    v_mfma_f32_32x32x16_bf16 v[112:127], v[136:139], v[76:79], v[112:127]
    v_bfi_b32 v108, v16, v108, 1.0
    v_cvt_pk_bf16_f32 v96, v96, v97
    v_cvt_pk_bf16_f32 v97, v98, v99
    v_cvt_pk_bf16_f32 v98, v100, v101
    v_cvt_pk_bf16_f32 v99, v102, v103
    v_cvt_pk_bf16_f32 v100, v104, v105
    v_cvt_pk_bf16_f32 v101, v106, v107
    v_cvt_pk_bf16_f32 v102, v108, v109
    v_cvt_pk_bf16_f32 v103, v110, v111
    v_and_b32 v20, 31, v1
    v_bfe_u32 v21, v1, 1, 3
    v_lshrrev_b32 v22, 5, v1
    v_xor_b32 v21, v21, v22
    v_lshlrev_b32 v21, 3, v21
    v_lshl_add_u32 v21, v20, 6, v21
    s_lshl_b32 s14, s70, 13
    s_lshl_b32 s15, s69, 11
    s_add_u32 s14, s14, s15
    s_add_u32 s14, s14, 0x8000
    v_add_u32 v21, s14, v21
    ds_write_b64 v21, v[96:97]
    v_xor_b32 v23, 16, v21
    ds_write_b64 v23, v[98:99]
    v_xor_b32 v23, 32, v21
    s_mul_i32 s92, s77, 0x38000
    s_add_u32 m0, s87, 0x18000
    s_add_u32 s92, s92, s88
    buffer_load_dwordx4 v10, s[36:39], s92 offen lds
    ds_write_b64 v23, v[100:101]
    v_xor_b32 v23, 48, v21
    ds_write_b64 v23, v[102:103]
    v_max3_f32 v128, v112, v113, v114
    v_min3_f32 v129, v112, v113, v114
    v_max3_f32 v128, v128, v115, v116
    v_min3_f32 v129, v129, v115, v116
    v_max3_f32 v128, v128, v117, v118
    v_min3_f32 v129, v129, v117, v118
    v_max3_f32 v128, v128, v119, v120
    v_min3_f32 v129, v129, v119, v120
    v_max3_f32 v128, v128, v121, v122
    v_min3_f32 v129, v129, v121, v122
    v_max3_f32 v128, v128, v123, v124
    v_min3_f32 v129, v129, v123, v124
    v_max3_f32 v128, v128, v125, v126
    v_min3_f32 v129, v129, v125, v126
    v_max_f32 v128, v128, v127
    v_min_f32 v129, v129, v127
    v_mov_b32 v130, v128
    v_mov_b32 v131, v129
    s_nop 0
    v_permlane32_swap_b32 v128, v130
    v_permlane32_swap_b32 v129, v131
    v_max_f32 v128, v128, v130
    v_min_f32 v129, v129, v131
    v_sub_f32 v80, v129, v112
    v_sub_f32 v112, v112, v128
    v_sub_f32 v81, v129, v113
    v_sub_f32 v113, v113, v128
    v_sub_f32 v82, v129, v114
    v_sub_f32 v114, v114, v128
    v_sub_f32 v83, v129, v115
    v_sub_f32 v115, v115, v128
    v_exp_f32 v80, v80
    v_exp_f32 v112, v112
    v_exp_f32 v81, v81
    v_exp_f32 v113, v113
    v_exp_f32 v82, v82
    v_exp_f32 v114, v114
    v_exp_f32 v83, v83
    v_exp_f32 v115, v115
    v_sub_f32 v84, v129, v116
    v_sub_f32 v116, v116, v128
    v_sub_f32 v85, v129, v117
    v_sub_f32 v117, v117, v128
    v_sub_f32 v86, v129, v118
    v_sub_f32 v118, v118, v128
    v_sub_f32 v87, v129, v119
    v_sub_f32 v119, v119, v128
    v_exp_f32 v84, v84
    v_exp_f32 v116, v116
    v_exp_f32 v85, v85
    v_exp_f32 v117, v117
    v_exp_f32 v86, v86
    s_mul_i32 s92, s77, 0x38000
    s_add_u32 m0, s87, 0x1a000
    s_add_u32 s92, s92, s88
    buffer_load_dwordx4 v11, s[40:43], s92 offen lds
    v_exp_f32 v118, v118
    v_exp_f32 v87, v87
    v_exp_f32 v119, v119
    v_sub_f32 v88, v129, v120
    v_sub_f32 v120, v120, v128
    v_sub_f32 v89, v129, v121
    v_sub_f32 v121, v121, v128
    v_sub_f32 v90, v129, v122
    v_sub_f32 v122, v122, v128
    v_sub_f32 v91, v129, v123
    v_sub_f32 v123, v123, v128
    v_exp_f32 v88, v88
    v_exp_f32 v120, v120
    v_exp_f32 v89, v89
    v_exp_f32 v121, v121
    v_exp_f32 v90, v90
    v_exp_f32 v122, v122
    v_exp_f32 v91, v91
    v_exp_f32 v123, v123
    v_sub_f32 v92, v129, v124
    v_sub_f32 v124, v124, v128
    v_sub_f32 v93, v129, v125
    v_sub_f32 v125, v125, v128
    v_sub_f32 v94, v129, v126
    v_sub_f32 v126, v126, v128
    v_sub_f32 v95, v129, v127
    v_sub_f32 v127, v127, v128
    v_exp_f32 v92, v92
    v_exp_f32 v124, v124
    v_exp_f32 v93, v93
    v_exp_f32 v125, v125
    v_exp_f32 v94, v94
    v_exp_f32 v126, v126
    v_exp_f32 v95, v95
    v_exp_f32 v127, v127
    v_add_f32 v140, v92, v93
    v_add_f32 v141, v124, v125
    v_add_f32 v130, v94, v95
    v_add_f32 v131, v126, v127
    v_add_f32 v140, v140, v130
    v_add_f32 v141, v141, v131
    v_add_f32 v130, v81, v82
    v_add_f32 v131, v113, v114
    v_fma_f32 v140, v140, v17, v80
    v_fma_f32 v141, v141, v17, v112
    v_add_f32 v130, v130, v84
    v_add_f32 v131, v131, v116
    v_add_f32 v140, v140, v83
    s_mul_i32 s92, s78, 0x38000
    s_add_u32 m0, s87, 0x1c000
    s_add_u32 s92, s92, s88
    buffer_load_dwordx4 v10, s[36:39], s92 offen lds
    v_add_f32 v141, v141, v115
    v_add_f32 v130, v130, v86
    v_add_f32 v131, v131, v118
    v_add_f32 v140, v140, v85
    v_add_f32 v141, v141, v117
    v_add_f32 v130, v130, v88
    v_add_f32 v131, v131, v120
    v_add_f32 v140, v140, v87
    v_add_f32 v141, v141, v119
    v_add_f32 v130, v130, v90
    v_add_f32 v131, v131, v122
    v_add_f32 v140, v140, v89
    v_add_f32 v141, v141, v121
    v_add_f32 v140, v140, v91
    v_add_f32 v141, v141, v123
    v_add_f32 v140, v140, v130
    v_add_f32 v141, v141, v131
    v_mov_b32 v130, v140
    v_mov_b32 v131, v141
    s_nop 0
    v_permlane32_swap_b32 v140, v130
    v_permlane32_swap_b32 v141, v131
    v_add_f32 v140, v140, v130
    v_add_f32 v141, v141, v131
    v_rcp_f32 v140, v140
    v_rcp_f32 v141, v141
    s_nop 0
    v_mul_f32 v142, v140, v17
    v_mul_f32 v143, v141, v17
    v_mul_f32 v80, v80, v140
    v_mul_f32 v112, v112, v141
    v_mul_f32 v81, v81, v140
    v_mul_f32 v113, v113, v141
    v_mul_f32 v82, v82, v140
    v_mul_f32 v114, v114, v141
    v_mul_f32 v83, v83, v140
    v_mul_f32 v115, v115, v141
    v_mul_f32 v84, v84, v140
    v_mul_f32 v116, v116, v141
    v_mul_f32 v85, v85, v140
    v_mul_f32 v117, v117, v141
    v_mul_f32 v86, v86, v140
    v_mul_f32 v118, v118, v141
    v_mul_f32 v87, v87, v140
    v_mul_f32 v119, v119, v141
    v_mul_f32 v88, v88, v140
    v_mul_f32 v120, v120, v141
    v_mul_f32 v89, v89, v140
    v_mul_f32 v121, v121, v141
    v_mul_f32 v90, v90, v140
    v_mul_f32 v122, v122, v141
    v_mul_f32 v91, v91, v140
    v_mul_f32 v123, v123, v141
    v_mul_f32 v92, v92, v142
    v_mul_f32 v124, v124, v143
    v_mul_f32 v93, v93, v142
    v_mul_f32 v125, v125, v143
    v_mul_f32 v94, v94, v142
    v_mul_f32 v126, v126, v143
    v_mul_f32 v95, v95, v142
    v_mul_f32 v127, v127, v143
    v_and_b32 v20, 31, v1
    v_and_b32 v21, 15, v1
    v_lshrrev_b32 v22, 5, v1
    v_xor_b32 v21, v21, v22
    v_lshlrev_b32 v21, 3, v21
    v_lshl_add_u32 v21, v20, 7, v21
    s_mul_i32 s92, s78, 0x38000
    s_add_u32 m0, s87, 0x1e000
    s_add_u32 s92, s92, s88
    buffer_load_dwordx4 v11, s[40:43], s92 offen lds
    s_lshl_b32 s14, s70, 14
    s_lshl_b32 s15, s69, 12
    s_add_u32 s14, s14, s15
    v_add_u32 v21, s14, v21
    v_cvt_pk_bf16_f32 v96, v80, v81
    v_cvt_pk_bf16_f32 v97, v82, v83
    v_cvt_pk_bf16_f32 v98, v84, v85
    v_cvt_pk_bf16_f32 v99, v86, v87
    v_cvt_pk_bf16_f32 v100, v88, v89
    v_cvt_pk_bf16_f32 v101, v90, v91
    v_cvt_pk_bf16_f32 v102, v92, v93
    v_cvt_pk_bf16_f32 v103, v94, v95
    v_cvt_pk_bf16_f32 v104, v112, v113
    v_cvt_pk_bf16_f32 v105, v114, v115
    v_cvt_pk_bf16_f32 v106, v116, v117
    v_cvt_pk_bf16_f32 v107, v118, v119
    v_cvt_pk_bf16_f32 v108, v120, v121
    v_cvt_pk_bf16_f32 v109, v122, v123
    v_cvt_pk_bf16_f32 v110, v124, v125
    v_cvt_pk_bf16_f32 v111, v126, v127
    ds_write_b64 v21, v[96:97]
    v_xor_b32 v23, 16, v21
    ds_write_b64 v23, v[98:99]
    v_xor_b32 v23, 32, v21
    ds_write_b64 v23, v[100:101]
    v_xor_b32 v23, 48, v21
    ds_write_b64 v23, v[102:103]
    v_xor_b32 v23, 64, v21
    ds_write_b64 v23, v[104:105]
    v_xor_b32 v23, 0x50, v21
    ds_write_b64 v23, v[106:107]
    v_xor_b32 v23, 0x60, v21
    ds_write_b64 v23, v[108:109]
    v_xor_b32 v23, 0x70, v21
    ds_write_b64 v23, v[110:111]
    s_waitcnt lgkmcnt(0)
    s_barrier
    v_lshrrev_b32 v141, 4, v1
    v_bfe_u32 v142, v1, 2, 2
    v_and_b32 v143, 3, v1
    v_lshl_add_u32 v131, v141, 2, v142
    s_lshl_b32 s93, s69, 2
    v_add_u32 v140, s93, v143
    v_xor_b32 v140, v140, v131
    v_lshlrev_b32 v140, 3, v140
    v_lshl_add_u32 v140, v131, 7, v140
    s_lshl_b32 s94, s70, 14
    v_add_u32 v128, s94, v140
    v_lshrrev_b32 v140, 1, v131
    v_xor_b32 v140, v140, v143
    v_lshlrev_b32 v140, 3, v140
    v_lshl_add_u32 v140, v131, 6, v140
    s_lshl_b32 s94, s70, 13
    s_add_u32 s94, s94, 0x8000
    v_add_u32 v129, s94, v140
    v_xor_b32 v130, 32, v129
    ds_read_b64_tr_b16 v[88:89], v128
    ds_read_b64_tr_b16 v[90:91], v128 offset:2048
    ds_read_b64_tr_b16 v[112:113], v129
    ds_read_b64_tr_b16 v[114:115], v129 offset:1024
    ds_read_b64_tr_b16 v[116:117], v130
    ds_read_b64_tr_b16 v[118:119], v130 offset:1024
    ds_read_b64_tr_b16 v[92:93], v128 offset:4096
    ds_read_b64_tr_b16 v[94:95], v128 offset:6144
    ds_read_b64_tr_b16 v[120:121], v129 offset:2048
    ds_read_b64_tr_b16 v[122:123], v129 offset:3072
    ds_read_b64_tr_b16 v[124:125], v130 offset:2048
    ds_read_b64_tr_b16 v[126:127], v130 offset:3072
    s_waitcnt lgkmcnt(8)
    v_mfma_f32_16x16x32_bf16 v[80:83], v[88:91], v[112:115], 0
    s_waitcnt lgkmcnt(6)
    v_mfma_f32_16x16x32_bf16 v[84:87], v[88:91], v[116:119], 0
    ds_read_b64_tr_b16 v[88:89], v128 offset:8192
    ds_read_b64_tr_b16 v[90:91], v128 offset:10240
    ds_read_b64_tr_b16 v[112:113], v129 offset:4096
    ds_read_b64_tr_b16 v[114:115], v129 offset:5120
    ds_read_b64_tr_b16 v[116:117], v130 offset:4096
    ds_read_b64_tr_b16 v[118:119], v130 offset:5120
    s_waitcnt lgkmcnt(8)
    v_mfma_f32_16x16x32_bf16 v[80:83], v[92:95], v[120:123], v[80:83]
    s_waitcnt lgkmcnt(6)
    v_mfma_f32_16x16x32_bf16 v[84:87], v[92:95], v[124:127], v[84:87]
    ds_read_b64_tr_b16 v[92:93], v128 offset:12288
    ds_read_b64_tr_b16 v[94:95], v128 offset:14336
    ds_read_b64_tr_b16 v[120:121], v129 offset:6144
    ds_read_b64_tr_b16 v[122:123], v129 offset:7168
    ds_read_b64_tr_b16 v[124:125], v130 offset:6144
    ds_read_b64_tr_b16 v[126:127], v130 offset:7168
    s_waitcnt lgkmcnt(8)
    v_mfma_f32_16x16x32_bf16 v[80:83], v[88:91], v[112:115], v[80:83]
    s_waitcnt lgkmcnt(6)
    v_mfma_f32_16x16x32_bf16 v[84:87], v[88:91], v[116:119], v[84:87]
    s_waitcnt lgkmcnt(2)
    v_mfma_f32_16x16x32_bf16 v[80:83], v[92:95], v[120:123], v[80:83]
    s_waitcnt lgkmcnt(0)
    v_mfma_f32_16x16x32_bf16 v[84:87], v[92:95], v[124:127], v[84:87]
    s_lshl_b32 s93, s72, 1
    s_add_u32 s93, s93, s70
    s_lshl_b32 s93, s93, 13
    s_lshl_b32 s94, s69, 11
    s_add_u32 s93, s93, s94
    s_add_u32 s95, s93, 0x900000
    buffer_atomic_add_f32 v80, v19, s[60:63], s95 offen
    buffer_atomic_add_f32 v81, v19, s[60:63], s95 offen offset:256
    buffer_atomic_add_f32 v82, v19, s[60:63], s95 offen offset:512
    buffer_atomic_add_f32 v83, v19, s[60:63], s95 offen offset:768
    buffer_atomic_add_f32 v84, v19, s[60:63], s95 offen offset:1024
    buffer_atomic_add_f32 v85, v19, s[60:63], s95 offen offset:1280
    buffer_atomic_add_f32 v86, v19, s[60:63], s95 offen offset:1536
    buffer_atomic_add_f32 v87, v19, s[60:63], s95 offen offset:1792
    v_add_u32 v4, 0xc000, v12
    ds_read_b64_tr_b16 v[56:57], v4
    ds_read_b64_tr_b16 v[58:59], v4 offset:512
    v_add_u32 v6, 0xc000, v13
    ds_read_b64_tr_b16 v[60:61], v6
    ds_read_b64_tr_b16 v[62:63], v6 offset:512
    ds_read_b64_tr_b16 v[64:65], v4 offset:2048
    ds_read_b64_tr_b16 v[66:67], v4 offset:2560
    ds_read_b64_tr_b16 v[68:69], v6 offset:2048
    ds_read_b64_tr_b16 v[70:71], v6 offset:2560
    s_waitcnt lgkmcnt(6)
    v_mfma_f32_32x32x16_bf16 v[24:39], v[56:59], a[0:3], 0
    ds_read_b64_tr_b16 v[56:57], v4 offset:4096
    ds_read_b64_tr_b16 v[58:59], v4 offset:4608
    s_waitcnt lgkmcnt(6)
    v_mfma_f32_32x32x16_bf16 v[40:55], v[60:63], a[0:3], 0
    s_mul_i32 s92, s79, 0x38000
    s_add_u32 m0, s87, 0x20000
    s_add_u32 s92, s92, s88
    buffer_load_dwordx4 v10, s[36:39], s92 offen lds
    ds_read_b64_tr_b16 v[60:61], v6 offset:4096
    ds_read_b64_tr_b16 v[62:63], v6 offset:4608
    s_waitcnt lgkmcnt(6)
    v_mfma_f32_32x32x16_bf16 v[24:39], v[64:67], a[4:7], v[24:39]
    ds_read_b64_tr_b16 v[64:65], v4 offset:6144
    ds_read_b64_tr_b16 v[66:67], v4 offset:6656
    s_waitcnt lgkmcnt(6)
    v_mfma_f32_32x32x16_bf16 v[40:55], v[68:71], a[4:7], v[40:55]
    ds_read_b64_tr_b16 v[68:69], v6 offset:6144
    ds_read_b64_tr_b16 v[70:71], v6 offset:6656
    s_waitcnt lgkmcnt(6)
    v_mfma_f32_32x32x16_bf16 v[24:39], v[56:59], a[8:11], v[24:39]
    s_mul_i32 s92, s79, 0x38000
    s_add_u32 m0, s87, 0x22000
    s_add_u32 s92, s92, s88
    buffer_load_dwordx4 v11, s[40:43], s92 offen lds
    v_add_u32 v5, 0x10000, v12
    ds_read_b64_tr_b16 v[56:57], v5
    ds_read_b64_tr_b16 v[58:59], v5 offset:512
    s_waitcnt lgkmcnt(6)
    v_mfma_f32_32x32x16_bf16 v[40:55], v[60:63], a[8:11], v[40:55]
    v_add_u32 v7, 0x10000, v13
    ds_read_b64_tr_b16 v[60:61], v7
    ds_read_b64_tr_b16 v[62:63], v7 offset:512
    s_waitcnt lgkmcnt(6)
    v_mfma_f32_32x32x16_bf16 v[24:39], v[64:67], a[12:15], v[24:39]
    ds_read_b64_tr_b16 v[64:65], v5 offset:2048
    ds_read_b64_tr_b16 v[66:67], v5 offset:2560
    s_waitcnt lgkmcnt(6)
    v_mfma_f32_32x32x16_bf16 v[40:55], v[68:71], a[12:15], v[40:55]
    s_waitcnt vmcnt(14)
    s_barrier
    ds_read_b64_tr_b16 v[68:69], v7 offset:2048
    ds_read_b64_tr_b16 v[70:71], v7 offset:2560
    s_waitcnt lgkmcnt(6)
    v_mfma_f32_32x32x16_bf16 v[24:39], v[56:59], a[16:19], v[24:39]
    s_mul_i32 s92, s80, 0x38000
    s_add_u32 m0, s87, 0x24000
    s_add_u32 s92, s92, s88
    buffer_load_dwordx4 v10, s[36:39], s92 offen lds
    ds_read_b64_tr_b16 v[56:57], v5 offset:4096
    ds_read_b64_tr_b16 v[58:59], v5 offset:4608
    s_waitcnt lgkmcnt(6)
    v_mfma_f32_32x32x16_bf16 v[40:55], v[60:63], a[16:19], v[40:55]
    s_mul_i32 s92, s80, 0x38000
    s_add_u32 m0, s87, 0x26000
    s_add_u32 s92, s92, s88
    buffer_load_dwordx4 v11, s[40:43], s92 offen lds
    ds_read_b64_tr_b16 v[60:61], v7 offset:4096
    ds_read_b64_tr_b16 v[62:63], v7 offset:4608
    s_waitcnt lgkmcnt(6)
    v_mfma_f32_32x32x16_bf16 v[24:39], v[64:67], a[20:23], v[24:39]
    ds_read_b64_tr_b16 v[64:65], v5 offset:6144
    ds_read_b64_tr_b16 v[66:67], v5 offset:6656
    s_waitcnt lgkmcnt(6)
    v_mfma_f32_32x32x16_bf16 v[40:55], v[68:71], a[20:23], v[40:55]
    s_mul_i32 s92, s74, 0x38000
    s_add_u32 m0, s87, 0xc000
    s_add_u32 s92, s92, s89
    buffer_load_dwordx4 v14, s[4:7], s92 offen lds
    ds_read_b64_tr_b16 v[68:69], v7 offset:6144
    ds_read_b64_tr_b16 v[70:71], v7 offset:6656
    s_waitcnt lgkmcnt(6)
    v_mfma_f32_32x32x16_bf16 v[24:39], v[56:59], a[24:27], v[24:39]
    s_mul_i32 s92, s8, 0x3800
    s_mov_b32 m0, s99
    s_add_u32 s92, s92, s85
    buffer_load_dwordx4 v9, s[44:47], s92 offen lds
    v_add_u32 v4, 0x14000, v12
    ds_read_b64_tr_b16 v[56:57], v4
    ds_read_b64_tr_b16 v[58:59], v4 offset:512
    s_waitcnt lgkmcnt(6)
    v_mfma_f32_32x32x16_bf16 v[40:55], v[60:63], a[24:27], v[40:55]
    s_mul_i32 s92, s8, 0x3800
    s_add_u32 s92, s92, s85
    s_add_u32 m0, s99, 0x2000
    s_add_u32 s92, s92, 0x3800
    buffer_load_dwordx4 v9, s[44:47], s92 offen lds
    v_add_u32 v6, 0x14000, v13
    ds_read_b64_tr_b16 v[60:61], v6
    ds_read_b64_tr_b16 v[62:63], v6 offset:512
    s_waitcnt lgkmcnt(6)
    v_mfma_f32_32x32x16_bf16 v[24:39], v[64:67], a[28:31], v[24:39]
    ds_read_b64_tr_b16 v[64:65], v4 offset:2048
    ds_read_b64_tr_b16 v[66:67], v4 offset:2560
    s_waitcnt lgkmcnt(6)
    v_mfma_f32_32x32x16_bf16 v[40:55], v[68:71], a[28:31], v[40:55]
    s_waitcnt vmcnt(17)
    s_waitcnt vmcnt(7)
    s_barrier
    ds_read_b64_tr_b16 v[68:69], v6 offset:2048
    ds_read_b64_tr_b16 v[70:71], v6 offset:2560
    s_waitcnt lgkmcnt(6)
    v_mfma_f32_32x32x16_bf16 v[24:39], v[56:59], a[32:35], v[24:39]
    s_lshr_b32 s93, s97, 1
    s_lshl_b32 s93, s93, 2
    s_and_b32 s94, s97, 1
    s_lshl_b32 s94, s94, 1
    s_add_u32 s93, s93, s94
    s_add_u32 s93, s93, s70
    s_mul_i32 s10, s93, 0x1c000
    s_mul_i32 s94, s69, 0x7000
    s_add_u32 s10, s10, s94
    s_lshl_b32 s11, s93, 15
    s_lshl_b32 s94, s69, 13
    s_add_u32 s11, s11, s94
    s_add_u32 s11, s11, 0x700000
    s_lshr_b32 s93, s97, 1
    s_lshl_b32 s93, s93, 13
    s_add_u32 s13, s93, 0x930000
    v_and_b32 v142, 15, v1
    v_lshlrev_b32 v142, 9, v142
    ds_read_b64_tr_b16 v[56:57], v4 offset:4096
    ds_read_b64_tr_b16 v[58:59], v4 offset:4608
    s_waitcnt lgkmcnt(6)
    v_mfma_f32_32x32x16_bf16 v[40:55], v[60:63], a[32:35], v[40:55]
    ds_read_b64_tr_b16 v[60:61], v6 offset:4096
    ds_read_b64_tr_b16 v[62:63], v6 offset:4608
    s_waitcnt lgkmcnt(6)
    v_mfma_f32_32x32x16_bf16 v[24:39], v[64:67], a[36:39], v[24:39]
    s_cmp_lg_u32 s68, 0
    s_cbranch_scc1 L_sig_1006
    v_mov_b32 v20, 1
    v_mov_b32 v21, 0
    s_add_u32 s93, s16, 0
    s_mov_b64 exec, 1
    buffer_store_dword v20, v21, s[60:63], s93 offen sc1
    s_mov_b64 exec, -1
L_sig_1006:
    ds_read_b64_tr_b16 v[64:65], v4 offset:6144
    ds_read_b64_tr_b16 v[66:67], v4 offset:6656
    s_waitcnt lgkmcnt(6)
    v_mfma_f32_32x32x16_bf16 v[40:55], v[68:71], a[36:39], v[40:55]
    s_mul_i32 s92, s75, 0x38000
    s_add_u32 m0, s87, 0x10000
    s_add_u32 s92, s92, s89
    buffer_load_dwordx4 v14, s[4:7], s92 offen lds
    ds_read_b64_tr_b16 v[68:69], v6 offset:6144
    ds_read_b64_tr_b16 v[70:71], v6 offset:6656
    s_waitcnt lgkmcnt(6)
    v_mfma_f32_32x32x16_bf16 v[24:39], v[56:59], a[40:43], v[24:39]
    s_mul_i32 s92, s8, 0x3800
    s_add_u32 s92, s92, s85
    s_add_u32 m0, s99, 0x4000
    s_add_u32 s92, s92, 0x7000
    buffer_load_dwordx4 v9, s[44:47], s92 offen lds
    v_add_u32 v5, 0x18000, v12
    ds_read_b64_tr_b16 v[56:57], v5
    ds_read_b64_tr_b16 v[58:59], v5 offset:512
    s_waitcnt lgkmcnt(6)
    v_mfma_f32_32x32x16_bf16 v[40:55], v[60:63], a[40:43], v[40:55]
    v_bfe_u32 v20, v1, 2, 2
    v_lshrrev_b32 v21, 5, v1
    v_lshl_add_u32 v21, v21, 2, v20
    v_lshrrev_b32 v20, 1, v20
    v_lshlrev_b32 v20, 6, v20
    v_lshl_add_u32 v20, v21, 7, v20
    v_bfe_u32 v21, v1, 4, 1
    v_lshl_add_u32 v20, v21, 5, v20
    v_and_b32 v21, 3, v1
    v_lshl_add_u32 v20, v21, 3, v20
    s_lshl_b32 s93, s69, 11
    v_add_u32 v128, s93, v20
    v_add_u32 v7, 0x18000, v13
    ds_read_b64_tr_b16 v[60:61], v7
    ds_read_b64_tr_b16 v[62:63], v7 offset:512
    s_waitcnt lgkmcnt(6)
    v_mfma_f32_32x32x16_bf16 v[24:39], v[64:67], a[44:47], v[24:39]
    ds_read_b64_tr_b16 v[64:65], v5 offset:2048
    ds_read_b64_tr_b16 v[66:67], v5 offset:2560
    s_waitcnt lgkmcnt(6)
    v_mfma_f32_32x32x16_bf16 v[40:55], v[68:71], a[44:47], v[40:55]
    s_mul_i32 s92, s8, 0x3800
    s_add_u32 s92, s92, s85
    s_add_u32 m0, s99, 0x6000
    s_add_u32 s92, s92, 0xa800
    buffer_load_dwordx4 v9, s[44:47], s92 offen lds
    s_barrier
    ds_read_b64_tr_b16 v[68:69], v7 offset:2048
    ds_read_b64_tr_b16 v[70:71], v7 offset:2560
    s_waitcnt lgkmcnt(6)
    v_mfma_f32_32x32x16_bf16 v[24:39], v[56:59], a[48:51], v[24:39]
    v_xor_b32 v129, 64, v128
    s_mul_i32 s92, s76, 0x38000
    s_add_u32 m0, s87, 0x14000
    s_add_u32 s92, s92, s89
    buffer_load_dwordx4 v14, s[4:7], s92 offen lds
    ds_read_b64_tr_b16 v[56:57], v5 offset:4096
    ds_read_b64_tr_b16 v[58:59], v5 offset:4608
    s_waitcnt lgkmcnt(6)
    v_mfma_f32_32x32x16_bf16 v[40:55], v[60:63], a[48:51], v[40:55]
    v_add_u32 v130, 0x10000, v128
    ds_read_b64_tr_b16 v[60:61], v7 offset:4096
    ds_read_b64_tr_b16 v[62:63], v7 offset:4608
    s_waitcnt lgkmcnt(6)
    v_mfma_f32_32x32x16_bf16 v[24:39], v[64:67], a[52:55], v[24:39]
    v_add_u32 v131, 0x10000, v129
    v_add_u32 v140, 0x20000, v128
    ds_read_b64_tr_b16 v[64:65], v5 offset:6144
    ds_read_b64_tr_b16 v[66:67], v5 offset:6656
    s_waitcnt lgkmcnt(6)
    v_mfma_f32_32x32x16_bf16 v[40:55], v[68:71], a[52:55], v[40:55]
    s_mul_i32 s92, s9, 0x3800
    s_add_u32 m0, s99, 0x8000
    s_add_u32 s92, s92, s85
    buffer_load_dwordx4 v9, s[44:47], s92 offen lds
    v_add_u32 v141, 0x20000, v129
    ds_read_b64_tr_b16 v[68:69], v7 offset:6144
    ds_read_b64_tr_b16 v[70:71], v7 offset:6656
    s_waitcnt lgkmcnt(6)
    v_mfma_f32_32x32x16_bf16 v[24:39], v[56:59], a[56:59], v[24:39]
    v_add_u32 v4, 0x1c000, v12
    ds_read_b64_tr_b16 v[56:57], v4
    ds_read_b64_tr_b16 v[58:59], v4 offset:512
    s_waitcnt lgkmcnt(6)
    v_mfma_f32_32x32x16_bf16 v[40:55], v[60:63], a[56:59], v[40:55]
    v_lshrrev_b32 v20, 3, v1
    s_lshl_b32 s93, s97, 6
    s_lshl_b32 s94, s70, 5
    s_add_u32 s93, s93, s94
    s_lshl_b32 s94, s69, 3
    s_add_u32 s93, s93, s94
    v_add_u32 v20, s93, v20
    v_mul_u32_u24 v20, 0x380, v20
    v_and_b32 v21, 7, v1
    v_lshl_add_u32 v20, v21, 4, v20
    s_lshl_b32 s93, s98, 7
    v_add_u32 v8, s93, v20
    v_add_u32 v6, 0x1c000, v13
    ds_read_b64_tr_b16 v[60:61], v6
    ds_read_b64_tr_b16 v[62:63], v6 offset:512
    s_waitcnt lgkmcnt(6)
    v_mfma_f32_32x32x16_bf16 v[24:39], v[64:67], a[60:63], v[24:39]
    ds_read_b64_tr_b16 v[64:65], v4 offset:2048
    ds_read_b64_tr_b16 v[66:67], v4 offset:2560
    s_waitcnt lgkmcnt(6)
    v_mfma_f32_32x32x16_bf16 v[40:55], v[68:71], a[60:63], v[40:55]
    s_mul_i32 s92, s9, 0x3800
    s_add_u32 s92, s92, s85
    s_add_u32 m0, s99, 0xa000
    s_add_u32 s92, s92, 0x3800
    buffer_load_dwordx4 v9, s[44:47], s92 offen lds
    s_waitcnt vmcnt(11)
    s_barrier
    ds_read_b64_tr_b16 v[68:69], v6 offset:2048
    ds_read_b64_tr_b16 v[70:71], v6 offset:2560
    s_waitcnt lgkmcnt(6)
    v_mfma_f32_32x32x16_bf16 v[24:39], v[56:59], a[64:67], v[24:39]
    s_mul_i32 s92, s77, 0x38000
    s_add_u32 m0, s87, 0x18000
    s_add_u32 s92, s92, s89
    buffer_load_dwordx4 v14, s[4:7], s92 offen lds
    ds_read_b64_tr_b16 v[56:57], v4 offset:4096
    ds_read_b64_tr_b16 v[58:59], v4 offset:4608
    s_waitcnt lgkmcnt(6)
    v_mfma_f32_32x32x16_bf16 v[40:55], v[60:63], a[64:67], v[40:55]
    ds_read_b64_tr_b16 v[60:61], v6 offset:4096
    ds_read_b64_tr_b16 v[62:63], v6 offset:4608
    s_waitcnt lgkmcnt(6)
    v_mfma_f32_32x32x16_bf16 v[24:39], v[64:67], a[68:71], v[24:39]
    s_mul_i32 s92, s9, 0x3800
    s_add_u32 s92, s92, s85
    s_add_u32 m0, s99, 0xe000
    s_add_u32 s92, s92, 0x7000
    buffer_load_dwordx4 v9, s[44:47], s92 offen lds
    ds_read_b64_tr_b16 v[64:65], v4 offset:6144
    ds_read_b64_tr_b16 v[66:67], v4 offset:6656
    s_waitcnt lgkmcnt(6)
    v_mfma_f32_32x32x16_bf16 v[40:55], v[68:71], a[68:71], v[40:55]
    ds_read_b64_tr_b16 v[68:69], v6 offset:6144
    ds_read_b64_tr_b16 v[70:71], v6 offset:6656
    s_waitcnt lgkmcnt(6)
    v_mfma_f32_32x32x16_bf16 v[24:39], v[56:59], a[72:75], v[24:39]
    v_add_u32 v5, 0x20000, v12
    ds_read_b64_tr_b16 v[56:57], v5
    ds_read_b64_tr_b16 v[58:59], v5 offset:512
    s_waitcnt lgkmcnt(6)
    v_mfma_f32_32x32x16_bf16 v[40:55], v[60:63], a[72:75], v[40:55]
    s_mul_i32 s92, s9, 0x3800
    s_add_u32 s92, s92, s85
    s_add_u32 m0, s99, 0x12000
    s_add_u32 s92, s92, 0xa800
    buffer_load_dwordx4 v9, s[44:47], s92 offen lds
    v_add_u32 v7, 0x20000, v13
    ds_read_b64_tr_b16 v[60:61], v7
    ds_read_b64_tr_b16 v[62:63], v7 offset:512
    s_waitcnt lgkmcnt(6)
    v_mfma_f32_32x32x16_bf16 v[24:39], v[64:67], a[76:79], v[24:39]
    ds_read_b64_tr_b16 v[64:65], v5 offset:2048
    ds_read_b64_tr_b16 v[66:67], v5 offset:2560
    s_waitcnt lgkmcnt(6)
    v_mfma_f32_32x32x16_bf16 v[40:55], v[68:71], a[76:79], v[40:55]
    s_waitcnt vmcnt(12)
    s_barrier
    ds_read_b64_tr_b16 v[68:69], v7 offset:2048
    ds_read_b64_tr_b16 v[70:71], v7 offset:2560
    s_waitcnt lgkmcnt(6)
    v_mfma_f32_32x32x16_bf16 v[24:39], v[56:59], a[80:83], v[24:39]
    s_mul_i32 s92, s78, 0x38000
    s_add_u32 m0, s87, 0x1c000
    s_add_u32 s92, s92, s89
    buffer_load_dwordx4 v14, s[4:7], s92 offen lds
    ds_read_b64_tr_b16 v[56:57], v5 offset:4096
    ds_read_b64_tr_b16 v[58:59], v5 offset:4608
    s_waitcnt lgkmcnt(6)
    v_mfma_f32_32x32x16_bf16 v[40:55], v[60:63], a[80:83], v[40:55]
    ds_read_b64_tr_b16 v[60:61], v7 offset:4096
    ds_read_b64_tr_b16 v[62:63], v7 offset:4608
    s_waitcnt lgkmcnt(6)
    v_mfma_f32_32x32x16_bf16 v[24:39], v[64:67], a[84:87], v[24:39]
    s_mul_i32 s92, s19, 0x3800
    s_add_u32 m0, s99, 0x16000
    s_add_u32 s92, s92, s85
    buffer_load_dwordx4 v9, s[44:47], s92 offen lds
    ds_read_b64_tr_b16 v[64:65], v5 offset:6144
    ds_read_b64_tr_b16 v[66:67], v5 offset:6656
    s_waitcnt lgkmcnt(6)
    v_mfma_f32_32x32x16_bf16 v[40:55], v[68:71], a[84:87], v[40:55]
    ds_read_b64_tr_b16 v[68:69], v7 offset:6144
    ds_read_b64_tr_b16 v[70:71], v7 offset:6656
    s_waitcnt lgkmcnt(6)
    v_mfma_f32_32x32x16_bf16 v[24:39], v[56:59], a[88:91], v[24:39]
    v_add_u32 v4, 0x24000, v12
    ds_read_b64_tr_b16 v[56:57], v4
    ds_read_b64_tr_b16 v[58:59], v4 offset:512
    s_waitcnt lgkmcnt(6)
    v_mfma_f32_32x32x16_bf16 v[40:55], v[60:63], a[88:91], v[40:55]
    s_mul_i32 s92, s19, 0x3800
    s_add_u32 s92, s92, s85
    s_add_u32 m0, s99, 0x1a000
    s_add_u32 s92, s92, 0x3800
    buffer_load_dwordx4 v9, s[44:47], s92 offen lds
    v_add_u32 v6, 0x24000, v13
    ds_read_b64_tr_b16 v[60:61], v6
    ds_read_b64_tr_b16 v[62:63], v6 offset:512
    s_waitcnt lgkmcnt(6)
    v_mfma_f32_32x32x16_bf16 v[24:39], v[64:67], a[92:95], v[24:39]
    ds_read_b64_tr_b16 v[64:65], v4 offset:2048
    ds_read_b64_tr_b16 v[66:67], v4 offset:2560
    s_waitcnt lgkmcnt(6)
    v_mfma_f32_32x32x16_bf16 v[40:55], v[68:71], a[92:95], v[40:55]
    s_barrier
    ds_read_b64_tr_b16 v[68:69], v6 offset:2048
    ds_read_b64_tr_b16 v[70:71], v6 offset:2560
    s_waitcnt lgkmcnt(6)
    v_mfma_f32_32x32x16_bf16 v[24:39], v[56:59], a[96:99], v[24:39]
    s_mul_i32 s92, s79, 0x38000
    s_add_u32 m0, s87, 0x20000
    s_add_u32 s92, s92, s89
    buffer_load_dwordx4 v14, s[4:7], s92 offen lds
    ds_read_b64_tr_b16 v[56:57], v4 offset:4096
    ds_read_b64_tr_b16 v[58:59], v4 offset:4608
    s_waitcnt lgkmcnt(6)
    v_mfma_f32_32x32x16_bf16 v[40:55], v[60:63], a[96:99], v[40:55]
    ds_read_b64_tr_b16 v[60:61], v6 offset:4096
    ds_read_b64_tr_b16 v[62:63], v6 offset:4608
    s_waitcnt lgkmcnt(6)
    v_mfma_f32_32x32x16_bf16 v[24:39], v[64:67], a[100:103], v[24:39]
    s_mul_i32 s92, s80, 0x38000
    s_add_u32 m0, s87, 0x22000
    s_add_u32 s92, s92, s89
    buffer_load_dwordx4 v14, s[4:7], s92 offen lds
    ds_read_b64_tr_b16 v[64:65], v4 offset:6144
    ds_read_b64_tr_b16 v[66:67], v4 offset:6656
    s_waitcnt lgkmcnt(6)
    v_mfma_f32_32x32x16_bf16 v[40:55], v[68:71], a[100:103], v[40:55]
    ds_read_b64_tr_b16 v[68:69], v6 offset:6144
    ds_read_b64_tr_b16 v[70:71], v6 offset:6656
    s_waitcnt lgkmcnt(6)
    v_mfma_f32_32x32x16_bf16 v[24:39], v[56:59], a[104:107], v[24:39]
    s_waitcnt lgkmcnt(4)
    v_mfma_f32_32x32x16_bf16 v[40:55], v[60:63], a[104:107], v[40:55]
    s_mul_i32 s92, s19, 0x3800
    s_add_u32 s92, s92, s85
    s_add_u32 m0, s99, 0x1e000
    s_add_u32 s92, s92, 0x7000
    buffer_load_dwordx4 v9, s[44:47], s92 offen lds
    s_waitcnt lgkmcnt(2)
    v_mfma_f32_32x32x16_bf16 v[24:39], v[64:67], a[108:111], v[24:39]
    s_waitcnt lgkmcnt(0)
    v_mfma_f32_32x32x16_bf16 v[40:55], v[68:71], a[108:111], v[40:55]
    s_waitcnt vmcnt(8)
    s_barrier
    v_add_u32 v4, 0xc000, v15
    ds_read_b64_tr_b16 v[56:57], v4
    ds_read_b64_tr_b16 v[58:59], v4 offset:256
    ds_read_b64_tr_b16 v[60:61], v4 offset:1024
    ds_read_b64_tr_b16 v[62:63], v4 offset:1280
    ds_read_b64_tr_b16 v[64:65], v4 offset:2048
    ds_read_b64_tr_b16 v[66:67], v4 offset:2304
    ds_read_b64_tr_b16 v[68:69], v4 offset:3072
    ds_read_b64_tr_b16 v[70:71], v4 offset:3328
    s_waitcnt lgkmcnt(6)
    v_mfma_f32_32x32x16_bf16 v[96:111], v[56:59], a[0:3], 0
    s_mul_i32 s92, s19, 0x3800
    s_add_u32 s92, s92, s85
    s_add_u32 m0, s99, 0x26000
    s_add_u32 s92, s92, 0xa800
    buffer_load_dwordx4 v9, s[44:47], s92 offen lds
    v_exp_f32 v112, v24
    v_exp_f32 v113, v25
    v_exp_f32 v114, v26
    v_add_u32 v5, 0x10000, v15
    ds_read_b64_tr_b16 v[56:57], v5
    ds_read_b64_tr_b16 v[58:59], v5 offset:256
    s_waitcnt lgkmcnt(6)
    v_mfma_f32_32x32x16_bf16 v[96:111], v[60:63], a[4:7], v[96:111]
    v_exp_f32 v115, v27
    v_exp_f32 v116, v28
    v_exp_f32 v117, v29
    v_exp_f32 v118, v30
    v_exp_f32 v119, v31
    v_mul_f32 v24, v24, v32
    v_mul_f32 v25, v25, v33
    ds_read_b64_tr_b16 v[60:61], v5 offset:1024
    ds_read_b64_tr_b16 v[62:63], v5 offset:1280
    s_waitcnt lgkmcnt(6)
    v_mfma_f32_32x32x16_bf16 v[96:111], v[64:67], a[8:11], v[96:111]
    v_mul_f32 v26, v26, v34
    v_mul_f32 v27, v27, v35
    v_mul_f32 v28, v28, v36
    v_mul_f32 v29, v29, v37
    v_mul_f32 v30, v30, v38
    v_mul_f32 v31, v31, v39
    v_add_f32 v112, 1.0, v112
    v_add_f32 v113, 1.0, v113
    v_add_f32 v114, 1.0, v114
    v_add_f32 v115, 1.0, v115
    v_add_f32 v116, 1.0, v116
    v_add_f32 v117, 1.0, v117
    ds_read_b64_tr_b16 v[64:65], v5 offset:2048
    ds_read_b64_tr_b16 v[66:67], v5 offset:2304
    s_waitcnt lgkmcnt(6)
    v_mfma_f32_32x32x16_bf16 v[96:111], v[68:71], a[12:15], v[96:111]
    v_add_f32 v118, 1.0, v118
    v_add_f32 v119, 1.0, v119
    v_rcp_f32 v112, v112
    v_rcp_f32 v113, v113
    v_rcp_f32 v114, v114
    v_rcp_f32 v115, v115
    v_rcp_f32 v116, v116
    s_barrier
    ds_read_b64_tr_b16 v[68:69], v5 offset:3072
    ds_read_b64_tr_b16 v[70:71], v5 offset:3328
    s_waitcnt lgkmcnt(6)
    v_mfma_f32_32x32x16_bf16 v[96:111], v[56:59], a[16:19], v[96:111]
    v_rcp_f32 v117, v117
    v_rcp_f32 v118, v118
    v_rcp_f32 v119, v119
    v_mul_f32 v24, v24, v112
    v_mul_f32 v25, v25, v113
    v_mul_f32 v26, v26, v114
    v_mul_f32 v27, v27, v115
    v_mul_f32 v28, v28, v116
    v_add_u32 v4, 0x14000, v15
    ds_read_b64_tr_b16 v[56:57], v4
    ds_read_b64_tr_b16 v[58:59], v4 offset:256
    s_waitcnt lgkmcnt(6)
    v_mfma_f32_32x32x16_bf16 v[96:111], v[60:63], a[20:23], v[96:111]
    v_mul_f32 v29, v29, v117
    v_mul_f32 v30, v30, v118
    v_mul_f32 v31, v31, v119
    v_cvt_pk_bf16_f32 v120, v24, v25
    v_cvt_pk_bf16_f32 v121, v26, v27
    v_cvt_pk_bf16_f32 v122, v28, v29
    v_cvt_pk_bf16_f32 v123, v30, v31
    s_lshl_b32 s93, s88, 5
    s_add_u32 s93, s93, s90
    s_mul_i32 s94, s70, 0x800
    s_add_u32 s93, s93, s94
    buffer_store_dwordx4 v[120:123], v2, s[60:63], s93 offen sc1
    ds_read_b64_tr_b16 v[60:61], v4 offset:1024
    ds_read_b64_tr_b16 v[62:63], v4 offset:1280
    s_waitcnt lgkmcnt(6)
    v_mfma_f32_32x32x16_bf16 v[96:111], v[64:67], a[24:27], v[96:111]
    v_exp_f32 v112, v40
    v_exp_f32 v113, v41
    v_exp_f32 v114, v42
    v_exp_f32 v115, v43
    v_exp_f32 v116, v44
    v_exp_f32 v117, v45
    ds_read_b64_tr_b16 v[64:65], v4 offset:2048
    ds_read_b64_tr_b16 v[66:67], v4 offset:2304
    s_waitcnt lgkmcnt(6)
    v_mfma_f32_32x32x16_bf16 v[96:111], v[68:71], a[28:31], v[96:111]
    v_exp_f32 v118, v46
    v_exp_f32 v119, v47
    v_mul_f32 v40, v40, v48
    v_mul_f32 v41, v41, v49
    v_mul_f32 v42, v42, v50
    v_mul_f32 v43, v43, v51
    v_mul_f32 v44, v44, v52
    v_mul_f32 v45, v45, v53
    s_waitcnt vmcnt(3)
    s_barrier
    ds_read_b64_tr_b16 v[68:69], v4 offset:3072
    ds_read_b64_tr_b16 v[70:71], v4 offset:3328
    s_waitcnt lgkmcnt(6)
    v_mfma_f32_32x32x16_bf16 v[96:111], v[56:59], a[32:35], v[96:111]
    v_mul_f32 v46, v46, v54
    v_mul_f32 v47, v47, v55
    s_mul_i32 s92, s22, 0x3800
    s_add_u32 m0, s99, 0xc000
    s_add_u32 s92, s92, s85
    buffer_load_dwordx4 v9, s[44:47], s92 offen lds
    v_add_f32 v112, 1.0, v112
    v_add_f32 v113, 1.0, v113
    v_add_f32 v114, 1.0, v114
    v_add_f32 v115, 1.0, v115
    v_add_f32 v116, 1.0, v116
    v_add_f32 v117, 1.0, v117
    v_add_u32 v5, 0x18000, v15
    ds_read_b64_tr_b16 v[56:57], v5
    ds_read_b64_tr_b16 v[58:59], v5 offset:256
    s_waitcnt lgkmcnt(6)
    v_mfma_f32_32x32x16_bf16 v[96:111], v[60:63], a[36:39], v[96:111]
    v_add_f32 v118, 1.0, v118
    v_add_f32 v119, 1.0, v119
    v_rcp_f32 v112, v112
    v_rcp_f32 v113, v113
    v_rcp_f32 v114, v114
    v_rcp_f32 v115, v115
    v_rcp_f32 v116, v116
    ds_read_b64_tr_b16 v[60:61], v5 offset:1024
    ds_read_b64_tr_b16 v[62:63], v5 offset:1280
    s_waitcnt lgkmcnt(6)
    v_mfma_f32_32x32x16_bf16 v[96:111], v[64:67], a[40:43], v[96:111]
    v_rcp_f32 v117, v117
    v_rcp_f32 v118, v118
    v_rcp_f32 v119, v119
    v_mul_f32 v40, v40, v112
    v_mul_f32 v41, v41, v113
    v_mul_f32 v42, v42, v114
    v_mul_f32 v43, v43, v115
    v_mul_f32 v44, v44, v116
    ds_read_b64_tr_b16 v[64:65], v5 offset:2048
    ds_read_b64_tr_b16 v[66:67], v5 offset:2304
    s_waitcnt lgkmcnt(6)
    v_mfma_f32_32x32x16_bf16 v[96:111], v[68:71], a[44:47], v[96:111]
    v_mul_f32 v45, v45, v117
    v_mul_f32 v46, v46, v118
    v_mul_f32 v47, v47, v119
    v_cvt_pk_bf16_f32 v124, v40, v41
    v_cvt_pk_bf16_f32 v125, v42, v43
    v_cvt_pk_bf16_f32 v126, v44, v45
    v_cvt_pk_bf16_f32 v127, v46, v47
    s_lshl_b32 s93, s88, 5
    s_add_u32 s93, s93, s90
    s_mul_i32 s94, s70, 0x800
    s_add_u32 s93, s93, s94
    buffer_store_dwordx4 v[124:127], v2, s[60:63], s93 offen offset:1024 sc1
    s_barrier
    ds_read_b64_tr_b16 v[68:69], v5 offset:3072
    ds_read_b64_tr_b16 v[70:71], v5 offset:3328
    s_waitcnt lgkmcnt(6)
    v_mfma_f32_32x32x16_bf16 v[96:111], v[56:59], a[48:51], v[96:111]
    s_mul_i32 s92, s22, 0x3800
    s_add_u32 s92, s92, s85
    s_add_u32 m0, s99, 0x10000
    s_add_u32 s92, s92, 0x3800
    buffer_load_dwordx4 v9, s[44:47], s92 offen lds
    v_add_u32 v4, 0x1c000, v15
    ds_read_b64_tr_b16 v[56:57], v4
    ds_read_b64_tr_b16 v[58:59], v4 offset:256
    s_waitcnt lgkmcnt(6)
    v_mfma_f32_32x32x16_bf16 v[96:111], v[60:63], a[52:55], v[96:111]
    ds_read_b64_tr_b16 v[60:61], v4 offset:1024
    ds_read_b64_tr_b16 v[62:63], v4 offset:1280
    s_waitcnt lgkmcnt(6)
    v_mfma_f32_32x32x16_bf16 v[96:111], v[64:67], a[56:59], v[96:111]
    ds_read_b64_tr_b16 v[64:65], v4 offset:2048
    ds_read_b64_tr_b16 v[66:67], v4 offset:2304
    s_waitcnt lgkmcnt(6)
    v_mfma_f32_32x32x16_bf16 v[96:111], v[68:71], a[60:63], v[96:111]
    s_barrier
    ds_read_b64_tr_b16 v[68:69], v4 offset:3072
    ds_read_b64_tr_b16 v[70:71], v4 offset:3328
    s_waitcnt lgkmcnt(6)
    v_mfma_f32_32x32x16_bf16 v[96:111], v[56:59], a[64:67], v[96:111]
    s_add_u32 s14, s13, 0x80
    s_cmp_lg_u32 s68, 0
    s_cbranch_scc1 L_pi_1007
    buffer_load_dword v143, v142, s[60:63], s14 offen sc1
L_pi_1007:
    v_add_u32 v5, 0x20000, v15
    ds_read_b64_tr_b16 v[56:57], v5
    ds_read_b64_tr_b16 v[58:59], v5 offset:256
    s_waitcnt lgkmcnt(6)
    v_mfma_f32_32x32x16_bf16 v[96:111], v[60:63], a[68:71], v[96:111]
    ds_read_b64_tr_b16 v[60:61], v5 offset:1024
    ds_read_b64_tr_b16 v[62:63], v5 offset:1280
    s_waitcnt lgkmcnt(6)
    v_mfma_f32_32x32x16_bf16 v[96:111], v[64:67], a[72:75], v[96:111]
    s_mul_i32 s92, s22, 0x3800
    s_add_u32 s92, s92, s85
    s_add_u32 m0, s99, 0x14000
    s_add_u32 s92, s92, 0x7000
    buffer_load_dwordx4 v9, s[44:47], s92 offen lds
    ds_read_b64_tr_b16 v[64:65], v5 offset:2048
    ds_read_b64_tr_b16 v[66:67], v5 offset:2304
    s_waitcnt lgkmcnt(6)
    v_mfma_f32_32x32x16_bf16 v[96:111], v[68:71], a[76:79], v[96:111]
    s_waitcnt vmcnt(2)
    s_cmp_lg_u32 s68, 0
    s_cbranch_scc1 L_pc_1008
    s_waitcnt vmcnt(1)
    v_cmp_le_u32 vcc, 1, v143
    s_nop 0
    s_and_b32 s93, vcc_lo, 0xaaaa
    s_cmp_eq_u32 s93, 0xaaaa
    s_cbranch_scc1 L_poll_1009_done
    s_mov_b32 s100, 0x186a0
L_poll_1009:
    s_sleep 2
    buffer_load_dword v143, v142, s[60:63], s14 offen sc1
    s_waitcnt vmcnt(0)
    v_cmp_le_u32 vcc, 1, v143
    s_nop 0
    s_and_b32 s93, vcc_lo, 0xaaaa
    s_cmp_eq_u32 s93, 0xaaaa
    s_cbranch_scc1 L_poll_1009_done
    s_sub_u32 s100, s100, 1
    s_cmp_lg_u32 s100, 0
    s_cbranch_scc1 L_poll_1009
L_poll_1009_done:
L_pc_1008:
    s_barrier
    ds_read_b64_tr_b16 v[68:69], v5 offset:3072
    ds_read_b64_tr_b16 v[70:71], v5 offset:3328
    s_waitcnt lgkmcnt(6)
    v_mfma_f32_32x32x16_bf16 v[96:111], v[56:59], a[80:83], v[96:111]
    s_cmp_lg_u32 s68, 0
    s_cbranch_scc1 L_sig_1010
    v_mov_b32 v20, 1
    v_mov_b32 v21, 0
    s_add_u32 s93, s16, 0x80
    s_mov_b64 exec, 1
    buffer_store_dword v20, v21, s[60:63], s93 offen sc1
    s_mov_b64 exec, -1
L_sig_1010:
    v_add_u32 v4, 0x22000, v15
    ds_read_b64_tr_b16 v[56:57], v4
    ds_read_b64_tr_b16 v[58:59], v4 offset:256
    s_waitcnt lgkmcnt(6)
    v_mfma_f32_32x32x16_bf16 v[96:111], v[60:63], a[84:87], v[96:111]
    s_lshl_b32 s92, s8, 10
    s_add_u32 s92, s92, s10
    buffer_load_dwordx4 a[0:3], v2, s[60:63], s92 offen sc1
    s_lshl_b32 s92, s8, 10
    s_add_u32 s92, s92, s10
    buffer_load_dwordx4 a[4:7], v2, s[60:63], s92 offen offset:1024 sc1
    ds_read_b64_tr_b16 v[60:61], v4 offset:1024
    ds_read_b64_tr_b16 v[62:63], v4 offset:1280
    s_waitcnt lgkmcnt(6)
    v_mfma_f32_32x32x16_bf16 v[96:111], v[64:67], a[88:91], v[96:111]
    s_lshl_b32 s92, s8, 10
    s_add_u32 s92, s92, s10
    buffer_load_dwordx4 a[8:11], v2, s[60:63], s92 offen offset:2048 sc1
    s_lshl_b32 s92, s8, 10
    s_add_u32 s92, s92, s10
    buffer_load_dwordx4 a[12:15], v2, s[60:63], s92 offen offset:3072 sc1
    ds_read_b64_tr_b16 v[64:65], v4 offset:2048
    ds_read_b64_tr_b16 v[66:67], v4 offset:2304
    s_waitcnt lgkmcnt(6)
    v_mfma_f32_32x32x16_bf16 v[96:111], v[68:71], a[92:95], v[96:111]
    s_mul_i32 s92, s22, 0x3800
    s_add_u32 s92, s92, s85
    s_add_u32 m0, s99, 0x18000
    s_add_u32 s92, s92, 0xa800
    buffer_load_dwordx4 v9, s[44:47], s92 offen lds
    s_barrier
    ds_read_b64_tr_b16 v[68:69], v4 offset:3072
    ds_read_b64_tr_b16 v[70:71], v4 offset:3328
    s_waitcnt lgkmcnt(6)
    v_mfma_f32_32x32x16_bf16 v[96:111], v[56:59], a[96:99], v[96:111]
    s_lshl_b32 s92, s9, 10
    s_add_u32 s92, s92, s10
    buffer_load_dwordx4 a[16:19], v2, s[60:63], s92 offen sc1
    s_waitcnt lgkmcnt(4)
    v_mfma_f32_32x32x16_bf16 v[96:111], v[60:63], a[100:103], v[96:111]
    s_lshl_b32 s92, s9, 10
    s_add_u32 s92, s92, s10
    buffer_load_dwordx4 a[20:23], v2, s[60:63], s92 offen offset:1024 sc1
    s_lshl_b32 s92, s9, 10
    s_add_u32 s92, s92, s10
    buffer_load_dwordx4 a[24:27], v2, s[60:63], s92 offen offset:2048 sc1
    s_waitcnt lgkmcnt(2)
    v_mfma_f32_32x32x16_bf16 v[96:111], v[64:67], a[104:107], v[96:111]
    s_lshl_b32 s92, s9, 10
    s_add_u32 s92, s92, s10
    buffer_load_dwordx4 a[28:31], v2, s[60:63], s92 offen offset:3072 sc1
    s_waitcnt lgkmcnt(0)
    v_mfma_f32_32x32x16_bf16 v[96:111], v[68:71], a[108:111], v[96:111]
    s_mul_i32 s92, s23, 0x3800
    s_add_u32 m0, s99, 0x1c000
    s_add_u32 s92, s92, s85
    buffer_load_dwordx4 v9, s[44:47], s92 offen lds
    s_nop 7
    v_exp_f32 v112, v96
    v_exp_f32 v113, v97
    v_exp_f32 v114, v98
    v_exp_f32 v115, v99
    v_exp_f32 v116, v100
    v_exp_f32 v117, v101
    v_exp_f32 v118, v102
    v_exp_f32 v119, v103
    v_mul_f32 v96, v96, v104
    v_mul_f32 v97, v97, v105
    v_mul_f32 v98, v98, v106
    v_mul_f32 v99, v99, v107
    v_mul_f32 v100, v100, v108
    v_mul_f32 v101, v101, v109
    v_mul_f32 v102, v102, v110
    v_mul_f32 v103, v103, v111
    v_add_f32 v112, 1.0, v112
    v_add_f32 v113, 1.0, v113
    v_add_f32 v114, 1.0, v114
    v_add_f32 v115, 1.0, v115
    v_add_f32 v116, 1.0, v116
    v_add_f32 v117, 1.0, v117
    v_add_f32 v118, 1.0, v118
    v_add_f32 v119, 1.0, v119
    v_rcp_f32 v112, v112
    v_rcp_f32 v113, v113
    v_rcp_f32 v114, v114
    v_rcp_f32 v115, v115
    v_rcp_f32 v116, v116
    v_rcp_f32 v117, v117
    v_rcp_f32 v118, v118
    v_rcp_f32 v119, v119
    v_mul_f32 v96, v96, v112
    v_mul_f32 v97, v97, v113
    v_mul_f32 v98, v98, v114
    v_mul_f32 v99, v99, v115
    v_mul_f32 v100, v100, v116
    v_mul_f32 v101, v101, v117
    v_mul_f32 v102, v102, v118
    v_mul_f32 v103, v103, v119
    v_cvt_pk_bf16_f32 v120, v96, v97
    v_cvt_pk_bf16_f32 v121, v98, v99
    v_cvt_pk_bf16_f32 v122, v100, v101
    v_cvt_pk_bf16_f32 v123, v102, v103
    s_lshl_b32 s93, s89, 5
    s_add_u32 s93, s93, s90
    s_mul_i32 s94, s70, 0x400
    s_add_u32 s93, s93, s94
    buffer_store_dwordx4 v[120:123], v2, s[60:63], s93 offen sc1
    s_waitcnt lgkmcnt(0)
    s_barrier
    s_cmp_lg_u32 s96, 0
    s_cbranch_scc1 L_nop2_1013
    s_waitcnt vmcnt(0)
    s_barrier
    s_cmp_lg_u32 s68, 0
    s_cbranch_scc1 L_sig_1012
    v_mov_b32 v20, 1
    v_mov_b32 v21, 0
    s_add_u32 s93, s16, 0x100
    s_mov_b64 exec, 1
    buffer_store_dword v20, v21, s[60:63], s93 offen sc1
    s_mov_b64 exec, -1
L_sig_1012:
    s_branch L_fin_1011
L_nop2_1013:
    ds_read_b64_tr_b16 v[96:97], v128
    ds_read_b64_tr_b16 v[98:99], v128 offset:1024
    ds_read_b64_tr_b16 v[100:101], v129
    ds_read_b64_tr_b16 v[102:103], v129 offset:1024
    ds_read_b64_tr_b16 v[104:105], v128 offset:8192
    ds_read_b64_tr_b16 v[106:107], v128 offset:9216
    ds_read_b64_tr_b16 v[108:109], v129 offset:8192
    ds_read_b64_tr_b16 v[110:111], v129 offset:9216
    ds_read_b64_tr_b16 v[112:113], v128 offset:16384
    ds_read_b64_tr_b16 v[114:115], v128 offset:17408
    ds_read_b64_tr_b16 v[116:117], v129 offset:16384
    ds_read_b64_tr_b16 v[118:119], v129 offset:17408
    s_waitcnt vmcnt(10) lgkmcnt(10)
    v_mfma_f32_32x32x16_bf16 v[32:47], v[96:99], a[0:3], 0
    s_add_u32 s14, s13, 0x80
    s_cmp_lg_u32 s68, 0
    s_cbranch_scc1 L_pi_1014
    buffer_load_dword v143, v142, s[60:63], s14 offen sc1
L_pi_1014:
    ds_read_b64_tr_b16 v[120:121], v128 offset:24576
    ds_read_b64_tr_b16 v[122:123], v128 offset:25600
    s_waitcnt lgkmcnt(10)
    v_mfma_f32_32x32x16_bf16 v[48:63], v[100:103], a[0:3], 0
    ds_read_b64_tr_b16 v[124:125], v129 offset:24576
    ds_read_b64_tr_b16 v[126:127], v129 offset:25600
    s_waitcnt vmcnt(9) lgkmcnt(10)
    v_mfma_f32_32x32x16_bf16 v[32:47], v[104:107], a[4:7], v[32:47]
    s_mul_i32 s92, s23, 0x3800
    s_add_u32 s92, s92, s85
    s_add_u32 m0, s99, 0x20000
    s_add_u32 s92, s92, 0x3800
    buffer_load_dwordx4 v9, s[44:47], s92 offen lds
    ds_read_b64_tr_b16 v[96:97], v128 offset:32768
    ds_read_b64_tr_b16 v[98:99], v128 offset:33792
    s_waitcnt lgkmcnt(10)
    v_mfma_f32_32x32x16_bf16 v[48:63], v[108:111], a[4:7], v[48:63]
    s_mul_i32 s92, s23, 0x3800
    s_add_u32 s92, s92, s85
    s_add_u32 m0, s99, 0x22000
    s_add_u32 s92, s92, 0x7000
    buffer_load_dwordx4 v9, s[44:47], s92 offen lds
    ds_read_b64_tr_b16 v[100:101], v129 offset:32768
    ds_read_b64_tr_b16 v[102:103], v129 offset:33792
    s_waitcnt vmcnt(10) lgkmcnt(10)
    v_mfma_f32_32x32x16_bf16 v[32:47], v[112:115], a[8:11], v[32:47]
    ds_read_b64_tr_b16 v[104:105], v128 offset:40960
    ds_read_b64_tr_b16 v[106:107], v128 offset:41984
    s_waitcnt lgkmcnt(10)
    v_mfma_f32_32x32x16_bf16 v[48:63], v[116:119], a[8:11], v[48:63]
    s_mul_i32 s92, s23, 0x3800
    s_add_u32 s92, s92, s85
    s_add_u32 m0, s99, 0x24000
    s_add_u32 s92, s92, 0xa800
    buffer_load_dwordx4 v9, s[44:47], s92 offen lds
    ds_read_b64_tr_b16 v[108:109], v129 offset:40960
    ds_read_b64_tr_b16 v[110:111], v129 offset:41984
    s_waitcnt vmcnt(10) lgkmcnt(10)
    v_mfma_f32_32x32x16_bf16 v[32:47], v[120:123], a[12:15], v[32:47]
    s_waitcnt lgkmcnt(8)
    v_mfma_f32_32x32x16_bf16 v[48:63], v[124:127], a[12:15], v[48:63]
    s_waitcnt vmcnt(3)
    s_cmp_lg_u32 s68, 0
    s_cbranch_scc1 L_pc_1015
    v_cmp_le_u32 vcc, 1, v143
    s_nop 0
    s_and_b32 s93, vcc_lo, 0x5555
    s_cmp_eq_u32 s93, 0x5555
    s_cbranch_scc1 L_poll_1016_done
    s_mov_b32 s100, 0x186a0
L_poll_1016:
    s_sleep 2
    buffer_load_dword v143, v142, s[60:63], s14 offen sc1
    s_waitcnt vmcnt(0)
    v_cmp_le_u32 vcc, 1, v143
    s_nop 0
    s_and_b32 s93, vcc_lo, 0x5555
    s_cmp_eq_u32 s93, 0x5555
    s_cbranch_scc1 L_poll_1016_done
    s_sub_u32 s100, s100, 1
    s_cmp_lg_u32 s100, 0
    s_cbranch_scc1 L_poll_1016
L_poll_1016_done:
L_pc_1015:
    s_barrier
    ds_read_b64_tr_b16 v[112:113], v128 offset:57344
    ds_read_b64_tr_b16 v[114:115], v128 offset:58368
    ds_read_b64_tr_b16 v[116:117], v129 offset:57344
    ds_read_b64_tr_b16 v[118:119], v129 offset:58368
    s_waitcnt lgkmcnt(10)
    v_mfma_f32_32x32x16_bf16 v[32:47], v[96:99], a[16:19], v[32:47]
    s_cmp_lg_u32 s68, 0
    s_cbranch_scc1 L_sig_1017
    v_mov_b32 v20, 1
    v_mov_b32 v21, 0
    s_add_u32 s93, s16, 0x100
    s_mov_b64 exec, 1
    buffer_store_dword v20, v21, s[60:63], s93 offen sc1
    s_mov_b64 exec, -1
L_sig_1017:
    ds_read_b64_tr_b16 v[120:121], v130 offset:8192
    ds_read_b64_tr_b16 v[122:123], v130 offset:9216
    s_waitcnt lgkmcnt(10)
    v_mfma_f32_32x32x16_bf16 v[48:63], v[100:103], a[16:19], v[48:63]
    s_lshl_b32 s92, s19, 10
    s_add_u32 s92, s92, s10
    buffer_load_dwordx4 a[32:35], v2, s[60:63], s92 offen sc1
    ds_read_b64_tr_b16 v[124:125], v131 offset:8192
    ds_read_b64_tr_b16 v[126:127], v131 offset:9216
    s_waitcnt lgkmcnt(10)
    v_mfma_f32_32x32x16_bf16 v[32:47], v[104:107], a[20:23], v[32:47]
    s_lshl_b32 s92, s19, 10
    s_add_u32 s92, s92, s10
    buffer_load_dwordx4 a[36:39], v2, s[60:63], s92 offen offset:1024 sc1
    ds_read_b64_tr_b16 v[96:97], v130 offset:24576
    ds_read_b64_tr_b16 v[98:99], v130 offset:25600
    s_waitcnt lgkmcnt(10)
    v_mfma_f32_32x32x16_bf16 v[48:63], v[108:111], a[20:23], v[48:63]
    s_lshl_b32 s92, s19, 10
    s_add_u32 s92, s92, s10
    buffer_load_dwordx4 a[40:43], v2, s[60:63], s92 offen offset:2048 sc1
    ds_read_b64_tr_b16 v[100:101], v131 offset:24576
    ds_read_b64_tr_b16 v[102:103], v131 offset:25600
    s_waitcnt lgkmcnt(10)
    v_mfma_f32_32x32x16_bf16 v[32:47], v[112:115], a[24:27], v[32:47]
    s_lshl_b32 s92, s19, 10
    s_add_u32 s92, s92, s10
    buffer_load_dwordx4 a[44:47], v2, s[60:63], s92 offen offset:3072 sc1
    ds_read_b64_tr_b16 v[104:105], v130 offset:40960
    ds_read_b64_tr_b16 v[106:107], v130 offset:41984
    s_waitcnt lgkmcnt(10)
    v_mfma_f32_32x32x16_bf16 v[48:63], v[116:119], a[24:27], v[48:63]
    s_lshl_b32 s92, s22, 10
    s_add_u32 s92, s92, s10
    buffer_load_dwordx4 a[48:51], v2, s[60:63], s92 offen sc1
    s_lshl_b32 s92, s22, 10
    s_add_u32 s92, s92, s10
    buffer_load_dwordx4 a[52:55], v2, s[60:63], s92 offen offset:1024 sc1
    ds_read_b64_tr_b16 v[108:109], v131 offset:40960
    ds_read_b64_tr_b16 v[110:111], v131 offset:41984
    s_waitcnt lgkmcnt(10)
    v_mfma_f32_32x32x16_bf16 v[32:47], v[120:123], a[28:31], v[32:47]
    s_lshl_b32 s92, s22, 10
    s_add_u32 s92, s92, s10
    buffer_load_dwordx4 a[56:59], v2, s[60:63], s92 offen offset:2048 sc1
    s_waitcnt lgkmcnt(8)
    v_mfma_f32_32x32x16_bf16 v[48:63], v[124:127], a[28:31], v[48:63]
    s_lshl_b32 s92, s22, 10
    s_add_u32 s92, s92, s10
    buffer_load_dwordx4 a[60:63], v2, s[60:63], s92 offen offset:3072 sc1
    s_barrier
    ds_read_b64_tr_b16 v[112:113], v130 offset:57344
    ds_read_b64_tr_b16 v[114:115], v130 offset:58368
    ds_read_b64_tr_b16 v[116:117], v131 offset:57344
    ds_read_b64_tr_b16 v[118:119], v131 offset:58368
    s_waitcnt vmcnt(7) lgkmcnt(10)
    v_mfma_f32_32x32x16_bf16 v[32:47], v[96:99], a[32:35], v[32:47]
    s_add_u32 s14, s13, 0x100
    s_cmp_lg_u32 s68, 0
    s_cbranch_scc1 L_pi_1018
    buffer_load_dword v143, v142, s[60:63], s14 offen sc1
L_pi_1018:
    ds_read_b64_tr_b16 v[120:121], v140 offset:24576
    ds_read_b64_tr_b16 v[122:123], v140 offset:25600
    s_waitcnt lgkmcnt(10)
    v_mfma_f32_32x32x16_bf16 v[48:63], v[100:103], a[32:35], v[48:63]
    s_mul_i32 s92, s24, 0x3800
    s_mov_b32 m0, s99
    s_add_u32 s92, s92, s85
    buffer_load_dwordx4 v9, s[44:47], s92 offen lds
    ds_read_b64_tr_b16 v[124:125], v141 offset:24576
    ds_read_b64_tr_b16 v[126:127], v141 offset:25600
    s_waitcnt vmcnt(7) lgkmcnt(10)
    v_mfma_f32_32x32x16_bf16 v[32:47], v[104:107], a[36:39], v[32:47]
    ds_read_b64_tr_b16 v[96:97], v128 offset:49152
    ds_read_b64_tr_b16 v[98:99], v128 offset:50176
    s_waitcnt lgkmcnt(10)
    v_mfma_f32_32x32x16_bf16 v[48:63], v[108:111], a[36:39], v[48:63]
    s_mul_i32 s92, s24, 0x3800
    s_add_u32 s92, s92, s85
    s_add_u32 m0, s99, 0x2000
    s_add_u32 s92, s92, 0x3800
    buffer_load_dwordx4 v9, s[44:47], s92 offen lds
    ds_read_b64_tr_b16 v[100:101], v129 offset:49152
    ds_read_b64_tr_b16 v[102:103], v129 offset:50176
    s_waitcnt vmcnt(7) lgkmcnt(10)
    v_mfma_f32_32x32x16_bf16 v[32:47], v[112:115], a[40:43], v[32:47]
    s_mul_i32 s92, s24, 0x3800
    s_add_u32 s92, s92, s85
    s_add_u32 m0, s99, 0x4000
    s_add_u32 s92, s92, 0x7000
    buffer_load_dwordx4 v9, s[44:47], s92 offen lds
    ds_read_b64_tr_b16 v[104:105], v130
    ds_read_b64_tr_b16 v[106:107], v130 offset:1024
    s_waitcnt lgkmcnt(10)
    v_mfma_f32_32x32x16_bf16 v[48:63], v[116:119], a[40:43], v[48:63]
    s_mul_i32 s92, s24, 0x3800
    s_add_u32 s92, s92, s85
    s_add_u32 m0, s99, 0x6000
    s_add_u32 s92, s92, 0xa800
    buffer_load_dwordx4 v9, s[44:47], s92 offen lds
    ds_read_b64_tr_b16 v[108:109], v131
    ds_read_b64_tr_b16 v[110:111], v131 offset:1024
    s_waitcnt vmcnt(8) lgkmcnt(10)
    v_mfma_f32_32x32x16_bf16 v[32:47], v[120:123], a[44:47], v[32:47]
    s_waitcnt lgkmcnt(8)
    v_mfma_f32_32x32x16_bf16 v[48:63], v[124:127], a[44:47], v[48:63]
    s_cmp_lg_u32 s68, 0
    s_cbranch_scc1 L_pc_1019
    s_waitcnt vmcnt(4)
    v_cmp_le_u32 vcc, 1, v143
    s_nop 0
    s_and_b32 s93, vcc_lo, 0xaaaa
    s_cmp_eq_u32 s93, 0xaaaa
    s_cbranch_scc1 L_poll_1020_done
    s_mov_b32 s100, 0x186a0
L_poll_1020:
    s_sleep 2
    buffer_load_dword v143, v142, s[60:63], s14 offen sc1
    s_waitcnt vmcnt(0)
    v_cmp_le_u32 vcc, 1, v143
    s_nop 0
    s_and_b32 s93, vcc_lo, 0xaaaa
    s_cmp_eq_u32 s93, 0xaaaa
    s_cbranch_scc1 L_poll_1020_done
    s_sub_u32 s100, s100, 1
    s_cmp_lg_u32 s100, 0
    s_cbranch_scc1 L_poll_1020
L_poll_1020_done:
L_pc_1019:
    s_barrier
    ds_read_b64_tr_b16 v[112:113], v130 offset:16384
    ds_read_b64_tr_b16 v[114:115], v130 offset:17408
    ds_read_b64_tr_b16 v[116:117], v131 offset:16384
    ds_read_b64_tr_b16 v[118:119], v131 offset:17408
    s_waitcnt vmcnt(7) lgkmcnt(10)
    v_mfma_f32_32x32x16_bf16 v[32:47], v[96:99], a[48:51], v[32:47]
    s_lshl_b32 s92, s23, 10
    s_add_u32 s92, s92, s10
    buffer_load_dwordx4 a[64:67], v2, s[60:63], s92 offen sc1
    ds_read_b64_tr_b16 v[120:121], v130 offset:32768
    ds_read_b64_tr_b16 v[122:123], v130 offset:33792
    s_waitcnt lgkmcnt(10)
    v_mfma_f32_32x32x16_bf16 v[48:63], v[100:103], a[48:51], v[48:63]
    s_lshl_b32 s92, s23, 10
    s_add_u32 s92, s92, s10
    buffer_load_dwordx4 a[68:71], v2, s[60:63], s92 offen offset:1024 sc1
    s_lshl_b32 s92, s23, 10
    s_add_u32 s92, s92, s10
    buffer_load_dwordx4 a[72:75], v2, s[60:63], s92 offen offset:2048 sc1
    ds_read_b64_tr_b16 v[124:125], v131 offset:32768
    ds_read_b64_tr_b16 v[126:127], v131 offset:33792
    s_waitcnt vmcnt(9) lgkmcnt(10)
    v_mfma_f32_32x32x16_bf16 v[32:47], v[104:107], a[52:55], v[32:47]
    s_lshl_b32 s92, s23, 10
    s_add_u32 s92, s92, s10
    buffer_load_dwordx4 a[76:79], v2, s[60:63], s92 offen offset:3072 sc1
    s_lshl_b32 s92, s24, 10
    s_add_u32 s92, s92, s10
    buffer_load_dwordx4 a[80:83], v2, s[60:63], s92 offen sc1
    ds_read_b64_tr_b16 v[96:97], v130 offset:49152
    ds_read_b64_tr_b16 v[98:99], v130 offset:50176
    s_waitcnt lgkmcnt(10)
    v_mfma_f32_32x32x16_bf16 v[48:63], v[108:111], a[52:55], v[48:63]
    s_lshl_b32 s92, s24, 10
    s_add_u32 s92, s92, s10
    buffer_load_dwordx4 a[84:87], v2, s[60:63], s92 offen offset:1024 sc1
    ds_read_b64_tr_b16 v[100:101], v131 offset:49152
    ds_read_b64_tr_b16 v[102:103], v131 offset:50176
    s_waitcnt vmcnt(11) lgkmcnt(10)
    v_mfma_f32_32x32x16_bf16 v[32:47], v[112:115], a[56:59], v[32:47]
    s_lshl_b32 s92, s24, 10
    s_add_u32 s92, s92, s10
    buffer_load_dwordx4 a[88:91], v2, s[60:63], s92 offen offset:2048 sc1
    s_lshl_b32 s92, s24, 10
    s_add_u32 s92, s92, s10
    buffer_load_dwordx4 a[92:95], v2, s[60:63], s92 offen offset:3072 sc1
    ds_read_b64_tr_b16 v[104:105], v140
    ds_read_b64_tr_b16 v[106:107], v140 offset:1024
    s_waitcnt lgkmcnt(10)
    v_mfma_f32_32x32x16_bf16 v[48:63], v[116:119], a[56:59], v[48:63]
    s_mul_i32 s92, s25, 0x3800
    s_add_u32 m0, s99, 0x8000
    s_add_u32 s92, s92, s85
    buffer_load_dwordx4 v9, s[44:47], s92 offen lds
    ds_read_b64_tr_b16 v[108:109], v141
    ds_read_b64_tr_b16 v[110:111], v141 offset:1024
    s_waitcnt vmcnt(13) lgkmcnt(10)
    v_mfma_f32_32x32x16_bf16 v[32:47], v[120:123], a[60:63], v[32:47]
    s_mul_i32 s92, s25, 0x3800
    s_add_u32 s92, s92, s85
    s_add_u32 m0, s99, 0xa000
    s_add_u32 s92, s92, 0x3800
    buffer_load_dwordx4 v9, s[44:47], s92 offen lds
    s_mul_i32 s92, s25, 0x3800
    s_add_u32 s92, s92, s85
    s_add_u32 m0, s99, 0xe000
    s_add_u32 s92, s92, 0x7000
    buffer_load_dwordx4 v9, s[44:47], s92 offen lds
    s_waitcnt lgkmcnt(8)
    v_mfma_f32_32x32x16_bf16 v[48:63], v[124:127], a[60:63], v[48:63]
    s_mul_i32 s92, s25, 0x3800
    s_add_u32 s92, s92, s85
    s_add_u32 m0, s99, 0x12000
    s_add_u32 s92, s92, 0xa800
    buffer_load_dwordx4 v9, s[44:47], s92 offen lds
    s_waitcnt vmcnt(14)
    s_barrier
    ds_read_b64_tr_b16 v[112:113], v140 offset:8192
    ds_read_b64_tr_b16 v[114:115], v140 offset:9216
    ds_read_b64_tr_b16 v[116:117], v141 offset:8192
    ds_read_b64_tr_b16 v[118:119], v141 offset:9216
    s_waitcnt vmcnt(11) lgkmcnt(10)
    v_mfma_f32_32x32x16_bf16 v[32:47], v[96:99], a[64:67], v[32:47]
    s_add_u32 s14, s13, 0x100
    s_cmp_lg_u32 s68, 0
    s_cbranch_scc1 L_pi_1021
    buffer_load_dword v143, v142, s[60:63], s14 offen sc1
L_pi_1021:
    ds_read_b64_tr_b16 v[120:121], v140 offset:16384
    ds_read_b64_tr_b16 v[122:123], v140 offset:17408
    s_waitcnt lgkmcnt(10)
    v_mfma_f32_32x32x16_bf16 v[48:63], v[100:103], a[64:67], v[48:63]
    s_mul_i32 s92, s26, 0x6200
    s_add_u32 m0, s99, 0x16000
    s_add_u32 s92, s92, s86
    buffer_load_dwordx4 v9, s[48:51], s92 offen lds
    ds_read_b64_tr_b16 v[124:125], v141 offset:16384
    ds_read_b64_tr_b16 v[126:127], v141 offset:17408
    s_waitcnt vmcnt(11) lgkmcnt(10)
    v_mfma_f32_32x32x16_bf16 v[32:47], v[104:107], a[68:71], v[32:47]
    ds_read_b64_tr_b16 v[96:97], v128
    ds_read_b64_tr_b16 v[98:99], v128 offset:1024
    s_waitcnt lgkmcnt(10)
    v_mfma_f32_32x32x16_bf16 v[48:63], v[108:111], a[68:71], v[48:63]
    s_mul_i32 s92, s26, 0x6200
    s_add_u32 s92, s92, s86
    s_add_u32 m0, s99, 0x1a000
    s_add_u32 s92, s92, 0x3800
    buffer_load_dwordx4 v9, s[48:51], s92 offen lds
    ds_read_b64_tr_b16 v[100:101], v129
    ds_read_b64_tr_b16 v[102:103], v129 offset:1024
    s_waitcnt vmcnt(11) lgkmcnt(10)
    v_mfma_f32_32x32x16_bf16 v[32:47], v[112:115], a[72:75], v[32:47]
    s_mul_i32 s92, s26, 0x6200
    s_add_u32 s92, s92, s86
    s_add_u32 m0, s99, 0x1e000
    s_add_u32 s92, s92, 0x6200
    buffer_load_dwordx4 v9, s[48:51], s92 offen lds
    ds_read_b64_tr_b16 v[104:105], v128 offset:8192
    ds_read_b64_tr_b16 v[106:107], v128 offset:9216
    s_waitcnt lgkmcnt(10)
    v_mfma_f32_32x32x16_bf16 v[48:63], v[116:119], a[72:75], v[48:63]
    s_mul_i32 s92, s26, 0x6200
    s_add_u32 s92, s92, s86
    s_add_u32 m0, s99, 0x26000
    s_add_u32 s92, s92, 0x9a00
    buffer_load_dwordx4 v9, s[48:51], s92 offen lds
    ds_read_b64_tr_b16 v[108:109], v129 offset:8192
    ds_read_b64_tr_b16 v[110:111], v129 offset:9216
    s_waitcnt vmcnt(12) lgkmcnt(10)
    v_mfma_f32_32x32x16_bf16 v[32:47], v[120:123], a[76:79], v[32:47]
    s_waitcnt lgkmcnt(8)
    v_mfma_f32_32x32x16_bf16 v[48:63], v[124:127], a[76:79], v[48:63]
    s_waitcnt vmcnt(6)
    s_cmp_lg_u32 s68, 0
    s_cbranch_scc1 L_pc_1022
    s_waitcnt vmcnt(4)
    v_cmp_le_u32 vcc, 1, v143
    s_nop 0
    s_and_b32 s93, vcc_lo, 0x5555
    s_cmp_eq_u32 s93, 0x5555
    s_cbranch_scc1 L_poll_1023_done
    s_mov_b32 s100, 0x186a0
L_poll_1023:
    s_sleep 2
    buffer_load_dword v143, v142, s[60:63], s14 offen sc1
    s_waitcnt vmcnt(0)
    v_cmp_le_u32 vcc, 1, v143
    s_nop 0
    s_and_b32 s93, vcc_lo, 0x5555
    s_cmp_eq_u32 s93, 0x5555
    s_cbranch_scc1 L_poll_1023_done
    s_sub_u32 s100, s100, 1
    s_cmp_lg_u32 s100, 0
    s_cbranch_scc1 L_poll_1023
L_poll_1023_done:
L_pc_1022:
    s_barrier
    ds_read_b64_tr_b16 v[112:113], v128 offset:16384
    ds_read_b64_tr_b16 v[114:115], v128 offset:17408
    ds_read_b64_tr_b16 v[116:117], v129 offset:16384
    ds_read_b64_tr_b16 v[118:119], v129 offset:17408
    s_waitcnt lgkmcnt(10)
    v_mfma_f32_32x32x16_bf16 v[32:47], v[96:99], a[80:83], v[32:47]
    s_add_u32 s14, s13, 0x180
    s_cmp_lg_u32 s68, 0
    s_cbranch_scc1 L_pi_1024
    buffer_load_dword v143, v142, s[60:63], s14 offen sc1
L_pi_1024:
    ds_read_b64_tr_b16 v[120:121], v128 offset:24576
    ds_read_b64_tr_b16 v[122:123], v128 offset:25600
    s_waitcnt lgkmcnt(10)
    v_mfma_f32_32x32x16_bf16 v[48:63], v[100:103], a[80:83], v[48:63]
    s_lshl_b32 s92, s25, 10
    s_add_u32 s92, s92, s10
    buffer_load_dwordx4 a[96:99], v2, s[60:63], s92 offen sc1
    s_lshl_b32 s92, s25, 10
    s_add_u32 s92, s92, s10
    buffer_load_dwordx4 a[100:103], v2, s[60:63], s92 offen offset:1024 sc1
    ds_read_b64_tr_b16 v[124:125], v129 offset:24576
    ds_read_b64_tr_b16 v[126:127], v129 offset:25600
    s_waitcnt lgkmcnt(10)
    v_mfma_f32_32x32x16_bf16 v[32:47], v[104:107], a[84:87], v[32:47]
    s_lshl_b32 s92, s25, 10
    s_add_u32 s92, s92, s10
    buffer_load_dwordx4 a[104:107], v2, s[60:63], s92 offen offset:2048 sc1
    ds_read_b64_tr_b16 v[96:97], v128 offset:32768
    ds_read_b64_tr_b16 v[98:99], v128 offset:33792
    s_waitcnt lgkmcnt(10)
    v_mfma_f32_32x32x16_bf16 v[48:63], v[108:111], a[84:87], v[48:63]
    s_lshl_b32 s92, s25, 10
    s_add_u32 s92, s92, s10
    buffer_load_dwordx4 a[108:111], v2, s[60:63], s92 offen offset:3072 sc1
    s_mul_i32 s92, s27, 0x6200
    s_add_u32 m0, s99, 0xc000
    s_add_u32 s92, s92, s86
    buffer_load_dwordx4 v9, s[48:51], s92 offen lds
    ds_read_b64_tr_b16 v[100:101], v129 offset:32768
    ds_read_b64_tr_b16 v[102:103], v129 offset:33792
    s_waitcnt lgkmcnt(10)
    v_mfma_f32_32x32x16_bf16 v[32:47], v[112:115], a[88:91], v[32:47]
    s_mul_i32 s92, s27, 0x6200
    s_add_u32 s92, s92, s86
    s_add_u32 m0, s99, 0x10000
    s_add_u32 s92, s92, 0x3800
    buffer_load_dwordx4 v9, s[48:51], s92 offen lds
    ds_read_b64_tr_b16 v[104:105], v128 offset:40960
    ds_read_b64_tr_b16 v[106:107], v128 offset:41984
    s_waitcnt lgkmcnt(10)
    v_mfma_f32_32x32x16_bf16 v[48:63], v[116:119], a[88:91], v[48:63]
    s_mul_i32 s92, s27, 0x6200
    s_add_u32 s92, s92, s86
    s_add_u32 m0, s99, 0x14000
    s_add_u32 s92, s92, 0x6200
    buffer_load_dwordx4 v9, s[48:51], s92 offen lds
    ds_read_b64_tr_b16 v[108:109], v129 offset:40960
    ds_read_b64_tr_b16 v[110:111], v129 offset:41984
    s_waitcnt lgkmcnt(10)
    v_mfma_f32_32x32x16_bf16 v[32:47], v[120:123], a[92:95], v[32:47]
    s_mul_i32 s92, s27, 0x6200
    s_add_u32 s92, s92, s86
    s_add_u32 m0, s99, 0x18000
    s_add_u32 s92, s92, 0x9a00
    buffer_load_dwordx4 v9, s[48:51], s92 offen lds
    s_waitcnt lgkmcnt(8)
    v_mfma_f32_32x32x16_bf16 v[48:63], v[124:127], a[92:95], v[48:63]
    v_lshrrev_b32 v20, 3, v1
    v_and_b32 v21, 7, v1
    v_xor_b32 v21, v21, v20
    s_lshl_b32 s93, s97, 6
    s_lshl_b32 s94, s68, 3
    s_add_u32 s93, s93, s94
    v_add_u32 v20, s93, v20
    v_mul_u32_u24 v20, 0x380, v20
    v_lshl_add_u32 v20, v21, 4, v20
    s_lshl_b32 s92, s98, 7
    s_add_u32 m0, s87, 0x1c000
    s_nop 0
    buffer_load_dwordx4 v20, s[28:31], s92 offen lds
    s_waitcnt vmcnt(11)
    s_cmp_lg_u32 s68, 0
    s_cbranch_scc1 L_pc_1025
    s_waitcnt vmcnt(9)
    v_cmp_le_u32 vcc, 1, v143
    s_nop 0
    s_and_b32 s93, vcc_lo, 0xaaaa
    s_cmp_eq_u32 s93, 0xaaaa
    s_cbranch_scc1 L_poll_1026_done
    s_mov_b32 s100, 0x186a0
L_poll_1026:
    s_sleep 2
    buffer_load_dword v143, v142, s[60:63], s14 offen sc1
    s_waitcnt vmcnt(0)
    v_cmp_le_u32 vcc, 1, v143
    s_nop 0
    s_and_b32 s93, vcc_lo, 0xaaaa
    s_cmp_eq_u32 s93, 0xaaaa
    s_cbranch_scc1 L_poll_1026_done
    s_sub_u32 s100, s100, 1
    s_cmp_lg_u32 s100, 0
    s_cbranch_scc1 L_poll_1026
L_poll_1026_done:
L_pc_1025:
    s_barrier
    ds_read_b64_tr_b16 v[112:113], v128 offset:57344
    ds_read_b64_tr_b16 v[114:115], v128 offset:58368
    ds_read_b64_tr_b16 v[116:117], v129 offset:57344
    ds_read_b64_tr_b16 v[118:119], v129 offset:58368
    s_waitcnt vmcnt(8) lgkmcnt(10)
    v_mfma_f32_32x32x16_bf16 v[32:47], v[96:99], a[96:99], v[32:47]
    v_and_b32 v20, 7, v1
    v_lshrrev_b32 v21, 5, v1
    v_xor_b32 v21, v21, v20
    v_lshlrev_b32 v21, 4, v21
    v_and_b32 v20, 31, v1
    v_lshl_add_u32 v21, v20, 8, v21
    s_mov_b32 s94, 0
    s_cmp_eq_u32 s69, 1
    s_cselect_b32 s94, 0x2000, s94
    s_cmp_eq_u32 s69, 2
    s_cselect_b32 s94, 0x4000, s94
    s_cmp_eq_u32 s69, 3
    s_cselect_b32 s94, 0x6000, s94
    v_add_u32 v14, s94, v21
    ds_read_b64_tr_b16 v[120:121], v130 offset:8192
    ds_read_b64_tr_b16 v[122:123], v130 offset:9216
    s_waitcnt lgkmcnt(10)
    v_mfma_f32_32x32x16_bf16 v[48:63], v[100:103], a[96:99], v[48:63]
    s_lshl_b32 s92, s26, 11
    s_add_u32 s92, s92, s11
    buffer_load_dwordx4 a[0:3], v2, s[60:63], s92 offen sc1
    ds_read_b64_tr_b16 v[124:125], v131 offset:8192
    ds_read_b64_tr_b16 v[126:127], v131 offset:9216
    s_waitcnt vmcnt(8) lgkmcnt(10)
    v_mfma_f32_32x32x16_bf16 v[32:47], v[104:107], a[100:103], v[32:47]
    s_lshl_b32 s92, s26, 11
    s_add_u32 s92, s92, s11
    buffer_load_dwordx4 a[4:7], v2, s[60:63], s92 offen offset:1024 sc1
    ds_read_b64_tr_b16 v[96:97], v130 offset:24576
    ds_read_b64_tr_b16 v[98:99], v130 offset:25600
    s_waitcnt lgkmcnt(10)
    v_mfma_f32_32x32x16_bf16 v[48:63], v[108:111], a[100:103], v[48:63]
    s_lshl_b32 s92, s26, 11
    s_add_u32 s92, s92, s11
    buffer_load_dwordx4 a[8:11], v2, s[60:63], s92 offen offset:2048 sc1
    s_lshl_b32 s92, s26, 11
    s_add_u32 s92, s92, s11
    buffer_load_dwordx4 a[12:15], v2, s[60:63], s92 offen offset:3072 sc1
    ds_read_b64_tr_b16 v[100:101], v131 offset:24576
    ds_read_b64_tr_b16 v[102:103], v131 offset:25600
    s_waitcnt vmcnt(10) lgkmcnt(10)
    v_mfma_f32_32x32x16_bf16 v[32:47], v[112:115], a[104:107], v[32:47]
    s_lshl_b32 s92, s27, 11
    s_add_u32 s92, s92, s11
    buffer_load_dwordx4 a[16:19], v2, s[60:63], s92 offen sc1
    s_lshl_b32 s92, s27, 11
    s_add_u32 s92, s92, s11
    buffer_load_dwordx4 a[20:23], v2, s[60:63], s92 offen offset:1024 sc1
    ds_read_b64_tr_b16 v[104:105], v130 offset:40960
    ds_read_b64_tr_b16 v[106:107], v130 offset:41984
    s_waitcnt lgkmcnt(10)
    v_mfma_f32_32x32x16_bf16 v[48:63], v[116:119], a[104:107], v[48:63]
    s_lshl_b32 s92, s27, 11
    s_add_u32 s92, s92, s11
    buffer_load_dwordx4 a[24:27], v2, s[60:63], s92 offen offset:2048 sc1
    ds_read_b64_tr_b16 v[108:109], v131 offset:40960
    ds_read_b64_tr_b16 v[110:111], v131 offset:41984
    s_waitcnt vmcnt(12) lgkmcnt(10)
    v_mfma_f32_32x32x16_bf16 v[32:47], v[120:123], a[108:111], v[32:47]
    s_lshl_b32 s92, s27, 11
    s_add_u32 s92, s92, s11
    buffer_load_dwordx4 a[28:31], v2, s[60:63], s92 offen offset:3072 sc1
    s_waitcnt lgkmcnt(8)
    v_mfma_f32_32x32x16_bf16 v[48:63], v[124:127], a[108:111], v[48:63]
    v_lshrrev_b32 v20, 3, v1
    v_and_b32 v21, 7, v1
    v_lshlrev_b32 v21, 1, v21
    v_xor_b32 v21, v21, v20
    v_lshlrev_b32 v21, 4, v21
    s_lshl_b32 s93, s69, 3
    v_add_u32 v20, s93, v20
    v_lshl_add_u32 v16, v20, 8, v21
    v_xor_b32 v17, 16, v16
    s_waitcnt vmcnt(11)
    s_waitcnt vmcnt(8)
    s_barrier
    ds_read_b64_tr_b16 v[112:113], v130 offset:57344
    ds_read_b64_tr_b16 v[114:115], v130 offset:58368
    ds_read_b64_tr_b16 v[116:117], v131 offset:57344
    ds_read_b64_tr_b16 v[118:119], v131 offset:58368
    s_waitcnt vmcnt(7) lgkmcnt(10)
    v_mfma_f32_32x32x16_bf16 v[64:79], v[96:99], a[0:3], 0
    ds_read_b64_tr_b16 v[120:121], v140 offset:24576
    ds_read_b64_tr_b16 v[122:123], v140 offset:25600
    s_waitcnt lgkmcnt(10)
    v_mfma_f32_32x32x16_bf16 v[80:95], v[100:103], a[0:3], 0
    ds_write_b128 v14, v[32:35]
    v_xor_b32 v22, 32, v14
    ds_write_b128 v22, v[36:39]
    ds_read_b64_tr_b16 v[124:125], v141 offset:24576
    ds_read_b64_tr_b16 v[126:127], v141 offset:25600
    s_waitcnt vmcnt(6) lgkmcnt(12)
    v_mfma_f32_32x32x16_bf16 v[64:79], v[104:107], a[4:7], v[64:79]
    v_xor_b32 v23, 64, v14
    ds_write_b128 v23, v[40:43]
    v_xor_b32 v22, 0x60, v14
    ds_write_b128 v22, v[44:47]
    ds_read_b64_tr_b16 v[96:97], v128 offset:49152
    ds_read_b64_tr_b16 v[98:99], v128 offset:50176
    s_waitcnt lgkmcnt(14)
    v_mfma_f32_32x32x16_bf16 v[80:95], v[108:111], a[4:7], v[80:95]
    v_xor_b32 v23, 0x80, v14
    ds_write_b128 v23, v[48:51]
    ds_read_b64_tr_b16 v[100:101], v129 offset:49152
    ds_read_b64_tr_b16 v[102:103], v129 offset:50176
    s_waitcnt vmcnt(5) lgkmcnt(15)
    v_mfma_f32_32x32x16_bf16 v[64:79], v[112:115], a[8:11], v[64:79]
    v_xor_b32 v22, 0xa0, v14
    ds_write_b128 v22, v[52:55]
    v_xor_b32 v23, 0xc0, v14
    ds_write_b128 v23, v[56:59]
    ds_read_b64_tr_b16 v[104:105], v130
    ds_read_b64_tr_b16 v[106:107], v130 offset:1024
    s_waitcnt lgkmcnt(15)
    v_mfma_f32_32x32x16_bf16 v[80:95], v[116:119], a[8:11], v[80:95]
    v_xor_b32 v22, 0xe0, v14
    ds_write_b128 v22, v[60:63]
    ds_read_b64_tr_b16 v[108:109], v131
    ds_read_b64_tr_b16 v[110:111], v131 offset:1024
    s_waitcnt vmcnt(4) lgkmcnt(15)
    v_mfma_f32_32x32x16_bf16 v[64:79], v[120:123], a[12:15], v[64:79]
    v_lshrrev_b32 v20, 3, v1
    v_and_b32 v21, 7, v1
    v_xor_b32 v21, v21, v20
    v_lshlrev_b32 v21, 4, v21
    v_lshl_add_u32 v21, v20, 7, v21
    s_lshl_b32 s93, s69, 10
    s_add_u32 s93, s93, 0x1c000
    v_add_u32 v21, s93, v21
    ds_read_b128 v[24:27], v21
    s_waitcnt lgkmcnt(15)
    v_mfma_f32_32x32x16_bf16 v[80:95], v[124:127], a[12:15], v[80:95]
    s_waitcnt lgkmcnt(0)
    s_barrier
    ds_read_b64_tr_b16 v[112:113], v130 offset:16384
    ds_read_b64_tr_b16 v[114:115], v130 offset:17408
    ds_read_b64_tr_b16 v[116:117], v131 offset:16384
    ds_read_b64_tr_b16 v[118:119], v131 offset:17408
    s_waitcnt vmcnt(3)
    v_mfma_f32_32x32x16_bf16 v[64:79], v[96:99], a[16:19], v[64:79]
    v_add_u32 v20, 0, v16
    ds_read_b128 v[32:35], v20
    v_add_u32 v21, 0, v17
    ds_read_b128 v[36:39], v21
    v_add_u32 v20, 0x2000, v16
    ds_read_b128 v[40:43], v20
    v_add_u32 v21, 0x2000, v17
    ds_read_b128 v[44:47], v21
    v_add_u32 v20, 0x4000, v16
    ds_read_b128 v[48:51], v20
    v_add_u32 v21, 0x4000, v17
    ds_read_b128 v[52:55], v21
    v_add_u32 v20, 0x6000, v16
    ds_read_b128 v[56:59], v20
    v_add_u32 v21, 0x6000, v17
    ds_read_b128 v[60:63], v21
    ds_read_b64_tr_b16 v[120:121], v130 offset:32768
    ds_read_b64_tr_b16 v[122:123], v130 offset:33792
    v_mfma_f32_32x32x16_bf16 v[80:95], v[100:103], a[16:19], v[80:95]
    s_waitcnt lgkmcnt(7)
    v_add_f32 v32, v32, v40
    v_add_f32 v33, v33, v41
    v_add_f32 v34, v34, v42
    v_add_f32 v35, v35, v43
    s_waitcnt lgkmcnt(6)
    v_add_f32 v36, v36, v44
    v_add_f32 v37, v37, v45
    v_add_f32 v38, v38, v46
    v_add_f32 v39, v39, v47
    s_waitcnt lgkmcnt(3)
    v_add_f32 v48, v48, v56
    v_add_f32 v49, v49, v57
    v_add_f32 v50, v50, v58
    v_add_f32 v51, v51, v59
    ds_read_b64_tr_b16 v[124:125], v131 offset:32768
    ds_read_b64_tr_b16 v[126:127], v131 offset:33792
    s_waitcnt vmcnt(2)
    v_mfma_f32_32x32x16_bf16 v[64:79], v[104:107], a[20:23], v[64:79]
    s_waitcnt lgkmcnt(4)
    v_add_f32 v52, v52, v60
    v_add_f32 v53, v53, v61
    v_add_f32 v54, v54, v62
    v_add_f32 v55, v55, v63
    v_add_f32 v32, v32, v48
    v_add_f32 v33, v33, v49
    v_add_f32 v34, v34, v50
    v_add_f32 v35, v35, v51
    v_add_f32 v36, v36, v52
    v_add_f32 v37, v37, v53
    v_add_f32 v38, v38, v54
    v_add_f32 v39, v39, v55
    v_mul_f32 v40, s82, v32
    v_mul_f32 v41, s82, v33
    v_mfma_f32_32x32x16_bf16 v[80:95], v[108:111], a[20:23], v[80:95]
    v_mul_f32 v42, s82, v34
    v_mul_f32 v43, s82, v35
    v_mul_f32 v44, s82, v36
    v_mul_f32 v45, s82, v37
    v_mul_f32 v46, s82, v38
    v_mul_f32 v47, s82, v39
    v_exp_f32 v40, v40
    v_exp_f32 v41, v41
    v_exp_f32 v42, v42
    v_exp_f32 v43, v43
    s_waitcnt vmcnt(1)
    v_mfma_f32_32x32x16_bf16 v[64:79], v[112:115], a[24:27], v[64:79]
    v_exp_f32 v44, v44
    v_exp_f32 v45, v45
    v_exp_f32 v46, v46
    v_exp_f32 v47, v47
    v_fma_f32 v40, v40, s83, s83
    v_fma_f32 v41, v41, s83, s83
    v_fma_f32 v42, v42, s83, s83
    v_fma_f32 v43, v43, s83, s83
    v_fma_f32 v44, v44, s83, s83
    v_fma_f32 v45, v45, s83, s83
    v_mfma_f32_32x32x16_bf16 v[80:95], v[116:119], a[24:27], v[80:95]
    v_fma_f32 v46, v46, s83, s83
    v_fma_f32 v47, v47, s83, s83
    v_rcp_f32 v40, v40
    v_rcp_f32 v41, v41
    v_rcp_f32 v42, v42
    v_rcp_f32 v43, v43
    v_rcp_f32 v44, v44
    v_rcp_f32 v45, v45
    s_waitcnt vmcnt(0) lgkmcnt(2)
    v_mfma_f32_32x32x16_bf16 v[64:79], v[120:123], a[28:31], v[64:79]
    v_rcp_f32 v46, v46
    v_rcp_f32 v47, v47
    v_mul_f32 v32, v32, v40
    v_mul_f32 v33, v33, v41
    v_mul_f32 v34, v34, v42
    v_mul_f32 v35, v35, v43
    v_mul_f32 v36, v36, v44
    v_mul_f32 v37, v37, v45
    v_mul_f32 v38, v38, v46
    v_mul_f32 v39, v39, v47
    v_lshlrev_b32 v48, 16, v24
    v_and_b32 v49, s81, v24
    v_lshlrev_b32 v50, 16, v25
    s_waitcnt lgkmcnt(0)
    v_mfma_f32_32x32x16_bf16 v[80:95], v[124:127], a[28:31], v[80:95]
    v_and_b32 v51, s81, v25
    v_lshlrev_b32 v52, 16, v26
    v_and_b32 v53, s81, v26
    v_lshlrev_b32 v54, 16, v27
    v_and_b32 v55, s81, v27
    v_and_b32 v20, 7, v1
    v_lshrrev_b32 v21, 5, v1
    v_xor_b32 v21, v21, v20
    v_lshlrev_b32 v21, 4, v21
    v_and_b32 v20, 31, v1
    v_lshl_add_u32 v21, v20, 8, v21
    s_mov_b32 s94, 0x1c000
    s_cmp_eq_u32 s69, 1
    s_cselect_b32 s94, 0x20000, s94
    s_cmp_eq_u32 s69, 2
    s_cselect_b32 s94, 0x22000, s94
    s_cmp_eq_u32 s69, 3
    s_cselect_b32 s94, 0x24000, s94
    v_add_u32 v15, s94, v21
    ds_write_b128 v15, v[64:67]
    v_xor_b32 v22, 32, v15
    ds_write_b128 v22, v[68:71]
    v_xor_b32 v23, 64, v15
    ds_write_b128 v23, v[72:75]
    v_xor_b32 v22, 0x60, v15
    ds_write_b128 v22, v[76:79]
    v_xor_b32 v23, 0x80, v15
    ds_write_b128 v23, v[80:83]
    v_xor_b32 v22, 0xa0, v15
    ds_write_b128 v22, v[84:87]
    v_xor_b32 v23, 0xc0, v15
    ds_write_b128 v23, v[88:91]
    v_xor_b32 v22, 0xe0, v15
    ds_write_b128 v22, v[92:95]
    s_waitcnt lgkmcnt(0)
    s_barrier
    v_add_u32 v20, 0x1c000, v16
    ds_read_b128 v[96:99], v20
    v_add_u32 v21, 0x1c000, v17
    ds_read_b128 v[100:103], v21
    v_add_u32 v20, 0x20000, v16
    ds_read_b128 v[104:107], v20
    v_add_u32 v21, 0x20000, v17
    ds_read_b128 v[108:111], v21
    v_add_u32 v20, 0x22000, v16
    ds_read_b128 v[112:115], v20
    v_add_u32 v21, 0x22000, v17
    ds_read_b128 v[116:119], v21
    v_add_u32 v20, 0x24000, v16
    ds_read_b128 v[120:123], v20
    v_add_u32 v21, 0x24000, v17
    ds_read_b128 v[124:127], v21
    s_waitcnt lgkmcnt(5)
    v_add_f32 v96, v96, v104
    v_add_f32 v97, v97, v105
    v_add_f32 v98, v98, v106
    v_add_f32 v99, v99, v107
    s_waitcnt lgkmcnt(4)
    v_add_f32 v100, v100, v108
    v_add_f32 v101, v101, v109
    v_add_f32 v102, v102, v110
    v_add_f32 v103, v103, v111
    s_waitcnt lgkmcnt(1)
    v_add_f32 v112, v112, v120
    v_add_f32 v113, v113, v121
    v_add_f32 v114, v114, v122
    v_add_f32 v115, v115, v123
    s_waitcnt lgkmcnt(0)
    v_add_f32 v116, v116, v124
    v_add_f32 v117, v117, v125
    v_add_f32 v118, v118, v126
    v_add_f32 v119, v119, v127
    v_add_f32 v96, v96, v112
    v_add_f32 v97, v97, v113
    v_add_f32 v98, v98, v114
    v_add_f32 v99, v99, v115
    v_add_f32 v100, v100, v116
    v_add_f32 v101, v101, v117
    v_add_f32 v102, v102, v118
    v_add_f32 v103, v103, v119
    v_fma_f32 v96, v96, v32, v48
    v_fma_f32 v97, v97, v33, v49
    v_fma_f32 v98, v98, v34, v50
    v_fma_f32 v99, v99, v35, v51
    v_fma_f32 v100, v100, v36, v52
    v_fma_f32 v101, v101, v37, v53
    v_fma_f32 v102, v102, v38, v54
    v_fma_f32 v103, v103, v39, v55
    v_cvt_pk_bf16_f32 v64, v96, v97
    v_cvt_pk_bf16_f32 v65, v98, v99
    v_cvt_pk_bf16_f32 v66, v100, v101
    v_cvt_pk_bf16_f32 v67, v102, v103
    buffer_store_dwordx4 v[64:67], v8, s[56:59], 0 offen
L_fin_1011:
    s_endpgm
.p2align 3
L_PROG1:
    s_waitcnt vmcnt(3)
    v_dot2c_f32_bf16 v128, s84, v44
    v_dot2c_f32_bf16 v130, v44, v44
    s_waitcnt vmcnt(2)
    v_dot2c_f32_bf16 v129, s84, v72
    s_mul_i32 s92, s74, 0x2a000
    s_add_u32 m0, s87, 0xc000
    s_add_u32 s92, s92, 0x380
    buffer_load_dwordx4 v9, s[32:35], s92 offen lds
    v_dot2c_f32_bf16 v131, v72, v72
    v_dot2c_f32_bf16 v128, s84, v45
    v_dot2c_f32_bf16 v130, v45, v45
    v_dot2c_f32_bf16 v129, s84, v73
    s_mul_i32 s92, s74, 0x2a000
    s_add_u32 m0, s87, 0xe000
    s_add_u32 s92, s92, 0x700
    buffer_load_dwordx4 v9, s[32:35], s92 offen lds
    v_dot2c_f32_bf16 v131, v73, v73
    v_dot2c_f32_bf16 v128, s84, v46
    v_dot2c_f32_bf16 v130, v46, v46
    v_dot2c_f32_bf16 v129, s84, v74
    v_dot2c_f32_bf16 v131, v74, v74
    s_and_b32 s93, s68, 3
    s_lshl_b32 s27, s93, 10
    v_add_u32 v22, s27, v2
    s_mul_i32 s92, s72, 0xc40
    s_add_u32 m0, s27, 0x8000
    s_nop 0
    buffer_load_dwordx4 v22, s[52:55], s92 offen lds
    v_dot2c_f32_bf16 v128, s84, v47
    v_dot2c_f32_bf16 v130, v47, v47
    v_dot2c_f32_bf16 v129, s84, v75
    v_dot2c_f32_bf16 v131, v75, v75
    s_mul_i32 s93, s72, 0x1c0
    s_bitcmp1_b32 s72, 0
    s_cselect_b32 s88, 64, 0x100
    s_cselect_b32 s89, 0, 0x180
    s_add_u32 s88, s88, s93
    s_add_u32 s89, s89, s93
    s_waitcnt vmcnt(4)
    v_dot2c_f32_bf16 v128, s84, v48
    v_dot2c_f32_bf16 v130, v48, v48
    s_waitcnt vmcnt(3)
    v_dot2c_f32_bf16 v129, s84, v76
    v_dot2c_f32_bf16 v131, v76, v76
    v_dot2c_f32_bf16 v128, s84, v49
    s_sub_u32 s93, s91, 0x920000
    s_lshl_b32 s93, s93, 2
    s_add_u32 s16, s93, 0x930000
    v_dot2c_f32_bf16 v130, v49, v49
    v_dot2c_f32_bf16 v129, s84, v77
    v_dot2c_f32_bf16 v131, v77, v77
    v_dot2c_f32_bf16 v128, s84, v50
    v_dot2c_f32_bf16 v130, v50, v50
    v_dot2c_f32_bf16 v129, s84, v78
    v_dot2c_f32_bf16 v131, v78, v78
    v_dot2c_f32_bf16 v128, s84, v51
    v_dot2c_f32_bf16 v130, v51, v51
    s_cmp_eq_u32 s70, 0
    s_cselect_b32 s4, s36, s40
    s_cselect_b32 s5, s37, s41
    s_cselect_b32 s6, s38, s42
    s_mov_b32 s7, 0x20000
    v_dot2c_f32_bf16 v129, s84, v79
    v_dot2c_f32_bf16 v131, v79, v79
    v_add_f32_dpp v128, v128, v128 quad_perm:[1,0,3,2] row_mask:0xf bank_mask:0xf
    v_add_f32_dpp v130, v130, v130 quad_perm:[1,0,3,2] row_mask:0xf bank_mask:0xf
    v_add_f32_dpp v129, v129, v129 quad_perm:[1,0,3,2] row_mask:0xf bank_mask:0xf
    v_add_f32_dpp v131, v131, v131 quad_perm:[1,0,3,2] row_mask:0xf bank_mask:0xf
    v_add_f32_dpp v128, v128, v128 quad_perm:[2,3,0,1] row_mask:0xf bank_mask:0xf
    v_add_f32_dpp v130, v130, v130 quad_perm:[2,3,0,1] row_mask:0xf bank_mask:0xf
    v_add_f32_dpp v129, v129, v129 quad_perm:[2,3,0,1] row_mask:0xf bank_mask:0xf
    v_add_f32_dpp v131, v131, v131 quad_perm:[2,3,0,1] row_mask:0xf bank_mask:0xf
    v_add_f32_dpp v128, v128, v128 row_half_mirror row_mask:0xf bank_mask:0xf
    v_add_f32_dpp v130, v130, v130 row_half_mirror row_mask:0xf bank_mask:0xf
    v_add_f32_dpp v129, v129, v129 row_half_mirror row_mask:0xf bank_mask:0xf
    v_add_f32_dpp v131, v131, v131 row_half_mirror row_mask:0xf bank_mask:0xf
    v_mul_f32 v128, 0xbb124925, v128
    v_mul_f32 v130, 0x3b124925, v130
    v_mul_f32 v129, 0xbb124925, v129
    v_mul_f32 v131, 0x3b124925, v131
    v_fma_f32 v130, -v128, v128, v130
    v_fma_f32 v131, -v129, v129, v131
    v_max_f32 v130, 0, v130
    v_max_f32 v131, 0, v131
    v_add_f32 v130, 0x3727c5ac, v130
    v_add_f32 v131, 0x3727c5ac, v131
    v_rsq_f32 v130, v130
    v_rsq_f32 v131, v131
    s_nop 0
    v_mul_f32 v130, 0xbfb8aa3b, v130
    v_mul_f32 v131, 0xbfb8aa3b, v131
    v_mul_f32 v128, v128, v130
    v_mul_f32 v129, v129, v131
    v_lshlrev_b32 v120, 16, v24
    v_and_b32 v121, s81, v24
    v_lshlrev_b32 v122, 16, v25
    v_and_b32 v123, s81, v25
    v_lshlrev_b32 v124, 16, v26
    v_and_b32 v125, s81, v26
    v_lshlrev_b32 v126, 16, v27
    v_and_b32 v127, s81, v27
    v_fma_f32 v120, v120, v130, v128
    v_fma_f32 v121, v121, v130, v128
    v_fma_f32 v122, v122, v130, v128
    v_fma_f32 v123, v123, v130, v128
    v_fma_f32 v124, v124, v130, v128
    v_fma_f32 v125, v125, v130, v128
    v_fma_f32 v126, v126, v130, v128
    v_fma_f32 v127, v127, v130, v128
    v_cvt_pk_bf16_f32 v24, v120, v121
    v_cvt_pk_bf16_f32 v25, v122, v123
    v_cvt_pk_bf16_f32 v26, v124, v125
    v_cvt_pk_bf16_f32 v27, v126, v127
    ds_write_b128 v3, v[24:27]
    v_lshlrev_b32 v120, 16, v52
    v_and_b32 v121, s81, v52
    v_lshlrev_b32 v122, 16, v53
    v_and_b32 v123, s81, v53
    v_lshlrev_b32 v124, 16, v54
    v_and_b32 v125, s81, v54
    v_lshlrev_b32 v126, 16, v55
    v_and_b32 v127, s81, v55
    v_fma_f32 v120, v120, v131, v129
    v_fma_f32 v121, v121, v131, v129
    v_fma_f32 v122, v122, v131, v129
    v_fma_f32 v123, v123, v131, v129
    v_fma_f32 v124, v124, v131, v129
    v_fma_f32 v125, v125, v131, v129
    v_fma_f32 v126, v126, v131, v129
    v_fma_f32 v127, v127, v131, v129
    v_cvt_pk_bf16_f32 v52, v120, v121
    v_cvt_pk_bf16_f32 v53, v122, v123
    v_cvt_pk_bf16_f32 v54, v124, v125
    v_cvt_pk_bf16_f32 v55, v126, v127
    ds_write_b128 v3, v[52:55] offset:128
    s_waitcnt lgkmcnt(0)
    s_barrier
    ds_read_b128 a[0:3], v4
    ds_read_b128 a[4:7], v5
    ds_read_b128 a[8:11], v6
    ds_read_b128 a[12:15], v7
    v_lshlrev_b32 v120, 16, v28
    v_and_b32 v121, s81, v28
    v_lshlrev_b32 v122, 16, v29
    v_and_b32 v123, s81, v29
    v_lshlrev_b32 v124, 16, v30
    v_and_b32 v125, s81, v30
    v_lshlrev_b32 v126, 16, v31
    v_and_b32 v127, s81, v31
    v_fma_f32 v120, v120, v130, v128
    v_fma_f32 v121, v121, v130, v128
    v_fma_f32 v122, v122, v130, v128
    v_fma_f32 v123, v123, v130, v128
    v_fma_f32 v124, v124, v130, v128
    v_fma_f32 v125, v125, v130, v128
    v_fma_f32 v126, v126, v130, v128
    v_fma_f32 v127, v127, v130, v128
    v_cvt_pk_bf16_f32 v28, v120, v121
    v_cvt_pk_bf16_f32 v29, v122, v123
    v_cvt_pk_bf16_f32 v30, v124, v125
    v_cvt_pk_bf16_f32 v31, v126, v127
    ds_write_b128 v3, v[28:31] offset:16384
    v_lshlrev_b32 v120, 16, v56
    s_mul_i32 s92, s75, 0x2a000
    s_add_u32 m0, s87, 0x10000
    s_add_u32 s92, s92, 0x380
    buffer_load_dwordx4 v9, s[32:35], s92 offen lds
    v_and_b32 v121, s81, v56
    v_lshlrev_b32 v122, 16, v57
    v_and_b32 v123, s81, v57
    v_lshlrev_b32 v124, 16, v58
    v_and_b32 v125, s81, v58
    v_lshlrev_b32 v126, 16, v59
    v_and_b32 v127, s81, v59
    v_fma_f32 v120, v120, v131, v129
    v_fma_f32 v121, v121, v131, v129
    v_fma_f32 v122, v122, v131, v129
    v_fma_f32 v123, v123, v131, v129
    v_fma_f32 v124, v124, v131, v129
    v_fma_f32 v125, v125, v131, v129
    v_fma_f32 v126, v126, v131, v129
    v_fma_f32 v127, v127, v131, v129
    v_cvt_pk_bf16_f32 v56, v120, v121
    v_cvt_pk_bf16_f32 v57, v122, v123
    v_cvt_pk_bf16_f32 v58, v124, v125
    s_mul_i32 s92, s75, 0x2a000
    s_add_u32 m0, s87, 0x12000
    s_add_u32 s92, s92, 0x700
    buffer_load_dwordx4 v9, s[32:35], s92 offen lds
    v_cvt_pk_bf16_f32 v59, v126, v127
    ds_write_b128 v3, v[56:59] offset:16512
    s_waitcnt vmcnt(2)
    s_waitcnt lgkmcnt(0)
    s_barrier
    ds_read_b64_tr_b16 v[132:133], v143
    ds_read_b64_tr_b16 v[134:135], v143 offset:448
    ds_read_b64_tr_b16 v[136:137], v143 offset:896
    ds_read_b64_tr_b16 v[138:139], v143 offset:1344
    v_add_u32 v22, 0xc000, v8
    ds_read_b64_tr_b16 v[112:113], v22
    ds_read_b64_tr_b16 v[114:115], v22 offset:512
    ds_read_b64_tr_b16 v[116:117], v22 offset:8192
    ds_read_b64_tr_b16 v[118:119], v22 offset:8704
    ds_read_b64_tr_b16 v[24:25], v22 offset:2048
    ds_read_b64_tr_b16 v[26:27], v22 offset:2560
    ds_read_b64_tr_b16 v[52:53], v22 offset:10240
    ds_read_b64_tr_b16 v[54:55], v22 offset:10752
    s_waitcnt lgkmcnt(6)
    v_mfma_f32_32x32x16_bf16 v[80:95], v[112:115], a[0:3], 0
    ds_read_b128 a[16:19], v4 offset:16384
    ds_read_b128 a[20:23], v5 offset:16384
    ds_read_b128 a[24:27], v6 offset:16384
    ds_read_b128 a[28:31], v7 offset:16384
    v_lshlrev_b32 v120, 16, v32
    v_and_b32 v121, s81, v32
    v_lshlrev_b32 v122, 16, v33
    v_and_b32 v123, s81, v33
    ds_read_b64_tr_b16 v[112:113], v22 offset:4096
    ds_read_b64_tr_b16 v[114:115], v22 offset:4608
    s_waitcnt lgkmcnt(10)
    v_mfma_f32_32x32x16_bf16 v[96:111], v[116:119], a[0:3], 0
    v_lshlrev_b32 v124, 16, v34
    v_and_b32 v125, s81, v34
    v_lshlrev_b32 v126, 16, v35
    v_and_b32 v127, s81, v35
    v_fma_f32 v120, v120, v130, v128
    v_fma_f32 v121, v121, v130, v128
    v_fma_f32 v122, v122, v130, v128
    v_fma_f32 v123, v123, v130, v128
    ds_read_b64_tr_b16 v[116:117], v22 offset:12288
    ds_read_b64_tr_b16 v[118:119], v22 offset:12800
    s_waitcnt lgkmcnt(10)
    v_mfma_f32_32x32x16_bf16 v[80:95], v[24:27], a[4:7], v[80:95]
    v_fma_f32 v124, v124, v130, v128
    v_fma_f32 v125, v125, v130, v128
    v_fma_f32 v126, v126, v130, v128
    v_fma_f32 v127, v127, v130, v128
    v_cvt_pk_bf16_f32 v32, v120, v121
    v_cvt_pk_bf16_f32 v33, v122, v123
    v_cvt_pk_bf16_f32 v34, v124, v125
    v_cvt_pk_bf16_f32 v35, v126, v127
    ds_read_b64_tr_b16 v[24:25], v22 offset:6144
    ds_read_b64_tr_b16 v[26:27], v22 offset:6656
    s_waitcnt lgkmcnt(10)
    v_mfma_f32_32x32x16_bf16 v[96:111], v[52:55], a[4:7], v[96:111]
    ds_write_b128 v3, v[32:35]
    s_mul_i32 s92, s76, 0x2a000
    s_add_u32 m0, s87, 0x14000
    s_add_u32 s92, s92, 0x380
    buffer_load_dwordx4 v9, s[32:35], s92 offen lds
    v_lshlrev_b32 v120, 16, v60
    v_and_b32 v121, s81, v60
    v_lshlrev_b32 v122, 16, v61
    ds_read_b64_tr_b16 v[52:53], v22 offset:14336
    ds_read_b64_tr_b16 v[54:55], v22 offset:14848
    s_waitcnt lgkmcnt(7)
    v_mfma_f32_32x32x16_bf16 v[80:95], v[112:115], a[8:11], v[80:95]
    v_and_b32 v123, s81, v61
    v_lshlrev_b32 v124, 16, v62
    v_and_b32 v125, s81, v62
    v_lshlrev_b32 v126, 16, v63
    s_mul_i32 s92, s76, 0x2a000
    s_add_u32 m0, s87, 0x16000
    s_add_u32 s92, s92, 0x700
    buffer_load_dwordx4 v9, s[32:35], s92 offen lds
    s_waitcnt lgkmcnt(5)
    v_mfma_f32_32x32x16_bf16 v[96:111], v[116:119], a[8:11], v[96:111]
    v_and_b32 v127, s81, v63
    v_fma_f32 v120, v120, v131, v129
    v_fma_f32 v121, v121, v131, v129
    v_fma_f32 v122, v122, v131, v129
    v_fma_f32 v123, v123, v131, v129
    v_fma_f32 v124, v124, v131, v129
    v_fma_f32 v125, v125, v131, v129
    s_waitcnt lgkmcnt(3)
    v_mfma_f32_32x32x16_bf16 v[80:95], v[24:27], a[12:15], v[80:95]
    s_mul_i32 s92, s77, 0x2a000
    s_add_u32 m0, s87, 0x18000
    s_add_u32 s92, s92, 0x380
    buffer_load_dwordx4 v9, s[32:35], s92 offen lds
    v_fma_f32 v126, v126, v131, v129
    v_fma_f32 v127, v127, v131, v129
    v_cvt_pk_bf16_f32 v60, v120, v121
    v_cvt_pk_bf16_f32 v61, v122, v123
    v_cvt_pk_bf16_f32 v62, v124, v125
    s_waitcnt lgkmcnt(0)
    v_mfma_f32_32x32x16_bf16 v[96:111], v[52:55], a[12:15], v[96:111]
    v_cvt_pk_bf16_f32 v63, v126, v127
    ds_write_b128 v3, v[60:63] offset:128
    s_mul_i32 s92, s77, 0x2a000
    s_add_u32 m0, s87, 0x1a000
    s_add_u32 s92, s92, 0x700
    buffer_load_dwordx4 v9, s[32:35], s92 offen lds
    v_and_b32 v138, v16, v138
    v_and_b32 v139, v16, v139
    s_waitcnt vmcnt(4)
    s_waitcnt lgkmcnt(0)
    s_barrier
    v_add_u32 v23, 0x10000, v8
    ds_read_b64_tr_b16 v[112:113], v23
    ds_read_b64_tr_b16 v[114:115], v23 offset:512
    ds_read_b64_tr_b16 v[116:117], v23 offset:8192
    ds_read_b64_tr_b16 v[118:119], v23 offset:8704
    ds_read_b64_tr_b16 v[24:25], v23 offset:2048
    ds_read_b64_tr_b16 v[26:27], v23 offset:2560
    ds_read_b64_tr_b16 v[52:53], v23 offset:10240
    ds_read_b64_tr_b16 v[54:55], v23 offset:10752
    s_waitcnt lgkmcnt(6)
    v_mfma_f32_32x32x16_bf16 v[80:95], v[112:115], a[16:19], v[80:95]
    ds_read_b128 a[32:35], v4
    ds_read_b128 a[36:39], v5
    ds_read_b128 a[40:43], v6
    ds_read_b128 a[44:47], v7
    v_lshlrev_b32 v120, 16, v36
    v_and_b32 v121, s81, v36
    v_lshlrev_b32 v122, 16, v37
    ds_read_b64_tr_b16 v[112:113], v23 offset:4096
    ds_read_b64_tr_b16 v[114:115], v23 offset:4608
    s_waitcnt lgkmcnt(10)
    v_mfma_f32_32x32x16_bf16 v[96:111], v[116:119], a[16:19], v[96:111]
    v_and_b32 v123, s81, v37
    v_lshlrev_b32 v124, 16, v38
    v_and_b32 v125, s81, v38
    v_lshlrev_b32 v126, 16, v39
    v_and_b32 v127, s81, v39
    v_fma_f32 v120, v120, v130, v128
    ds_read_b64_tr_b16 v[116:117], v23 offset:12288
    ds_read_b64_tr_b16 v[118:119], v23 offset:12800
    s_waitcnt lgkmcnt(10)
    v_mfma_f32_32x32x16_bf16 v[80:95], v[24:27], a[20:23], v[80:95]
    v_fma_f32 v121, v121, v130, v128
    v_fma_f32 v122, v122, v130, v128
    v_fma_f32 v123, v123, v130, v128
    v_fma_f32 v124, v124, v130, v128
    v_fma_f32 v125, v125, v130, v128
    v_fma_f32 v126, v126, v130, v128
    v_fma_f32 v127, v127, v130, v128
    ds_read_b64_tr_b16 v[24:25], v23 offset:6144
    ds_read_b64_tr_b16 v[26:27], v23 offset:6656
    s_waitcnt lgkmcnt(10)
    v_mfma_f32_32x32x16_bf16 v[96:111], v[52:55], a[20:23], v[96:111]
    v_cvt_pk_bf16_f32 v36, v120, v121
    v_cvt_pk_bf16_f32 v37, v122, v123
    v_cvt_pk_bf16_f32 v38, v124, v125
    v_cvt_pk_bf16_f32 v39, v126, v127
    s_mul_i32 s92, s78, 0x2a000
    s_add_u32 m0, s87, 0x1c000
    s_add_u32 s92, s92, 0x380
    buffer_load_dwordx4 v9, s[32:35], s92 offen lds
    ds_read_b64_tr_b16 v[52:53], v23 offset:14336
    ds_read_b64_tr_b16 v[54:55], v23 offset:14848
    s_waitcnt lgkmcnt(6)
    v_mfma_f32_32x32x16_bf16 v[80:95], v[112:115], a[24:27], v[80:95]
    ds_write_b128 v3, v[36:39] offset:16384
    v_lshlrev_b32 v120, 16, v64
    v_and_b32 v121, s81, v64
    v_lshlrev_b32 v122, 16, v65
    v_and_b32 v123, s81, v65
    v_lshlrev_b32 v124, 16, v66
    s_waitcnt lgkmcnt(5)
    v_mfma_f32_32x32x16_bf16 v[96:111], v[116:119], a[24:27], v[96:111]
    v_and_b32 v125, s81, v66
    v_lshlrev_b32 v126, 16, v67
    v_and_b32 v127, s81, v67
    v_fma_f32 v120, v120, v131, v129
    v_fma_f32 v121, v121, v131, v129
    v_fma_f32 v122, v122, v131, v129
    s_waitcnt lgkmcnt(3)
    v_mfma_f32_32x32x16_bf16 v[80:95], v[24:27], a[28:31], v[80:95]
    v_fma_f32 v123, v123, v131, v129
    v_fma_f32 v124, v124, v131, v129
    v_fma_f32 v125, v125, v131, v129
    v_fma_f32 v126, v126, v131, v129
    v_fma_f32 v127, v127, v131, v129
    v_cvt_pk_bf16_f32 v64, v120, v121
    v_cvt_pk_bf16_f32 v65, v122, v123
    s_waitcnt lgkmcnt(1)
    v_mfma_f32_32x32x16_bf16 v[96:111], v[52:55], a[28:31], v[96:111]
    v_cvt_pk_bf16_f32 v66, v124, v125
    s_mul_i32 s92, s78, 0x2a000
    s_add_u32 m0, s87, 0x1e000
    s_add_u32 s92, s92, 0x700
    buffer_load_dwordx4 v9, s[32:35], s92 offen lds
    v_cvt_pk_bf16_f32 v67, v126, v127
    ds_write_b128 v3, v[64:67] offset:16512
    s_waitcnt vmcnt(4)
    s_waitcnt vmcnt(2)
    s_waitcnt lgkmcnt(0)
    s_barrier
    v_add_u32 v22, 0x14000, v8
    ds_read_b64_tr_b16 v[112:113], v22
    ds_read_b64_tr_b16 v[114:115], v22 offset:512
    ds_read_b64_tr_b16 v[116:117], v22 offset:8192
    ds_read_b64_tr_b16 v[118:119], v22 offset:8704
    ds_read_b64_tr_b16 v[24:25], v22 offset:2048
    ds_read_b64_tr_b16 v[26:27], v22 offset:2560
    ds_read_b64_tr_b16 v[52:53], v22 offset:10240
    ds_read_b64_tr_b16 v[54:55], v22 offset:10752
    s_waitcnt lgkmcnt(6)
    v_mfma_f32_32x32x16_bf16 v[80:95], v[112:115], a[32:35], v[80:95]
    ds_read_b128 a[48:51], v4 offset:16384
    ds_read_b128 a[52:55], v5 offset:16384
    ds_read_b128 a[56:59], v6 offset:16384
    ds_read_b128 a[60:63], v7 offset:16384
    v_lshlrev_b32 v120, 16, v40
    v_and_b32 v121, s81, v40
    v_lshlrev_b32 v122, 16, v41
    ds_read_b64_tr_b16 v[112:113], v22 offset:4096
    ds_read_b64_tr_b16 v[114:115], v22 offset:4608
    s_waitcnt lgkmcnt(10)
    v_mfma_f32_32x32x16_bf16 v[96:111], v[116:119], a[32:35], v[96:111]
    v_and_b32 v123, s81, v41
    v_lshlrev_b32 v124, 16, v42
    v_and_b32 v125, s81, v42
    v_lshlrev_b32 v126, 16, v43
    v_and_b32 v127, s81, v43
    v_fma_f32 v120, v120, v130, v128
    ds_read_b64_tr_b16 v[116:117], v22 offset:12288
    ds_read_b64_tr_b16 v[118:119], v22 offset:12800
    s_waitcnt lgkmcnt(10)
    v_mfma_f32_32x32x16_bf16 v[80:95], v[24:27], a[36:39], v[80:95]
    v_fma_f32 v121, v121, v130, v128
    v_fma_f32 v122, v122, v130, v128
    v_fma_f32 v123, v123, v130, v128
    v_fma_f32 v124, v124, v130, v128
    v_fma_f32 v125, v125, v130, v128
    v_fma_f32 v126, v126, v130, v128
    v_fma_f32 v127, v127, v130, v128
    ds_read_b64_tr_b16 v[24:25], v22 offset:6144
    ds_read_b64_tr_b16 v[26:27], v22 offset:6656
    s_waitcnt lgkmcnt(10)
    v_mfma_f32_32x32x16_bf16 v[96:111], v[52:55], a[36:39], v[96:111]
    v_cvt_pk_bf16_f32 v40, v120, v121
    v_cvt_pk_bf16_f32 v41, v122, v123
    v_cvt_pk_bf16_f32 v42, v124, v125
    v_cvt_pk_bf16_f32 v43, v126, v127
    s_mul_i32 s92, s79, 0x2a000
    s_add_u32 m0, s87, 0x20000
    s_add_u32 s92, s92, 0x380
    buffer_load_dwordx4 v9, s[32:35], s92 offen lds
    ds_read_b64_tr_b16 v[52:53], v22 offset:14336
    ds_read_b64_tr_b16 v[54:55], v22 offset:14848
    s_waitcnt lgkmcnt(6)
    v_mfma_f32_32x32x16_bf16 v[80:95], v[112:115], a[40:43], v[80:95]
    ds_write_b128 v3, v[40:43]
    v_lshlrev_b32 v120, 16, v68
    v_and_b32 v121, s81, v68
    v_lshlrev_b32 v122, 16, v69
    v_and_b32 v123, s81, v69
    v_lshlrev_b32 v124, 16, v70
    v_add_u32 v23, 0x18000, v8
    ds_read_b64_tr_b16 v[112:113], v23
    ds_read_b64_tr_b16 v[114:115], v23 offset:512
    s_waitcnt lgkmcnt(7)
    v_mfma_f32_32x32x16_bf16 v[96:111], v[116:119], a[40:43], v[96:111]
    v_and_b32 v125, s81, v70
    v_lshlrev_b32 v126, 16, v71
    v_and_b32 v127, s81, v71
    v_fma_f32 v120, v120, v131, v129
    v_fma_f32 v121, v121, v131, v129
    v_fma_f32 v122, v122, v131, v129
    ds_read_b64_tr_b16 v[116:117], v23 offset:8192
    ds_read_b64_tr_b16 v[118:119], v23 offset:8704
    s_waitcnt lgkmcnt(7)
    v_mfma_f32_32x32x16_bf16 v[80:95], v[24:27], a[44:47], v[80:95]
    v_fma_f32 v123, v123, v131, v129
    v_fma_f32 v124, v124, v131, v129
    v_fma_f32 v125, v125, v131, v129
    v_fma_f32 v126, v126, v131, v129
    v_fma_f32 v127, v127, v131, v129
    v_cvt_pk_bf16_f32 v68, v120, v121
    v_cvt_pk_bf16_f32 v69, v122, v123
    ds_read_b64_tr_b16 v[24:25], v23 offset:2048
    ds_read_b64_tr_b16 v[26:27], v23 offset:2560
    s_waitcnt lgkmcnt(7)
    v_mfma_f32_32x32x16_bf16 v[96:111], v[52:55], a[44:47], v[96:111]
    v_cvt_pk_bf16_f32 v70, v124, v125
    s_mul_i32 s92, s79, 0x2a000
    s_add_u32 m0, s87, 0x22000
    s_add_u32 s92, s92, 0x700
    buffer_load_dwordx4 v9, s[32:35], s92 offen lds
    v_cvt_pk_bf16_f32 v71, v126, v127
    ds_write_b128 v3, v[68:71] offset:128
    s_waitcnt vmcnt(2)
    s_waitcnt lgkmcnt(0)
    s_barrier
    ds_read_b64_tr_b16 v[52:53], v23 offset:10240
    ds_read_b64_tr_b16 v[54:55], v23 offset:10752
    v_mfma_f32_32x32x16_bf16 v[80:95], v[112:115], a[48:51], v[80:95]
    ds_read_b128 a[64:67], v4
    ds_read_b128 a[68:71], v5
    ds_read_b128 a[72:75], v6
    ds_read_b128 a[76:79], v7
    v_lshlrev_b32 v120, 16, v44
    v_and_b32 v121, s81, v44
    v_lshlrev_b32 v122, 16, v45
    ds_read_b64_tr_b16 v[112:113], v23 offset:4096
    ds_read_b64_tr_b16 v[114:115], v23 offset:4608
    v_mfma_f32_32x32x16_bf16 v[96:111], v[116:119], a[48:51], v[96:111]
    v_and_b32 v123, s81, v45
    v_lshlrev_b32 v124, 16, v46
    v_and_b32 v125, s81, v46
    v_lshlrev_b32 v126, 16, v47
    v_and_b32 v127, s81, v47
    v_fma_f32 v120, v120, v130, v128
    ds_read_b64_tr_b16 v[116:117], v23 offset:12288
    ds_read_b64_tr_b16 v[118:119], v23 offset:12800
    v_mfma_f32_32x32x16_bf16 v[80:95], v[24:27], a[52:55], v[80:95]
    v_fma_f32 v121, v121, v130, v128
    v_fma_f32 v122, v122, v130, v128
    v_fma_f32 v123, v123, v130, v128
    v_fma_f32 v124, v124, v130, v128
    v_fma_f32 v125, v125, v130, v128
    v_fma_f32 v126, v126, v130, v128
    v_fma_f32 v127, v127, v130, v128
    ds_read_b64_tr_b16 v[24:25], v23 offset:6144
    ds_read_b64_tr_b16 v[26:27], v23 offset:6656
    s_waitcnt lgkmcnt(10)
    v_mfma_f32_32x32x16_bf16 v[96:111], v[52:55], a[52:55], v[96:111]
    v_cvt_pk_bf16_f32 v44, v120, v121
    v_cvt_pk_bf16_f32 v45, v122, v123
    v_cvt_pk_bf16_f32 v46, v124, v125
    v_cvt_pk_bf16_f32 v47, v126, v127
    s_mul_i32 s92, s80, 0x2a000
    s_add_u32 m0, s87, 0x24000
    s_add_u32 s92, s92, 0x380
    buffer_load_dwordx4 v9, s[32:35], s92 offen lds
    ds_read_b64_tr_b16 v[52:53], v23 offset:14336
    ds_read_b64_tr_b16 v[54:55], v23 offset:14848
    s_waitcnt lgkmcnt(6)
    v_mfma_f32_32x32x16_bf16 v[80:95], v[112:115], a[56:59], v[80:95]
    ds_write_b128 v3, v[44:47] offset:16384
    v_lshlrev_b32 v120, 16, v72
    v_and_b32 v121, s81, v72
    v_lshlrev_b32 v122, 16, v73
    v_and_b32 v123, s81, v73
    v_lshlrev_b32 v124, 16, v74
    v_add_u32 v22, 0x1c000, v8
    ds_read_b64_tr_b16 v[112:113], v22
    ds_read_b64_tr_b16 v[114:115], v22 offset:512
    s_waitcnt lgkmcnt(7)
    v_mfma_f32_32x32x16_bf16 v[96:111], v[116:119], a[56:59], v[96:111]
    v_and_b32 v125, s81, v74
    v_lshlrev_b32 v126, 16, v75
    v_and_b32 v127, s81, v75
    v_fma_f32 v120, v120, v131, v129
    v_fma_f32 v121, v121, v131, v129
    v_fma_f32 v122, v122, v131, v129
    ds_read_b64_tr_b16 v[116:117], v22 offset:8192
    ds_read_b64_tr_b16 v[118:119], v22 offset:8704
    s_waitcnt lgkmcnt(7)
    v_mfma_f32_32x32x16_bf16 v[80:95], v[24:27], a[60:63], v[80:95]
    v_fma_f32 v123, v123, v131, v129
    v_fma_f32 v124, v124, v131, v129
    v_fma_f32 v125, v125, v131, v129
    v_fma_f32 v126, v126, v131, v129
    v_fma_f32 v127, v127, v131, v129
    v_cvt_pk_bf16_f32 v72, v120, v121
    v_cvt_pk_bf16_f32 v73, v122, v123
    ds_read_b64_tr_b16 v[24:25], v22 offset:2048
    ds_read_b64_tr_b16 v[26:27], v22 offset:2560
    s_waitcnt lgkmcnt(7)
    v_mfma_f32_32x32x16_bf16 v[96:111], v[52:55], a[60:63], v[96:111]
    v_cvt_pk_bf16_f32 v74, v124, v125
    s_mul_i32 s92, s80, 0x2a000
    s_add_u32 m0, s87, 0x26000
    s_add_u32 s92, s92, 0x700
    buffer_load_dwordx4 v9, s[32:35], s92 offen lds
    v_cvt_pk_bf16_f32 v75, v126, v127
    ds_write_b128 v3, v[72:75] offset:16512
    s_waitcnt vmcnt(2)
    s_waitcnt lgkmcnt(0)
    s_barrier
    ds_read_b64_tr_b16 v[52:53], v22 offset:10240
    ds_read_b64_tr_b16 v[54:55], v22 offset:10752
    v_mfma_f32_32x32x16_bf16 v[80:95], v[112:115], a[64:67], v[80:95]
    ds_read_b128 a[80:83], v4 offset:16384
    ds_read_b128 a[84:87], v5 offset:16384
    ds_read_b128 a[88:91], v6 offset:16384
    ds_read_b128 a[92:95], v7 offset:16384
    v_lshlrev_b32 v120, 16, v48
    v_and_b32 v121, s81, v48
    v_lshlrev_b32 v122, 16, v49
    ds_read_b64_tr_b16 v[112:113], v22 offset:4096
    ds_read_b64_tr_b16 v[114:115], v22 offset:4608
    v_mfma_f32_32x32x16_bf16 v[96:111], v[116:119], a[64:67], v[96:111]
    v_and_b32 v123, s81, v49
    v_lshlrev_b32 v124, 16, v50
    v_and_b32 v125, s81, v50
    v_lshlrev_b32 v126, 16, v51
    v_and_b32 v127, s81, v51
    v_fma_f32 v120, v120, v130, v128
    ds_read_b64_tr_b16 v[116:117], v22 offset:12288
    ds_read_b64_tr_b16 v[118:119], v22 offset:12800
    v_mfma_f32_32x32x16_bf16 v[80:95], v[24:27], a[68:71], v[80:95]
    v_fma_f32 v121, v121, v130, v128
    v_fma_f32 v122, v122, v130, v128
    v_fma_f32 v123, v123, v130, v128
    v_fma_f32 v124, v124, v130, v128
    v_fma_f32 v125, v125, v130, v128
    v_fma_f32 v126, v126, v130, v128
    v_fma_f32 v127, v127, v130, v128
    ds_read_b64_tr_b16 v[24:25], v22 offset:6144
    ds_read_b64_tr_b16 v[26:27], v22 offset:6656
    s_waitcnt lgkmcnt(10)
    v_mfma_f32_32x32x16_bf16 v[96:111], v[52:55], a[68:71], v[96:111]
    v_cvt_pk_bf16_f32 v48, v120, v121
    v_cvt_pk_bf16_f32 v49, v122, v123
    v_cvt_pk_bf16_f32 v50, v124, v125
    v_cvt_pk_bf16_f32 v51, v126, v127
    s_mul_i32 s92, s74, 0x38000
    s_add_u32 m0, s87, 0xc000
    s_add_u32 s92, s92, s88
    buffer_load_dwordx4 v10, s[36:39], s92 offen lds
    ds_read_b64_tr_b16 v[52:53], v22 offset:14336
    ds_read_b64_tr_b16 v[54:55], v22 offset:14848
    s_waitcnt lgkmcnt(6)
    v_mfma_f32_32x32x16_bf16 v[80:95], v[112:115], a[72:75], v[80:95]
    ds_write_b128 v3, v[48:51]
    v_lshlrev_b32 v120, 16, v76
    v_and_b32 v121, s81, v76
    v_lshlrev_b32 v122, 16, v77
    v_and_b32 v123, s81, v77
    v_lshlrev_b32 v124, 16, v78
    v_add_u32 v23, 0x20000, v8
    ds_read_b64_tr_b16 v[112:113], v23
    ds_read_b64_tr_b16 v[114:115], v23 offset:512
    s_waitcnt lgkmcnt(7)
    v_mfma_f32_32x32x16_bf16 v[96:111], v[116:119], a[72:75], v[96:111]
    v_and_b32 v125, s81, v78
    v_lshlrev_b32 v126, 16, v79
    v_and_b32 v127, s81, v79
    v_fma_f32 v120, v120, v131, v129
    v_fma_f32 v121, v121, v131, v129
    v_fma_f32 v122, v122, v131, v129
    ds_read_b64_tr_b16 v[116:117], v23 offset:8192
    ds_read_b64_tr_b16 v[118:119], v23 offset:8704
    s_waitcnt lgkmcnt(7)
    v_mfma_f32_32x32x16_bf16 v[80:95], v[24:27], a[76:79], v[80:95]
    v_fma_f32 v123, v123, v131, v129
    v_fma_f32 v124, v124, v131, v129
    v_fma_f32 v125, v125, v131, v129
    v_fma_f32 v126, v126, v131, v129
    v_fma_f32 v127, v127, v131, v129
    v_cvt_pk_bf16_f32 v76, v120, v121
    v_cvt_pk_bf16_f32 v77, v122, v123
    ds_read_b64_tr_b16 v[24:25], v23 offset:2048
    ds_read_b64_tr_b16 v[26:27], v23 offset:2560
    s_waitcnt lgkmcnt(7)
    v_mfma_f32_32x32x16_bf16 v[96:111], v[52:55], a[76:79], v[96:111]
    v_cvt_pk_bf16_f32 v78, v124, v125
    s_mul_i32 s92, s74, 0x38000
    s_add_u32 m0, s87, 0xe000
    s_add_u32 s92, s92, s88
    buffer_load_dwordx4 v11, s[40:43], s92 offen lds
    v_cvt_pk_bf16_f32 v79, v126, v127
    ds_write_b128 v3, v[76:79] offset:128
    s_waitcnt vmcnt(2)
    s_waitcnt lgkmcnt(0)
    s_barrier
    ds_read_b64_tr_b16 v[52:53], v23 offset:10240
    ds_read_b64_tr_b16 v[54:55], v23 offset:10752
    v_mfma_f32_32x32x16_bf16 v[80:95], v[112:115], a[80:83], v[80:95]
    ds_read_b128 a[96:99], v4
    ds_read_b128 a[100:103], v5
    ds_read_b128 a[104:107], v6
    ds_read_b64_tr_b16 v[112:113], v23 offset:4096
    ds_read_b64_tr_b16 v[114:115], v23 offset:4608
    v_mfma_f32_32x32x16_bf16 v[96:111], v[116:119], a[80:83], v[96:111]
    ds_read_b128 a[108:111], v7
    v_lshrrev_b32 v20, 3, v1
    v_bfe_u32 v21, v20, 1, 1
    ds_read_b64_tr_b16 v[116:117], v23 offset:12288
    ds_read_b64_tr_b16 v[118:119], v23 offset:12800
    v_mfma_f32_32x32x16_bf16 v[80:95], v[24:27], a[84:87], v[80:95]
    v_lshlrev_b32 v21, 2, v21
    v_and_b32 v18, 7, v1
    v_xor_b32 v21, v21, v18
    v_lshlrev_b32 v141, 6, v1
    ds_read_b64_tr_b16 v[24:25], v23 offset:6144
    ds_read_b64_tr_b16 v[26:27], v23 offset:6656
    s_waitcnt lgkmcnt(10)
    v_mfma_f32_32x32x16_bf16 v[96:111], v[52:55], a[84:87], v[96:111]
    s_lshl_b32 s93, s70, 3
    v_add_u32 v20, s93, v20
    v_mul_u32_u24 v20, 0x380, v20
    v_lshl_add_u32 v20, v21, 4, v20
    ds_read_b64_tr_b16 v[52:53], v23 offset:14336
    ds_read_b64_tr_b16 v[54:55], v23 offset:14848
    s_waitcnt lgkmcnt(7)
    v_mfma_f32_32x32x16_bf16 v[80:95], v[112:115], a[88:91], v[80:95]
    s_lshl_b32 s93, s98, 7
    s_mul_i32 s92, s75, 0x38000
    s_add_u32 m0, s87, 0x10000
    s_add_u32 s92, s92, s88
    buffer_load_dwordx4 v10, s[36:39], s92 offen lds
    v_add_u32 v22, 0x24000, v8
    ds_read_b64_tr_b16 v[112:113], v22
    ds_read_b64_tr_b16 v[114:115], v22 offset:512
    s_waitcnt lgkmcnt(6)
    v_mfma_f32_32x32x16_bf16 v[96:111], v[116:119], a[88:91], v[96:111]
    v_add_u32 v9, s93, v20
    ds_read_b64_tr_b16 v[116:117], v22 offset:8192
    ds_read_b64_tr_b16 v[118:119], v22 offset:8704
    s_waitcnt lgkmcnt(6)
    v_mfma_f32_32x32x16_bf16 v[80:95], v[24:27], a[92:95], v[80:95]
    s_and_b32 s93, s97, 3
    s_add_u32 s93, s93, s98
    s_bitcmp1_b32 s93, 0
    s_cselect_b32 s8, 20, 0
    s_cselect_b32 s9, 0, 20
    s_cselect_b32 s24, 24, 4
    s_cselect_b32 s23, 4, 24
    s_bitcmp1_b32 s93, 1
    s_cselect_b32 s19, 16, 8
    s_cselect_b32 s22, 8, 16
    s_mov_b32 s25, 12
    s_and_b32 s94, s93, 1
    s_lshl_b32 s26, s94, 1
    s_xor_b32 s27, s26, 2
    ds_read_b64_tr_b16 v[24:25], v22 offset:2048
    ds_read_b64_tr_b16 v[26:27], v22 offset:2560
    s_waitcnt lgkmcnt(6)
    v_mfma_f32_32x32x16_bf16 v[96:111], v[52:55], a[92:95], v[96:111]
    s_mul_i32 s92, s75, 0x38000
    s_add_u32 m0, s87, 0x12000
    s_add_u32 s92, s92, s88
    buffer_load_dwordx4 v11, s[40:43], s92 offen lds
    s_barrier
    ds_read_b64_tr_b16 v[52:53], v22 offset:10240
    ds_read_b64_tr_b16 v[54:55], v22 offset:10752
    s_waitcnt lgkmcnt(6)
    v_mfma_f32_32x32x16_bf16 v[80:95], v[112:115], a[96:99], v[80:95]
    ds_read_b64_tr_b16 v[112:113], v22 offset:4096
    ds_read_b64_tr_b16 v[114:115], v22 offset:4608
    s_waitcnt lgkmcnt(6)
    v_mfma_f32_32x32x16_bf16 v[96:111], v[116:119], a[96:99], v[96:111]
    ds_read_b64_tr_b16 v[116:117], v22 offset:12288
    ds_read_b64_tr_b16 v[118:119], v22 offset:12800
    s_waitcnt lgkmcnt(6)
    v_mfma_f32_32x32x16_bf16 v[80:95], v[24:27], a[100:103], v[80:95]
    ds_read_b64_tr_b16 v[24:25], v22 offset:6144
    ds_read_b64_tr_b16 v[26:27], v22 offset:6656
    s_waitcnt lgkmcnt(6)
    v_mfma_f32_32x32x16_bf16 v[96:111], v[52:55], a[100:103], v[96:111]
    s_mul_i32 s92, s76, 0x38000
    s_add_u32 m0, s87, 0x14000
    s_add_u32 s92, s92, s88
    buffer_load_dwordx4 v10, s[36:39], s92 offen lds
    ds_read_b64_tr_b16 v[52:53], v22 offset:14336
    ds_read_b64_tr_b16 v[54:55], v22 offset:14848
    s_waitcnt lgkmcnt(6)
    v_mfma_f32_32x32x16_bf16 v[80:95], v[112:115], a[104:107], v[80:95]
    s_waitcnt lgkmcnt(4)
    v_mfma_f32_32x32x16_bf16 v[96:111], v[116:119], a[104:107], v[96:111]
    s_waitcnt lgkmcnt(2)
    v_mfma_f32_32x32x16_bf16 v[80:95], v[24:27], a[108:111], v[80:95]
    s_waitcnt lgkmcnt(0)
    v_mfma_f32_32x32x16_bf16 v[96:111], v[52:55], a[108:111], v[96:111]
    s_mul_i32 s92, s76, 0x38000
    s_add_u32 m0, s87, 0x16000
    s_add_u32 s92, s92, s88
    buffer_load_dwordx4 v11, s[40:43], s92 offen lds
    s_waitcnt vmcnt(2)
    s_barrier
    s_nop 3
    v_cvt_pk_bf16_f32 v72, v80, v81
    v_cvt_pk_bf16_f32 v73, v82, v83
    v_cvt_pk_bf16_f32 v74, v84, v85
    v_cvt_pk_bf16_f32 v75, v86, v87
    v_cvt_pk_bf16_f32 v76, v88, v89
    v_cvt_pk_bf16_f32 v77, v90, v91
    v_cvt_pk_bf16_f32 v78, v92, v93
    v_cvt_pk_bf16_f32 v79, v94, v95
    v_mfma_f32_32x32x16_bf16 v[112:127], v[132:135], v[72:75], 0
    s_nop 0
    v_mfma_f32_32x32x16_bf16 v[112:127], v[136:139], v[76:79], v[112:127]
    v_bfi_b32 v108, v16, v108, 1.0
    v_cvt_pk_bf16_f32 v96, v96, v97
    v_cvt_pk_bf16_f32 v97, v98, v99
    v_cvt_pk_bf16_f32 v98, v100, v101
    v_cvt_pk_bf16_f32 v99, v102, v103
    v_cvt_pk_bf16_f32 v100, v104, v105
    v_cvt_pk_bf16_f32 v101, v106, v107
    v_cvt_pk_bf16_f32 v102, v108, v109
    v_cvt_pk_bf16_f32 v103, v110, v111
    v_and_b32 v20, 31, v1
    v_bfe_u32 v21, v1, 1, 3
    v_lshrrev_b32 v22, 5, v1
    v_xor_b32 v21, v21, v22
    v_lshlrev_b32 v21, 3, v21
    v_lshl_add_u32 v21, v20, 6, v21
    s_lshl_b32 s14, s70, 13
    s_lshl_b32 s15, s69, 11
    s_add_u32 s14, s14, s15
    s_add_u32 s14, s14, 0x8000
    v_add_u32 v21, s14, v21
    ds_write_b64 v21, v[96:97]
    v_xor_b32 v23, 16, v21
    ds_write_b64 v23, v[98:99]
    v_xor_b32 v23, 32, v21
    s_mul_i32 s92, s77, 0x38000
    s_add_u32 m0, s87, 0x18000
    s_add_u32 s92, s92, s88
    buffer_load_dwordx4 v10, s[36:39], s92 offen lds
    ds_write_b64 v23, v[100:101]
    v_xor_b32 v23, 48, v21
    ds_write_b64 v23, v[102:103]
    v_max3_f32 v128, v112, v113, v114
    v_min3_f32 v129, v112, v113, v114
    v_max3_f32 v128, v128, v115, v116
    v_min3_f32 v129, v129, v115, v116
    v_max3_f32 v128, v128, v117, v118
    v_min3_f32 v129, v129, v117, v118
    v_max3_f32 v128, v128, v119, v120
    v_min3_f32 v129, v129, v119, v120
    v_max3_f32 v128, v128, v121, v122
    v_min3_f32 v129, v129, v121, v122
    v_max3_f32 v128, v128, v123, v124
    v_min3_f32 v129, v129, v123, v124
    v_max3_f32 v128, v128, v125, v126
    v_min3_f32 v129, v129, v125, v126
    v_max_f32 v128, v128, v127
    v_min_f32 v129, v129, v127
    v_mov_b32 v130, v128
    v_mov_b32 v131, v129
    s_nop 0
    v_permlane32_swap_b32 v128, v130
    v_permlane32_swap_b32 v129, v131
    v_max_f32 v128, v128, v130
    v_min_f32 v129, v129, v131
    v_sub_f32 v80, v129, v112
    v_sub_f32 v112, v112, v128
    v_sub_f32 v81, v129, v113
    v_sub_f32 v113, v113, v128
    v_sub_f32 v82, v129, v114
    v_sub_f32 v114, v114, v128
    v_sub_f32 v83, v129, v115
    v_sub_f32 v115, v115, v128
    v_exp_f32 v80, v80
    v_exp_f32 v112, v112
    v_exp_f32 v81, v81
    v_exp_f32 v113, v113
    v_exp_f32 v82, v82
    v_exp_f32 v114, v114
    v_exp_f32 v83, v83
    v_exp_f32 v115, v115
    v_sub_f32 v84, v129, v116
    v_sub_f32 v116, v116, v128
    v_sub_f32 v85, v129, v117
    v_sub_f32 v117, v117, v128
    v_sub_f32 v86, v129, v118
    v_sub_f32 v118, v118, v128
    v_sub_f32 v87, v129, v119
    v_sub_f32 v119, v119, v128
    v_exp_f32 v84, v84
    v_exp_f32 v116, v116
    v_exp_f32 v85, v85
    v_exp_f32 v117, v117
    v_exp_f32 v86, v86
    s_mul_i32 s92, s77, 0x38000
    s_add_u32 m0, s87, 0x1a000
    s_add_u32 s92, s92, s88
    buffer_load_dwordx4 v11, s[40:43], s92 offen lds
    v_exp_f32 v118, v118
    v_exp_f32 v87, v87
    v_exp_f32 v119, v119
    v_sub_f32 v88, v129, v120
    v_sub_f32 v120, v120, v128
    v_sub_f32 v89, v129, v121
    v_sub_f32 v121, v121, v128
    v_sub_f32 v90, v129, v122
    v_sub_f32 v122, v122, v128
    v_sub_f32 v91, v129, v123
    v_sub_f32 v123, v123, v128
    v_exp_f32 v88, v88
    v_exp_f32 v120, v120
    v_exp_f32 v89, v89
    v_exp_f32 v121, v121
    v_exp_f32 v90, v90
    v_exp_f32 v122, v122
    v_exp_f32 v91, v91
    v_exp_f32 v123, v123
    v_sub_f32 v92, v129, v124
    v_sub_f32 v124, v124, v128
    v_sub_f32 v93, v129, v125
    v_sub_f32 v125, v125, v128
    v_sub_f32 v94, v129, v126
    v_sub_f32 v126, v126, v128
    v_sub_f32 v95, v129, v127
    v_sub_f32 v127, v127, v128
    v_exp_f32 v92, v92
    v_exp_f32 v124, v124
    v_exp_f32 v93, v93
    v_exp_f32 v125, v125
    v_exp_f32 v94, v94
    v_exp_f32 v126, v126
    v_exp_f32 v95, v95
    v_exp_f32 v127, v127
    v_add_f32 v140, v92, v93
    v_add_f32 v141, v124, v125
    v_add_f32 v130, v94, v95
    v_add_f32 v131, v126, v127
    v_add_f32 v140, v140, v130
    v_add_f32 v141, v141, v131
    v_add_f32 v130, v81, v82
    v_add_f32 v131, v113, v114
    v_fma_f32 v140, v140, v17, v80
    v_fma_f32 v141, v141, v17, v112
    v_add_f32 v130, v130, v84
    v_add_f32 v131, v131, v116
    v_add_f32 v140, v140, v83
    s_mul_i32 s92, s78, 0x38000
    s_add_u32 m0, s87, 0x1c000
    s_add_u32 s92, s92, s88
    buffer_load_dwordx4 v10, s[36:39], s92 offen lds
    v_add_f32 v141, v141, v115
    v_add_f32 v130, v130, v86
    v_add_f32 v131, v131, v118
    v_add_f32 v140, v140, v85
    v_add_f32 v141, v141, v117
    v_add_f32 v130, v130, v88
    v_add_f32 v131, v131, v120
    v_add_f32 v140, v140, v87
    v_add_f32 v141, v141, v119
    v_add_f32 v130, v130, v90
    v_add_f32 v131, v131, v122
    v_add_f32 v140, v140, v89
    v_add_f32 v141, v141, v121
    v_add_f32 v140, v140, v91
    v_add_f32 v141, v141, v123
    v_add_f32 v140, v140, v130
    v_add_f32 v141, v141, v131
    v_mov_b32 v130, v140
    v_mov_b32 v131, v141
    s_nop 0
    v_permlane32_swap_b32 v140, v130
    v_permlane32_swap_b32 v141, v131
    v_add_f32 v140, v140, v130
    v_add_f32 v141, v141, v131
    v_rcp_f32 v140, v140
    v_rcp_f32 v141, v141
    s_nop 0
    v_mul_f32 v142, v140, v17
    v_mul_f32 v143, v141, v17
    v_mul_f32 v80, v80, v140
    v_mul_f32 v112, v112, v141
    v_mul_f32 v81, v81, v140
    v_mul_f32 v113, v113, v141
    v_mul_f32 v82, v82, v140
    v_mul_f32 v114, v114, v141
    v_mul_f32 v83, v83, v140
    v_mul_f32 v115, v115, v141
    v_mul_f32 v84, v84, v140
    v_mul_f32 v116, v116, v141
    v_mul_f32 v85, v85, v140
    v_mul_f32 v117, v117, v141
    v_mul_f32 v86, v86, v140
    v_mul_f32 v118, v118, v141
    v_mul_f32 v87, v87, v140
    v_mul_f32 v119, v119, v141
    v_mul_f32 v88, v88, v140
    v_mul_f32 v120, v120, v141
    v_mul_f32 v89, v89, v140
    v_mul_f32 v121, v121, v141
    v_mul_f32 v90, v90, v140
    v_mul_f32 v122, v122, v141
    v_mul_f32 v91, v91, v140
    v_mul_f32 v123, v123, v141
    v_mul_f32 v92, v92, v142
    v_mul_f32 v124, v124, v143
    v_mul_f32 v93, v93, v142
    v_mul_f32 v125, v125, v143
    v_mul_f32 v94, v94, v142
    v_mul_f32 v126, v126, v143
    v_mul_f32 v95, v95, v142
    v_mul_f32 v127, v127, v143
    v_and_b32 v20, 31, v1
    v_and_b32 v21, 15, v1
    v_lshrrev_b32 v22, 5, v1
    v_xor_b32 v21, v21, v22
    v_lshlrev_b32 v21, 3, v21
    v_lshl_add_u32 v21, v20, 7, v21
    s_mul_i32 s92, s78, 0x38000
    s_add_u32 m0, s87, 0x1e000
    s_add_u32 s92, s92, s88
    buffer_load_dwordx4 v11, s[40:43], s92 offen lds
    s_lshl_b32 s14, s70, 14
    s_lshl_b32 s15, s69, 12
    s_add_u32 s14, s14, s15
    v_add_u32 v21, s14, v21
    v_cvt_pk_bf16_f32 v96, v80, v81
    v_cvt_pk_bf16_f32 v97, v82, v83
    v_cvt_pk_bf16_f32 v98, v84, v85
    v_cvt_pk_bf16_f32 v99, v86, v87
    v_cvt_pk_bf16_f32 v100, v88, v89
    v_cvt_pk_bf16_f32 v101, v90, v91
    v_cvt_pk_bf16_f32 v102, v92, v93
    v_cvt_pk_bf16_f32 v103, v94, v95
    v_cvt_pk_bf16_f32 v104, v112, v113
    v_cvt_pk_bf16_f32 v105, v114, v115
    v_cvt_pk_bf16_f32 v106, v116, v117
    v_cvt_pk_bf16_f32 v107, v118, v119
    v_cvt_pk_bf16_f32 v108, v120, v121
    v_cvt_pk_bf16_f32 v109, v122, v123
    v_cvt_pk_bf16_f32 v110, v124, v125
    v_cvt_pk_bf16_f32 v111, v126, v127
    ds_write_b64 v21, v[96:97]
    v_xor_b32 v23, 16, v21
    ds_write_b64 v23, v[98:99]
    v_xor_b32 v23, 32, v21
    ds_write_b64 v23, v[100:101]
    v_xor_b32 v23, 48, v21
    ds_write_b64 v23, v[102:103]
    v_xor_b32 v23, 64, v21
    ds_write_b64 v23, v[104:105]
    v_xor_b32 v23, 0x50, v21
    ds_write_b64 v23, v[106:107]
    v_xor_b32 v23, 0x60, v21
    ds_write_b64 v23, v[108:109]
    v_xor_b32 v23, 0x70, v21
    ds_write_b64 v23, v[110:111]
    s_waitcnt lgkmcnt(0)
    s_barrier
    v_lshrrev_b32 v141, 4, v1
    v_bfe_u32 v142, v1, 2, 2
    v_and_b32 v143, 3, v1
    v_lshl_add_u32 v131, v141, 2, v142
    s_lshl_b32 s93, s69, 2
    v_add_u32 v140, s93, v143
    v_xor_b32 v140, v140, v131
    v_lshlrev_b32 v140, 3, v140
    v_lshl_add_u32 v140, v131, 7, v140
    s_lshl_b32 s94, s70, 14
    v_add_u32 v128, s94, v140
    v_lshrrev_b32 v140, 1, v131
    v_xor_b32 v140, v140, v143
    v_lshlrev_b32 v140, 3, v140
    v_lshl_add_u32 v140, v131, 6, v140
    s_lshl_b32 s94, s70, 13
    s_add_u32 s94, s94, 0x8000
    v_add_u32 v129, s94, v140
    v_xor_b32 v130, 32, v129
    ds_read_b64_tr_b16 v[88:89], v128
    ds_read_b64_tr_b16 v[90:91], v128 offset:2048
    ds_read_b64_tr_b16 v[112:113], v129
    ds_read_b64_tr_b16 v[114:115], v129 offset:1024
    ds_read_b64_tr_b16 v[116:117], v130
    ds_read_b64_tr_b16 v[118:119], v130 offset:1024
    ds_read_b64_tr_b16 v[92:93], v128 offset:4096
    ds_read_b64_tr_b16 v[94:95], v128 offset:6144
    ds_read_b64_tr_b16 v[120:121], v129 offset:2048
    ds_read_b64_tr_b16 v[122:123], v129 offset:3072
    ds_read_b64_tr_b16 v[124:125], v130 offset:2048
    ds_read_b64_tr_b16 v[126:127], v130 offset:3072
    s_waitcnt lgkmcnt(8)
    v_mfma_f32_16x16x32_bf16 v[80:83], v[88:91], v[112:115], 0
    s_waitcnt lgkmcnt(6)
    v_mfma_f32_16x16x32_bf16 v[84:87], v[88:91], v[116:119], 0
    ds_read_b64_tr_b16 v[88:89], v128 offset:8192
    ds_read_b64_tr_b16 v[90:91], v128 offset:10240
    ds_read_b64_tr_b16 v[112:113], v129 offset:4096
    ds_read_b64_tr_b16 v[114:115], v129 offset:5120
    ds_read_b64_tr_b16 v[116:117], v130 offset:4096
    ds_read_b64_tr_b16 v[118:119], v130 offset:5120
    s_waitcnt lgkmcnt(8)
    v_mfma_f32_16x16x32_bf16 v[80:83], v[92:95], v[120:123], v[80:83]
    s_waitcnt lgkmcnt(6)
    v_mfma_f32_16x16x32_bf16 v[84:87], v[92:95], v[124:127], v[84:87]
    ds_read_b64_tr_b16 v[92:93], v128 offset:12288
    ds_read_b64_tr_b16 v[94:95], v128 offset:14336
    ds_read_b64_tr_b16 v[120:121], v129 offset:6144
    ds_read_b64_tr_b16 v[122:123], v129 offset:7168
    ds_read_b64_tr_b16 v[124:125], v130 offset:6144
    ds_read_b64_tr_b16 v[126:127], v130 offset:7168
    s_waitcnt lgkmcnt(8)
    v_mfma_f32_16x16x32_bf16 v[80:83], v[88:91], v[112:115], v[80:83]
    s_waitcnt lgkmcnt(6)
    v_mfma_f32_16x16x32_bf16 v[84:87], v[88:91], v[116:119], v[84:87]
    s_waitcnt lgkmcnt(2)
    v_mfma_f32_16x16x32_bf16 v[80:83], v[92:95], v[120:123], v[80:83]
    s_waitcnt lgkmcnt(0)
    v_mfma_f32_16x16x32_bf16 v[84:87], v[92:95], v[124:127], v[84:87]
    s_lshl_b32 s93, s72, 1
    s_add_u32 s93, s93, s70
    s_lshl_b32 s93, s93, 13
    s_lshl_b32 s94, s69, 11
    s_add_u32 s93, s93, s94
    s_add_u32 s95, s93, 0x900000
    buffer_atomic_add_f32 v80, v19, s[60:63], s95 offen
    buffer_atomic_add_f32 v81, v19, s[60:63], s95 offen offset:256
    buffer_atomic_add_f32 v82, v19, s[60:63], s95 offen offset:512
    buffer_atomic_add_f32 v83, v19, s[60:63], s95 offen offset:768
    buffer_atomic_add_f32 v84, v19, s[60:63], s95 offen offset:1024
    buffer_atomic_add_f32 v85, v19, s[60:63], s95 offen offset:1280
    buffer_atomic_add_f32 v86, v19, s[60:63], s95 offen offset:1536
    buffer_atomic_add_f32 v87, v19, s[60:63], s95 offen offset:1792
    v_add_u32 v4, 0xc000, v12
    ds_read_b64_tr_b16 v[56:57], v4
    ds_read_b64_tr_b16 v[58:59], v4 offset:512
    v_add_u32 v6, 0xc000, v13
    ds_read_b64_tr_b16 v[60:61], v6
    ds_read_b64_tr_b16 v[62:63], v6 offset:512
    ds_read_b64_tr_b16 v[64:65], v4 offset:2048
    ds_read_b64_tr_b16 v[66:67], v4 offset:2560
    ds_read_b64_tr_b16 v[68:69], v6 offset:2048
    ds_read_b64_tr_b16 v[70:71], v6 offset:2560
    s_waitcnt lgkmcnt(6)
    v_mfma_f32_32x32x16_bf16 v[24:39], v[56:59], a[0:3], 0
    ds_read_b64_tr_b16 v[56:57], v4 offset:4096
    ds_read_b64_tr_b16 v[58:59], v4 offset:4608
    s_waitcnt lgkmcnt(6)
    v_mfma_f32_32x32x16_bf16 v[40:55], v[60:63], a[0:3], 0
    ds_read_b64_tr_b16 v[60:61], v6 offset:4096
    ds_read_b64_tr_b16 v[62:63], v6 offset:4608
    s_waitcnt lgkmcnt(6)
    v_mfma_f32_32x32x16_bf16 v[24:39], v[64:67], a[4:7], v[24:39]
    ds_read_b64_tr_b16 v[64:65], v4 offset:6144
    ds_read_b64_tr_b16 v[66:67], v4 offset:6656
    s_waitcnt lgkmcnt(6)
    v_mfma_f32_32x32x16_bf16 v[40:55], v[68:71], a[4:7], v[40:55]
    s_mul_i32 s92, s79, 0x38000
    s_add_u32 m0, s87, 0x20000
    s_add_u32 s92, s92, s88
    buffer_load_dwordx4 v10, s[36:39], s92 offen lds
    ds_read_b64_tr_b16 v[68:69], v6 offset:6144
    ds_read_b64_tr_b16 v[70:71], v6 offset:6656
    s_waitcnt lgkmcnt(6)
    v_mfma_f32_32x32x16_bf16 v[24:39], v[56:59], a[8:11], v[24:39]
    v_add_u32 v5, 0x10000, v12
    ds_read_b64_tr_b16 v[56:57], v5
    ds_read_b64_tr_b16 v[58:59], v5 offset:512
    s_waitcnt lgkmcnt(6)
    v_mfma_f32_32x32x16_bf16 v[40:55], v[60:63], a[8:11], v[40:55]
    v_add_u32 v7, 0x10000, v13
    ds_read_b64_tr_b16 v[60:61], v7
    ds_read_b64_tr_b16 v[62:63], v7 offset:512
    s_waitcnt lgkmcnt(6)
    v_mfma_f32_32x32x16_bf16 v[24:39], v[64:67], a[12:15], v[24:39]
    ds_read_b64_tr_b16 v[64:65], v5 offset:2048
    ds_read_b64_tr_b16 v[66:67], v5 offset:2560
    s_waitcnt lgkmcnt(6)
    v_mfma_f32_32x32x16_bf16 v[40:55], v[68:71], a[12:15], v[40:55]
    s_mul_i32 s92, s79, 0x38000
    s_add_u32 m0, s87, 0x22000
    s_add_u32 s92, s92, s88
    buffer_load_dwordx4 v11, s[40:43], s92 offen lds
    s_waitcnt vmcnt(14)
    s_barrier
    ds_read_b64_tr_b16 v[68:69], v7 offset:2048
    ds_read_b64_tr_b16 v[70:71], v7 offset:2560
    s_waitcnt lgkmcnt(6)
    v_mfma_f32_32x32x16_bf16 v[24:39], v[56:59], a[16:19], v[24:39]
    ds_read_b64_tr_b16 v[56:57], v5 offset:4096
    ds_read_b64_tr_b16 v[58:59], v5 offset:4608
    s_waitcnt lgkmcnt(6)
    v_mfma_f32_32x32x16_bf16 v[40:55], v[60:63], a[16:19], v[40:55]
    ds_read_b64_tr_b16 v[60:61], v7 offset:4096
    ds_read_b64_tr_b16 v[62:63], v7 offset:4608
    s_waitcnt lgkmcnt(6)
    v_mfma_f32_32x32x16_bf16 v[24:39], v[64:67], a[20:23], v[24:39]
    s_mul_i32 s92, s80, 0x38000
    s_add_u32 m0, s87, 0x24000
    s_add_u32 s92, s92, s88
    buffer_load_dwordx4 v10, s[36:39], s92 offen lds
    ds_read_b64_tr_b16 v[64:65], v5 offset:6144
    ds_read_b64_tr_b16 v[66:67], v5 offset:6656
    s_waitcnt lgkmcnt(6)
    v_mfma_f32_32x32x16_bf16 v[40:55], v[68:71], a[20:23], v[40:55]
    s_mul_i32 s92, s80, 0x38000
    s_add_u32 m0, s87, 0x26000
    s_add_u32 s92, s92, s88
    buffer_load_dwordx4 v11, s[40:43], s92 offen lds
    ds_read_b64_tr_b16 v[68:69], v7 offset:6144
    ds_read_b64_tr_b16 v[70:71], v7 offset:6656
    s_waitcnt lgkmcnt(6)
    v_mfma_f32_32x32x16_bf16 v[24:39], v[56:59], a[24:27], v[24:39]
    s_mul_i32 s92, s74, 0x38000
    s_add_u32 m0, s87, 0xc000
    s_add_u32 s92, s92, s89
    buffer_load_dwordx4 v14, s[4:7], s92 offen lds
    v_add_u32 v4, 0x14000, v12
    ds_read_b64_tr_b16 v[56:57], v4
    ds_read_b64_tr_b16 v[58:59], v4 offset:512
    s_waitcnt lgkmcnt(6)
    v_mfma_f32_32x32x16_bf16 v[40:55], v[60:63], a[24:27], v[40:55]
    v_add_u32 v6, 0x14000, v13
    ds_read_b64_tr_b16 v[60:61], v6
    ds_read_b64_tr_b16 v[62:63], v6 offset:512
    s_waitcnt lgkmcnt(6)
    v_mfma_f32_32x32x16_bf16 v[24:39], v[64:67], a[28:31], v[24:39]
    s_mul_i32 s92, s8, 0x3800
    s_mov_b32 m0, s99
    s_add_u32 s92, s92, s85
    buffer_load_dwordx4 v9, s[44:47], s92 offen lds
    ds_read_b64_tr_b16 v[64:65], v4 offset:2048
    ds_read_b64_tr_b16 v[66:67], v4 offset:2560
    s_waitcnt lgkmcnt(6)
    v_mfma_f32_32x32x16_bf16 v[40:55], v[68:71], a[28:31], v[40:55]
    s_mul_i32 s92, s8, 0x3800
    s_add_u32 s92, s92, s85
    s_add_u32 m0, s99, 0x2000
    s_add_u32 s92, s92, 0x3800
    buffer_load_dwordx4 v9, s[44:47], s92 offen lds
    s_waitcnt vmcnt(17)
    s_waitcnt vmcnt(7)
    s_barrier
    ds_read_b64_tr_b16 v[68:69], v6 offset:2048
    ds_read_b64_tr_b16 v[70:71], v6 offset:2560
    s_waitcnt lgkmcnt(6)
    v_mfma_f32_32x32x16_bf16 v[24:39], v[56:59], a[32:35], v[24:39]
    s_lshr_b32 s93, s97, 1
    s_lshl_b32 s93, s93, 2
    s_and_b32 s94, s97, 1
    s_lshl_b32 s94, s94, 1
    s_add_u32 s93, s93, s94
    s_add_u32 s93, s93, s70
    s_mul_i32 s10, s93, 0x1c000
    s_mul_i32 s94, s69, 0x7000
    s_add_u32 s10, s10, s94
    s_lshl_b32 s11, s93, 15
    s_lshl_b32 s94, s69, 13
    s_add_u32 s11, s11, s94
    s_add_u32 s11, s11, 0x700000
    s_lshr_b32 s93, s97, 1
    s_lshl_b32 s93, s93, 13
    s_add_u32 s13, s93, 0x930000
    v_and_b32 v142, 15, v1
    v_lshlrev_b32 v142, 9, v142
    ds_read_b64_tr_b16 v[56:57], v4 offset:4096
    ds_read_b64_tr_b16 v[58:59], v4 offset:4608
    s_waitcnt lgkmcnt(6)
    v_mfma_f32_32x32x16_bf16 v[40:55], v[60:63], a[32:35], v[40:55]
    ds_read_b64_tr_b16 v[60:61], v6 offset:4096
    ds_read_b64_tr_b16 v[62:63], v6 offset:4608
    s_waitcnt lgkmcnt(6)
    v_mfma_f32_32x32x16_bf16 v[24:39], v[64:67], a[36:39], v[24:39]
    ds_read_b64_tr_b16 v[64:65], v4 offset:6144
    ds_read_b64_tr_b16 v[66:67], v4 offset:6656
    s_waitcnt lgkmcnt(6)
    v_mfma_f32_32x32x16_bf16 v[40:55], v[68:71], a[36:39], v[40:55]
    v_bfe_u32 v20, v1, 2, 2
    v_lshrrev_b32 v21, 5, v1
    v_lshl_add_u32 v21, v21, 2, v20
    v_lshrrev_b32 v20, 1, v20
    v_lshlrev_b32 v20, 6, v20
    v_lshl_add_u32 v20, v21, 7, v20
    v_bfe_u32 v21, v1, 4, 1
    v_lshl_add_u32 v20, v21, 5, v20
    v_and_b32 v21, 3, v1
    v_lshl_add_u32 v20, v21, 3, v20
    s_lshl_b32 s93, s69, 11
    v_add_u32 v128, s93, v20
    ds_read_b64_tr_b16 v[68:69], v6 offset:6144
    ds_read_b64_tr_b16 v[70:71], v6 offset:6656
    s_waitcnt lgkmcnt(6)
    v_mfma_f32_32x32x16_bf16 v[24:39], v[56:59], a[40:43], v[24:39]
    v_add_u32 v5, 0x18000, v12
    ds_read_b64_tr_b16 v[56:57], v5
    ds_read_b64_tr_b16 v[58:59], v5 offset:512
    s_waitcnt lgkmcnt(6)
    v_mfma_f32_32x32x16_bf16 v[40:55], v[60:63], a[40:43], v[40:55]
    s_mul_i32 s92, s75, 0x38000
    s_add_u32 m0, s87, 0x10000
    s_add_u32 s92, s92, s89
    buffer_load_dwordx4 v14, s[4:7], s92 offen lds
    v_add_u32 v7, 0x18000, v13
    ds_read_b64_tr_b16 v[60:61], v7
    ds_read_b64_tr_b16 v[62:63], v7 offset:512
    s_waitcnt lgkmcnt(6)
    v_mfma_f32_32x32x16_bf16 v[24:39], v[64:67], a[44:47], v[24:39]
    s_mul_i32 s92, s8, 0x3800
    s_add_u32 s92, s92, s85
    s_add_u32 m0, s99, 0x4000
    s_add_u32 s92, s92, 0x7000
    buffer_load_dwordx4 v9, s[44:47], s92 offen lds
    ds_read_b64_tr_b16 v[64:65], v5 offset:2048
    ds_read_b64_tr_b16 v[66:67], v5 offset:2560
    s_waitcnt lgkmcnt(6)
    v_mfma_f32_32x32x16_bf16 v[40:55], v[68:71], a[44:47], v[40:55]
    s_mul_i32 s92, s8, 0x3800
    s_add_u32 s92, s92, s85
    s_add_u32 m0, s99, 0x6000
    s_add_u32 s92, s92, 0xa800
    buffer_load_dwordx4 v9, s[44:47], s92 offen lds
    s_barrier
    ds_read_b64_tr_b16 v[68:69], v7 offset:2048
    ds_read_b64_tr_b16 v[70:71], v7 offset:2560
    s_waitcnt lgkmcnt(6)
    v_mfma_f32_32x32x16_bf16 v[24:39], v[56:59], a[48:51], v[24:39]
    v_xor_b32 v129, 64, v128
    v_add_u32 v130, 0x10000, v128
    v_add_u32 v131, 0x10000, v129
    ds_read_b64_tr_b16 v[56:57], v5 offset:4096
    ds_read_b64_tr_b16 v[58:59], v5 offset:4608
    s_waitcnt lgkmcnt(6)
    v_mfma_f32_32x32x16_bf16 v[40:55], v[60:63], a[48:51], v[40:55]
    v_add_u32 v140, 0x20000, v128
    v_add_u32 v141, 0x20000, v129
    ds_read_b64_tr_b16 v[60:61], v7 offset:4096
    ds_read_b64_tr_b16 v[62:63], v7 offset:4608
    s_waitcnt lgkmcnt(6)
    v_mfma_f32_32x32x16_bf16 v[24:39], v[64:67], a[52:55], v[24:39]
    v_lshrrev_b32 v20, 3, v1
    s_lshl_b32 s93, s97, 6
    s_lshl_b32 s94, s70, 5
    s_add_u32 s93, s93, s94
    s_lshl_b32 s94, s69, 3
    s_add_u32 s93, s93, s94
    v_add_u32 v20, s93, v20
    v_mul_u32_u24 v20, 0x380, v20
    v_and_b32 v21, 7, v1
    v_lshl_add_u32 v20, v21, 4, v20
    s_lshl_b32 s93, s98, 7
    v_add_u32 v8, s93, v20
    ds_read_b64_tr_b16 v[64:65], v5 offset:6144
    ds_read_b64_tr_b16 v[66:67], v5 offset:6656
    s_waitcnt lgkmcnt(6)
    v_mfma_f32_32x32x16_bf16 v[40:55], v[68:71], a[52:55], v[40:55]
    ds_read_b64_tr_b16 v[68:69], v7 offset:6144
    ds_read_b64_tr_b16 v[70:71], v7 offset:6656
    s_waitcnt lgkmcnt(6)
    v_mfma_f32_32x32x16_bf16 v[24:39], v[56:59], a[56:59], v[24:39]
    s_mul_i32 s92, s76, 0x38000
    s_add_u32 m0, s87, 0x14000
    s_add_u32 s92, s92, s89
    buffer_load_dwordx4 v14, s[4:7], s92 offen lds
    v_add_u32 v4, 0x1c000, v12
    ds_read_b64_tr_b16 v[56:57], v4
    ds_read_b64_tr_b16 v[58:59], v4 offset:512
    s_waitcnt lgkmcnt(6)
    v_mfma_f32_32x32x16_bf16 v[40:55], v[60:63], a[56:59], v[40:55]
    v_add_u32 v6, 0x1c000, v13
    ds_read_b64_tr_b16 v[60:61], v6
    ds_read_b64_tr_b16 v[62:63], v6 offset:512
    s_waitcnt lgkmcnt(6)
    v_mfma_f32_32x32x16_bf16 v[24:39], v[64:67], a[60:63], v[24:39]
    s_mul_i32 s92, s9, 0x3800
    s_add_u32 m0, s99, 0x8000
    s_add_u32 s92, s92, s85
    buffer_load_dwordx4 v9, s[44:47], s92 offen lds
    ds_read_b64_tr_b16 v[64:65], v4 offset:2048
    ds_read_b64_tr_b16 v[66:67], v4 offset:2560
    s_waitcnt lgkmcnt(6)
    v_mfma_f32_32x32x16_bf16 v[40:55], v[68:71], a[60:63], v[40:55]
    s_mul_i32 s92, s9, 0x3800
    s_add_u32 s92, s92, s85
    s_add_u32 m0, s99, 0xa000
    s_add_u32 s92, s92, 0x3800
    buffer_load_dwordx4 v9, s[44:47], s92 offen lds
    s_waitcnt vmcnt(11)
    s_barrier
    ds_read_b64_tr_b16 v[68:69], v6 offset:2048
    ds_read_b64_tr_b16 v[70:71], v6 offset:2560
    s_waitcnt lgkmcnt(6)
    v_mfma_f32_32x32x16_bf16 v[24:39], v[56:59], a[64:67], v[24:39]
    ds_read_b64_tr_b16 v[56:57], v4 offset:4096
    ds_read_b64_tr_b16 v[58:59], v4 offset:4608
    s_waitcnt lgkmcnt(6)
    v_mfma_f32_32x32x16_bf16 v[40:55], v[60:63], a[64:67], v[40:55]
    ds_read_b64_tr_b16 v[60:61], v6 offset:4096
    ds_read_b64_tr_b16 v[62:63], v6 offset:4608
    s_waitcnt lgkmcnt(6)
    v_mfma_f32_32x32x16_bf16 v[24:39], v[64:67], a[68:71], v[24:39]
    s_mul_i32 s92, s77, 0x38000
    s_add_u32 m0, s87, 0x18000
    s_add_u32 s92, s92, s89
    buffer_load_dwordx4 v14, s[4:7], s92 offen lds
    ds_read_b64_tr_b16 v[64:65], v4 offset:6144
    ds_read_b64_tr_b16 v[66:67], v4 offset:6656
    s_waitcnt lgkmcnt(6)
    v_mfma_f32_32x32x16_bf16 v[40:55], v[68:71], a[68:71], v[40:55]
    ds_read_b64_tr_b16 v[68:69], v6 offset:6144
    ds_read_b64_tr_b16 v[70:71], v6 offset:6656
    s_waitcnt lgkmcnt(6)
    v_mfma_f32_32x32x16_bf16 v[24:39], v[56:59], a[72:75], v[24:39]
    s_mul_i32 s92, s9, 0x3800
    s_add_u32 s92, s92, s85
    s_add_u32 m0, s99, 0xe000
    s_add_u32 s92, s92, 0x7000
    buffer_load_dwordx4 v9, s[44:47], s92 offen lds
    v_add_u32 v5, 0x20000, v12
    ds_read_b64_tr_b16 v[56:57], v5
    ds_read_b64_tr_b16 v[58:59], v5 offset:512
    s_waitcnt lgkmcnt(6)
    v_mfma_f32_32x32x16_bf16 v[40:55], v[60:63], a[72:75], v[40:55]
    v_add_u32 v7, 0x20000, v13
    ds_read_b64_tr_b16 v[60:61], v7
    ds_read_b64_tr_b16 v[62:63], v7 offset:512
    s_waitcnt lgkmcnt(6)
    v_mfma_f32_32x32x16_bf16 v[24:39], v[64:67], a[76:79], v[24:39]
    ds_read_b64_tr_b16 v[64:65], v5 offset:2048
    ds_read_b64_tr_b16 v[66:67], v5 offset:2560
    s_waitcnt lgkmcnt(6)
    v_mfma_f32_32x32x16_bf16 v[40:55], v[68:71], a[76:79], v[40:55]
    s_mul_i32 s92, s9, 0x3800
    s_add_u32 s92, s92, s85
    s_add_u32 m0, s99, 0x12000
    s_add_u32 s92, s92, 0xa800
    buffer_load_dwordx4 v9, s[44:47], s92 offen lds
    s_waitcnt vmcnt(12)
    s_barrier
    ds_read_b64_tr_b16 v[68:69], v7 offset:2048
    ds_read_b64_tr_b16 v[70:71], v7 offset:2560
    s_waitcnt lgkmcnt(6)
    v_mfma_f32_32x32x16_bf16 v[24:39], v[56:59], a[80:83], v[24:39]
    ds_read_b64_tr_b16 v[56:57], v5 offset:4096
    ds_read_b64_tr_b16 v[58:59], v5 offset:4608
    s_waitcnt lgkmcnt(6)
    v_mfma_f32_32x32x16_bf16 v[40:55], v[60:63], a[80:83], v[40:55]
    ds_read_b64_tr_b16 v[60:61], v7 offset:4096
    ds_read_b64_tr_b16 v[62:63], v7 offset:4608
    s_waitcnt lgkmcnt(6)
    v_mfma_f32_32x32x16_bf16 v[24:39], v[64:67], a[84:87], v[24:39]
    ds_read_b64_tr_b16 v[64:65], v5 offset:6144
    ds_read_b64_tr_b16 v[66:67], v5 offset:6656
    s_waitcnt lgkmcnt(6)
    v_mfma_f32_32x32x16_bf16 v[40:55], v[68:71], a[84:87], v[40:55]
    s_mul_i32 s92, s78, 0x38000
    s_add_u32 m0, s87, 0x1c000
    s_add_u32 s92, s92, s89
    buffer_load_dwordx4 v14, s[4:7], s92 offen lds
    ds_read_b64_tr_b16 v[68:69], v7 offset:6144
    ds_read_b64_tr_b16 v[70:71], v7 offset:6656
    s_waitcnt lgkmcnt(6)
    v_mfma_f32_32x32x16_bf16 v[24:39], v[56:59], a[88:91], v[24:39]
    s_mul_i32 s92, s19, 0x3800
    s_add_u32 m0, s99, 0x16000
    s_add_u32 s92, s92, s85
    buffer_load_dwordx4 v9, s[44:47], s92 offen lds
    v_add_u32 v4, 0x24000, v12
    ds_read_b64_tr_b16 v[56:57], v4
    ds_read_b64_tr_b16 v[58:59], v4 offset:512
    s_waitcnt lgkmcnt(6)
    v_mfma_f32_32x32x16_bf16 v[40:55], v[60:63], a[88:91], v[40:55]
    v_add_u32 v6, 0x24000, v13
    ds_read_b64_tr_b16 v[60:61], v6
    ds_read_b64_tr_b16 v[62:63], v6 offset:512
    s_waitcnt lgkmcnt(6)
    v_mfma_f32_32x32x16_bf16 v[24:39], v[64:67], a[92:95], v[24:39]
    ds_read_b64_tr_b16 v[64:65], v4 offset:2048
    ds_read_b64_tr_b16 v[66:67], v4 offset:2560
    s_waitcnt lgkmcnt(6)
    v_mfma_f32_32x32x16_bf16 v[40:55], v[68:71], a[92:95], v[40:55]
    s_mul_i32 s92, s19, 0x3800
    s_add_u32 s92, s92, s85
    s_add_u32 m0, s99, 0x1a000
    s_add_u32 s92, s92, 0x3800
    buffer_load_dwordx4 v9, s[44:47], s92 offen lds
    s_barrier
    ds_read_b64_tr_b16 v[68:69], v6 offset:2048
    ds_read_b64_tr_b16 v[70:71], v6 offset:2560
    s_waitcnt lgkmcnt(6)
    v_mfma_f32_32x32x16_bf16 v[24:39], v[56:59], a[96:99], v[24:39]
    ds_read_b64_tr_b16 v[56:57], v4 offset:4096
    ds_read_b64_tr_b16 v[58:59], v4 offset:4608
    s_waitcnt lgkmcnt(6)
    v_mfma_f32_32x32x16_bf16 v[40:55], v[60:63], a[96:99], v[40:55]
    ds_read_b64_tr_b16 v[60:61], v6 offset:4096
    ds_read_b64_tr_b16 v[62:63], v6 offset:4608
    s_waitcnt lgkmcnt(6)
    v_mfma_f32_32x32x16_bf16 v[24:39], v[64:67], a[100:103], v[24:39]
    ds_read_b64_tr_b16 v[64:65], v4 offset:6144
    ds_read_b64_tr_b16 v[66:67], v4 offset:6656
    s_waitcnt lgkmcnt(6)
    v_mfma_f32_32x32x16_bf16 v[40:55], v[68:71], a[100:103], v[40:55]
    s_mul_i32 s92, s79, 0x38000
    s_add_u32 m0, s87, 0x20000
    s_add_u32 s92, s92, s89
    buffer_load_dwordx4 v14, s[4:7], s92 offen lds
    ds_read_b64_tr_b16 v[68:69], v6 offset:6144
    ds_read_b64_tr_b16 v[70:71], v6 offset:6656
    s_waitcnt lgkmcnt(6)
    v_mfma_f32_32x32x16_bf16 v[24:39], v[56:59], a[104:107], v[24:39]
    s_mul_i32 s92, s80, 0x38000
    s_add_u32 m0, s87, 0x22000
    s_add_u32 s92, s92, s89
    buffer_load_dwordx4 v14, s[4:7], s92 offen lds
    s_waitcnt lgkmcnt(4)
    v_mfma_f32_32x32x16_bf16 v[40:55], v[60:63], a[104:107], v[40:55]
    s_waitcnt lgkmcnt(2)
    v_mfma_f32_32x32x16_bf16 v[24:39], v[64:67], a[108:111], v[24:39]
    s_waitcnt lgkmcnt(0)
    v_mfma_f32_32x32x16_bf16 v[40:55], v[68:71], a[108:111], v[40:55]
    s_mul_i32 s92, s19, 0x3800
    s_add_u32 s92, s92, s85
    s_add_u32 m0, s99, 0x1e000
    s_add_u32 s92, s92, 0x7000
    buffer_load_dwordx4 v9, s[44:47], s92 offen lds
    s_waitcnt vmcnt(8)
    s_barrier
    v_add_u32 v4, 0xc000, v15
    ds_read_b64_tr_b16 v[56:57], v4
    ds_read_b64_tr_b16 v[58:59], v4 offset:256
    ds_read_b64_tr_b16 v[60:61], v4 offset:1024
    ds_read_b64_tr_b16 v[62:63], v4 offset:1280
    ds_read_b64_tr_b16 v[64:65], v4 offset:2048
    ds_read_b64_tr_b16 v[66:67], v4 offset:2304
    ds_read_b64_tr_b16 v[68:69], v4 offset:3072
    ds_read_b64_tr_b16 v[70:71], v4 offset:3328
    s_waitcnt lgkmcnt(6)
    v_mfma_f32_32x32x16_bf16 v[96:111], v[56:59], a[0:3], 0
    v_exp_f32 v112, v24
    v_exp_f32 v113, v25
    v_exp_f32 v114, v26
    v_exp_f32 v115, v27
    v_exp_f32 v116, v28
    v_add_u32 v5, 0x10000, v15
    ds_read_b64_tr_b16 v[56:57], v5
    ds_read_b64_tr_b16 v[58:59], v5 offset:256
    s_waitcnt lgkmcnt(6)
    v_mfma_f32_32x32x16_bf16 v[96:111], v[60:63], a[4:7], v[96:111]
    v_exp_f32 v117, v29
    v_exp_f32 v118, v30
    v_exp_f32 v119, v31
    v_mul_f32 v24, v24, v32
    v_mul_f32 v25, v25, v33
    v_mul_f32 v26, v26, v34
    v_mul_f32 v27, v27, v35
    v_mul_f32 v28, v28, v36
    ds_read_b64_tr_b16 v[60:61], v5 offset:1024
    ds_read_b64_tr_b16 v[62:63], v5 offset:1280
    s_waitcnt lgkmcnt(6)
    v_mfma_f32_32x32x16_bf16 v[96:111], v[64:67], a[8:11], v[96:111]
    s_mul_i32 s92, s19, 0x3800
    s_add_u32 s92, s92, s85
    s_add_u32 m0, s99, 0x26000
    s_add_u32 s92, s92, 0xa800
    buffer_load_dwordx4 v9, s[44:47], s92 offen lds
    v_mul_f32 v29, v29, v37
    v_mul_f32 v30, v30, v38
    v_mul_f32 v31, v31, v39
    v_add_f32 v112, 1.0, v112
    v_add_f32 v113, 1.0, v113
    v_add_f32 v114, 1.0, v114
    v_add_f32 v115, 1.0, v115
    v_add_f32 v116, 1.0, v116
    v_add_f32 v117, 1.0, v117
    ds_read_b64_tr_b16 v[64:65], v5 offset:2048
    ds_read_b64_tr_b16 v[66:67], v5 offset:2304
    s_waitcnt lgkmcnt(6)
    v_mfma_f32_32x32x16_bf16 v[96:111], v[68:71], a[12:15], v[96:111]
    v_add_f32 v118, 1.0, v118
    v_add_f32 v119, 1.0, v119
    v_rcp_f32 v112, v112
    v_rcp_f32 v113, v113
    v_rcp_f32 v114, v114
    v_rcp_f32 v115, v115
    v_rcp_f32 v116, v116
    s_barrier
    ds_read_b64_tr_b16 v[68:69], v5 offset:3072
    ds_read_b64_tr_b16 v[70:71], v5 offset:3328
    s_waitcnt lgkmcnt(6)
    v_mfma_f32_32x32x16_bf16 v[96:111], v[56:59], a[16:19], v[96:111]
    v_rcp_f32 v117, v117
    v_rcp_f32 v118, v118
    v_rcp_f32 v119, v119
    v_mul_f32 v24, v24, v112
    v_mul_f32 v25, v25, v113
    v_mul_f32 v26, v26, v114
    v_mul_f32 v27, v27, v115
    v_mul_f32 v28, v28, v116
    v_add_u32 v4, 0x14000, v15
    ds_read_b64_tr_b16 v[56:57], v4
    ds_read_b64_tr_b16 v[58:59], v4 offset:256
    s_waitcnt lgkmcnt(6)
    v_mfma_f32_32x32x16_bf16 v[96:111], v[60:63], a[20:23], v[96:111]
    v_mul_f32 v29, v29, v117
    v_mul_f32 v30, v30, v118
    v_mul_f32 v31, v31, v119
    v_cvt_pk_bf16_f32 v120, v24, v25
    v_cvt_pk_bf16_f32 v121, v26, v27
    v_cvt_pk_bf16_f32 v122, v28, v29
    v_cvt_pk_bf16_f32 v123, v30, v31
    s_lshl_b32 s93, s88, 5
    s_add_u32 s93, s93, s90
    s_mul_i32 s94, s70, 0x800
    s_add_u32 s93, s93, s94
    buffer_store_dwordx4 v[120:123], v2, s[60:63], s93 offen sc1
    ds_read_b64_tr_b16 v[60:61], v4 offset:1024
    ds_read_b64_tr_b16 v[62:63], v4 offset:1280
    s_waitcnt lgkmcnt(6)
    v_mfma_f32_32x32x16_bf16 v[96:111], v[64:67], a[24:27], v[96:111]
    v_exp_f32 v112, v40
    v_exp_f32 v113, v41
    v_exp_f32 v114, v42
    v_exp_f32 v115, v43
    v_exp_f32 v116, v44
    v_exp_f32 v117, v45
    ds_read_b64_tr_b16 v[64:65], v4 offset:2048
    ds_read_b64_tr_b16 v[66:67], v4 offset:2304
    s_waitcnt lgkmcnt(6)
    v_mfma_f32_32x32x16_bf16 v[96:111], v[68:71], a[28:31], v[96:111]
    v_exp_f32 v118, v46
    v_exp_f32 v119, v47
    v_mul_f32 v40, v40, v48
    v_mul_f32 v41, v41, v49
    v_mul_f32 v42, v42, v50
    v_mul_f32 v43, v43, v51
    v_mul_f32 v44, v44, v52
    v_mul_f32 v45, v45, v53
    s_waitcnt vmcnt(3)
    s_barrier
    ds_read_b64_tr_b16 v[68:69], v4 offset:3072
    ds_read_b64_tr_b16 v[70:71], v4 offset:3328
    s_waitcnt lgkmcnt(6)
    v_mfma_f32_32x32x16_bf16 v[96:111], v[56:59], a[32:35], v[96:111]
    v_mul_f32 v46, v46, v54
    v_mul_f32 v47, v47, v55
    v_add_f32 v112, 1.0, v112
    v_add_f32 v113, 1.0, v113
    v_add_f32 v114, 1.0, v114
    v_add_f32 v115, 1.0, v115
    v_add_f32 v116, 1.0, v116
    v_add_f32 v117, 1.0, v117
    v_add_f32 v118, 1.0, v118
    v_add_f32 v119, 1.0, v119
    v_rcp_f32 v112, v112
    v_add_u32 v5, 0x18000, v15
    ds_read_b64_tr_b16 v[56:57], v5
    ds_read_b64_tr_b16 v[58:59], v5 offset:256
    s_waitcnt lgkmcnt(6)
    v_mfma_f32_32x32x16_bf16 v[96:111], v[60:63], a[36:39], v[96:111]
    v_rcp_f32 v113, v113
    v_rcp_f32 v114, v114
    v_rcp_f32 v115, v115
    v_rcp_f32 v116, v116
    v_rcp_f32 v117, v117
    ds_read_b64_tr_b16 v[60:61], v5 offset:1024
    ds_read_b64_tr_b16 v[62:63], v5 offset:1280
    s_waitcnt lgkmcnt(6)
    v_mfma_f32_32x32x16_bf16 v[96:111], v[64:67], a[40:43], v[96:111]
    s_mul_i32 s92, s22, 0x3800
    s_add_u32 m0, s99, 0xc000
    s_add_u32 s92, s92, s85
    buffer_load_dwordx4 v9, s[44:47], s92 offen lds
    v_rcp_f32 v118, v118
    v_rcp_f32 v119, v119
    v_mul_f32 v40, v40, v112
    v_mul_f32 v41, v41, v113
    v_mul_f32 v42, v42, v114
    v_mul_f32 v43, v43, v115
    v_mul_f32 v44, v44, v116
    ds_read_b64_tr_b16 v[64:65], v5 offset:2048
    ds_read_b64_tr_b16 v[66:67], v5 offset:2304
    s_waitcnt lgkmcnt(6)
    v_mfma_f32_32x32x16_bf16 v[96:111], v[68:71], a[44:47], v[96:111]
    v_mul_f32 v45, v45, v117
    v_mul_f32 v46, v46, v118
    v_mul_f32 v47, v47, v119
    v_cvt_pk_bf16_f32 v124, v40, v41
    v_cvt_pk_bf16_f32 v125, v42, v43
    v_cvt_pk_bf16_f32 v126, v44, v45
    v_cvt_pk_bf16_f32 v127, v46, v47
    s_lshl_b32 s93, s88, 5
    s_add_u32 s93, s93, s90
    s_mul_i32 s94, s70, 0x800
    s_add_u32 s93, s93, s94
    buffer_store_dwordx4 v[124:127], v2, s[60:63], s93 offen offset:1024 sc1
    s_barrier
    ds_read_b64_tr_b16 v[68:69], v5 offset:3072
    ds_read_b64_tr_b16 v[70:71], v5 offset:3328
    s_waitcnt lgkmcnt(6)
    v_mfma_f32_32x32x16_bf16 v[96:111], v[56:59], a[48:51], v[96:111]
    v_add_u32 v4, 0x1c000, v15
    ds_read_b64_tr_b16 v[56:57], v4
    ds_read_b64_tr_b16 v[58:59], v4 offset:256
    s_waitcnt lgkmcnt(6)
    v_mfma_f32_32x32x16_bf16 v[96:111], v[60:63], a[52:55], v[96:111]
    ds_read_b64_tr_b16 v[60:61], v4 offset:1024
    ds_read_b64_tr_b16 v[62:63], v4 offset:1280
    s_waitcnt lgkmcnt(6)
    v_mfma_f32_32x32x16_bf16 v[96:111], v[64:67], a[56:59], v[96:111]
    s_mul_i32 s92, s22, 0x3800
    s_add_u32 s92, s92, s85
    s_add_u32 m0, s99, 0x10000
    s_add_u32 s92, s92, 0x3800
    buffer_load_dwordx4 v9, s[44:47], s92 offen lds
    ds_read_b64_tr_b16 v[64:65], v4 offset:2048
    ds_read_b64_tr_b16 v[66:67], v4 offset:2304
    s_waitcnt lgkmcnt(6)
    v_mfma_f32_32x32x16_bf16 v[96:111], v[68:71], a[60:63], v[96:111]
    s_barrier
    ds_read_b64_tr_b16 v[68:69], v4 offset:3072
    ds_read_b64_tr_b16 v[70:71], v4 offset:3328
    s_waitcnt lgkmcnt(6)
    v_mfma_f32_32x32x16_bf16 v[96:111], v[56:59], a[64:67], v[96:111]
    v_add_u32 v5, 0x20000, v15
    ds_read_b64_tr_b16 v[56:57], v5
    ds_read_b64_tr_b16 v[58:59], v5 offset:256
    s_waitcnt lgkmcnt(6)
    v_mfma_f32_32x32x16_bf16 v[96:111], v[60:63], a[68:71], v[96:111]
    s_add_u32 s14, s13, 0x80
    ds_read_b64_tr_b16 v[60:61], v5 offset:1024
    ds_read_b64_tr_b16 v[62:63], v5 offset:1280
    s_waitcnt lgkmcnt(6)
    v_mfma_f32_32x32x16_bf16 v[96:111], v[64:67], a[72:75], v[96:111]
    ds_read_b64_tr_b16 v[64:65], v5 offset:2048
    ds_read_b64_tr_b16 v[66:67], v5 offset:2304
    s_waitcnt lgkmcnt(6)
    v_mfma_f32_32x32x16_bf16 v[96:111], v[68:71], a[76:79], v[96:111]
    s_mul_i32 s92, s22, 0x3800
    s_add_u32 s92, s92, s85
    s_add_u32 m0, s99, 0x14000
    s_add_u32 s92, s92, 0x7000
    buffer_load_dwordx4 v9, s[44:47], s92 offen lds
    s_waitcnt vmcnt(2)
    s_barrier
    ds_read_b64_tr_b16 v[68:69], v5 offset:3072
    ds_read_b64_tr_b16 v[70:71], v5 offset:3328
    s_waitcnt lgkmcnt(6)
    v_mfma_f32_32x32x16_bf16 v[96:111], v[56:59], a[80:83], v[96:111]
    v_add_u32 v4, 0x22000, v15
    ds_read_b64_tr_b16 v[56:57], v4
    ds_read_b64_tr_b16 v[58:59], v4 offset:256
    s_waitcnt lgkmcnt(6)
    v_mfma_f32_32x32x16_bf16 v[96:111], v[60:63], a[84:87], v[96:111]
    s_lshl_b32 s92, s8, 10
    s_add_u32 s92, s92, s10
    buffer_load_dwordx4 a[0:3], v2, s[60:63], s92 offen sc1
    s_lshl_b32 s92, s8, 10
    s_add_u32 s92, s92, s10
    buffer_load_dwordx4 a[4:7], v2, s[60:63], s92 offen offset:1024 sc1
    ds_read_b64_tr_b16 v[60:61], v4 offset:1024
    ds_read_b64_tr_b16 v[62:63], v4 offset:1280
    s_waitcnt lgkmcnt(6)
    v_mfma_f32_32x32x16_bf16 v[96:111], v[64:67], a[88:91], v[96:111]
    s_lshl_b32 s92, s8, 10
    s_add_u32 s92, s92, s10
    buffer_load_dwordx4 a[8:11], v2, s[60:63], s92 offen offset:2048 sc1
    s_lshl_b32 s92, s8, 10
    s_add_u32 s92, s92, s10
    buffer_load_dwordx4 a[12:15], v2, s[60:63], s92 offen offset:3072 sc1
    ds_read_b64_tr_b16 v[64:65], v4 offset:2048
    ds_read_b64_tr_b16 v[66:67], v4 offset:2304
    s_waitcnt lgkmcnt(6)
    v_mfma_f32_32x32x16_bf16 v[96:111], v[68:71], a[92:95], v[96:111]
    s_mul_i32 s92, s22, 0x3800
    s_add_u32 s92, s92, s85
    s_add_u32 m0, s99, 0x18000
    s_add_u32 s92, s92, 0xa800
    buffer_load_dwordx4 v9, s[44:47], s92 offen lds
    s_barrier
    ds_read_b64_tr_b16 v[68:69], v4 offset:3072
    ds_read_b64_tr_b16 v[70:71], v4 offset:3328
    s_waitcnt lgkmcnt(6)
    v_mfma_f32_32x32x16_bf16 v[96:111], v[56:59], a[96:99], v[96:111]
    s_waitcnt lgkmcnt(4)
    v_mfma_f32_32x32x16_bf16 v[96:111], v[60:63], a[100:103], v[96:111]
    s_lshl_b32 s92, s9, 10
    s_add_u32 s92, s92, s10
    buffer_load_dwordx4 a[16:19], v2, s[60:63], s92 offen sc1
    s_lshl_b32 s92, s9, 10
    s_add_u32 s92, s92, s10
    buffer_load_dwordx4 a[20:23], v2, s[60:63], s92 offen offset:1024 sc1
    s_waitcnt lgkmcnt(2)
    v_mfma_f32_32x32x16_bf16 v[96:111], v[64:67], a[104:107], v[96:111]
    s_lshl_b32 s92, s9, 10
    s_add_u32 s92, s92, s10
    buffer_load_dwordx4 a[24:27], v2, s[60:63], s92 offen offset:2048 sc1
    s_lshl_b32 s92, s9, 10
    s_add_u32 s92, s92, s10
    buffer_load_dwordx4 a[28:31], v2, s[60:63], s92 offen offset:3072 sc1
    s_waitcnt lgkmcnt(0)
    v_mfma_f32_32x32x16_bf16 v[96:111], v[68:71], a[108:111], v[96:111]
    s_mul_i32 s92, s23, 0x3800
    s_add_u32 m0, s99, 0x1c000
    s_add_u32 s92, s92, s85
    buffer_load_dwordx4 v9, s[44:47], s92 offen lds
    s_nop 7
    v_exp_f32 v112, v96
    v_exp_f32 v113, v97
    v_exp_f32 v114, v98
    v_exp_f32 v115, v99
    v_exp_f32 v116, v100
    v_exp_f32 v117, v101
    v_exp_f32 v118, v102
    v_exp_f32 v119, v103
    v_mul_f32 v96, v96, v104
    v_mul_f32 v97, v97, v105
    v_mul_f32 v98, v98, v106
    v_mul_f32 v99, v99, v107
    v_mul_f32 v100, v100, v108
    v_mul_f32 v101, v101, v109
    v_mul_f32 v102, v102, v110
    v_mul_f32 v103, v103, v111
    v_add_f32 v112, 1.0, v112
    v_add_f32 v113, 1.0, v113
    v_add_f32 v114, 1.0, v114
    v_add_f32 v115, 1.0, v115
    v_add_f32 v116, 1.0, v116
    v_add_f32 v117, 1.0, v117
    v_add_f32 v118, 1.0, v118
    v_add_f32 v119, 1.0, v119
    v_rcp_f32 v112, v112
    v_rcp_f32 v113, v113
    v_rcp_f32 v114, v114
    v_rcp_f32 v115, v115
    v_rcp_f32 v116, v116
    v_rcp_f32 v117, v117
    v_rcp_f32 v118, v118
    v_rcp_f32 v119, v119
    v_mul_f32 v96, v96, v112
    v_mul_f32 v97, v97, v113
    v_mul_f32 v98, v98, v114
    v_mul_f32 v99, v99, v115
    v_mul_f32 v100, v100, v116
    v_mul_f32 v101, v101, v117
    v_mul_f32 v102, v102, v118
    v_mul_f32 v103, v103, v119
    v_cvt_pk_bf16_f32 v120, v96, v97
    v_cvt_pk_bf16_f32 v121, v98, v99
    v_cvt_pk_bf16_f32 v122, v100, v101
    v_cvt_pk_bf16_f32 v123, v102, v103
    s_lshl_b32 s93, s89, 5
    s_add_u32 s93, s93, s90
    s_mul_i32 s94, s70, 0x400
    s_add_u32 s93, s93, s94
    buffer_store_dwordx4 v[120:123], v2, s[60:63], s93 offen sc1
    s_waitcnt lgkmcnt(0)
    s_barrier
    s_cmp_lg_u32 s96, 0
    s_cbranch_scc1 L_nop2_2002
    s_waitcnt vmcnt(0)
    s_barrier
    s_branch L_fin_2001
L_nop2_2002:
    ds_read_b64_tr_b16 v[96:97], v128
    ds_read_b64_tr_b16 v[98:99], v128 offset:1024
    ds_read_b64_tr_b16 v[100:101], v129
    ds_read_b64_tr_b16 v[102:103], v129 offset:1024
    ds_read_b64_tr_b16 v[104:105], v128 offset:8192
    ds_read_b64_tr_b16 v[106:107], v128 offset:9216
    ds_read_b64_tr_b16 v[108:109], v129 offset:8192
    ds_read_b64_tr_b16 v[110:111], v129 offset:9216
    ds_read_b64_tr_b16 v[112:113], v128 offset:16384
    ds_read_b64_tr_b16 v[114:115], v128 offset:17408
    ds_read_b64_tr_b16 v[116:117], v129 offset:16384
    ds_read_b64_tr_b16 v[118:119], v129 offset:17408
    s_waitcnt vmcnt(10) lgkmcnt(10)
    v_mfma_f32_32x32x16_bf16 v[32:47], v[96:99], a[0:3], 0
    s_add_u32 s14, s13, 0x80
    ds_read_b64_tr_b16 v[120:121], v128 offset:24576
    ds_read_b64_tr_b16 v[122:123], v128 offset:25600
    s_waitcnt lgkmcnt(10)
    v_mfma_f32_32x32x16_bf16 v[48:63], v[100:103], a[0:3], 0
    ds_read_b64_tr_b16 v[124:125], v129 offset:24576
    ds_read_b64_tr_b16 v[126:127], v129 offset:25600
    s_waitcnt vmcnt(9) lgkmcnt(10)
    v_mfma_f32_32x32x16_bf16 v[32:47], v[104:107], a[4:7], v[32:47]
    ds_read_b64_tr_b16 v[96:97], v128 offset:32768
    ds_read_b64_tr_b16 v[98:99], v128 offset:33792
    s_waitcnt lgkmcnt(10)
    v_mfma_f32_32x32x16_bf16 v[48:63], v[108:111], a[4:7], v[48:63]
    s_mul_i32 s92, s23, 0x3800
    s_add_u32 s92, s92, s85
    s_add_u32 m0, s99, 0x20000
    s_add_u32 s92, s92, 0x3800
    buffer_load_dwordx4 v9, s[44:47], s92 offen lds
    ds_read_b64_tr_b16 v[100:101], v129 offset:32768
    ds_read_b64_tr_b16 v[102:103], v129 offset:33792
    s_waitcnt vmcnt(9) lgkmcnt(10)
    v_mfma_f32_32x32x16_bf16 v[32:47], v[112:115], a[8:11], v[32:47]
    ds_read_b64_tr_b16 v[104:105], v128 offset:40960
    ds_read_b64_tr_b16 v[106:107], v128 offset:41984
    s_waitcnt lgkmcnt(10)
    v_mfma_f32_32x32x16_bf16 v[48:63], v[116:119], a[8:11], v[48:63]
    s_mul_i32 s92, s23, 0x3800
    s_add_u32 s92, s92, s85
    s_add_u32 m0, s99, 0x22000
    s_add_u32 s92, s92, 0x7000
    buffer_load_dwordx4 v9, s[44:47], s92 offen lds
    ds_read_b64_tr_b16 v[108:109], v129 offset:40960
    ds_read_b64_tr_b16 v[110:111], v129 offset:41984
    s_waitcnt vmcnt(9) lgkmcnt(10)
    v_mfma_f32_32x32x16_bf16 v[32:47], v[120:123], a[12:15], v[32:47]
    s_waitcnt lgkmcnt(8)
    v_mfma_f32_32x32x16_bf16 v[48:63], v[124:127], a[12:15], v[48:63]
    s_mul_i32 s92, s23, 0x3800
    s_add_u32 s92, s92, s85
    s_add_u32 m0, s99, 0x24000
    s_add_u32 s92, s92, 0xa800
    buffer_load_dwordx4 v9, s[44:47], s92 offen lds
    s_waitcnt vmcnt(3)
    s_barrier
    ds_read_b64_tr_b16 v[112:113], v128 offset:57344
    ds_read_b64_tr_b16 v[114:115], v128 offset:58368
    ds_read_b64_tr_b16 v[116:117], v129 offset:57344
    ds_read_b64_tr_b16 v[118:119], v129 offset:58368
    s_waitcnt lgkmcnt(10)
    v_mfma_f32_32x32x16_bf16 v[32:47], v[96:99], a[16:19], v[32:47]
    ds_read_b64_tr_b16 v[120:121], v130 offset:8192
    ds_read_b64_tr_b16 v[122:123], v130 offset:9216
    s_waitcnt lgkmcnt(10)
    v_mfma_f32_32x32x16_bf16 v[48:63], v[100:103], a[16:19], v[48:63]
    s_lshl_b32 s92, s19, 10
    s_add_u32 s92, s92, s10
    buffer_load_dwordx4 a[32:35], v2, s[60:63], s92 offen sc1
    ds_read_b64_tr_b16 v[124:125], v131 offset:8192
    ds_read_b64_tr_b16 v[126:127], v131 offset:9216
    s_waitcnt lgkmcnt(10)
    v_mfma_f32_32x32x16_bf16 v[32:47], v[104:107], a[20:23], v[32:47]
    s_lshl_b32 s92, s19, 10
    s_add_u32 s92, s92, s10
    buffer_load_dwordx4 a[36:39], v2, s[60:63], s92 offen offset:1024 sc1
    ds_read_b64_tr_b16 v[96:97], v130 offset:24576
    ds_read_b64_tr_b16 v[98:99], v130 offset:25600
    s_waitcnt lgkmcnt(10)
    v_mfma_f32_32x32x16_bf16 v[48:63], v[108:111], a[20:23], v[48:63]
    s_lshl_b32 s92, s19, 10
    s_add_u32 s92, s92, s10
    buffer_load_dwordx4 a[40:43], v2, s[60:63], s92 offen offset:2048 sc1
    ds_read_b64_tr_b16 v[100:101], v131 offset:24576
    ds_read_b64_tr_b16 v[102:103], v131 offset:25600
    s_waitcnt lgkmcnt(10)
    v_mfma_f32_32x32x16_bf16 v[32:47], v[112:115], a[24:27], v[32:47]
    s_lshl_b32 s92, s19, 10
    s_add_u32 s92, s92, s10
    buffer_load_dwordx4 a[44:47], v2, s[60:63], s92 offen offset:3072 sc1
    ds_read_b64_tr_b16 v[104:105], v130 offset:40960
    ds_read_b64_tr_b16 v[106:107], v130 offset:41984
    s_waitcnt lgkmcnt(10)
    v_mfma_f32_32x32x16_bf16 v[48:63], v[116:119], a[24:27], v[48:63]
    s_lshl_b32 s92, s22, 10
    s_add_u32 s92, s92, s10
    buffer_load_dwordx4 a[48:51], v2, s[60:63], s92 offen sc1
    s_lshl_b32 s92, s22, 10
    s_add_u32 s92, s92, s10
    buffer_load_dwordx4 a[52:55], v2, s[60:63], s92 offen offset:1024 sc1
    ds_read_b64_tr_b16 v[108:109], v131 offset:40960
    ds_read_b64_tr_b16 v[110:111], v131 offset:41984
    s_waitcnt lgkmcnt(10)
    v_mfma_f32_32x32x16_bf16 v[32:47], v[120:123], a[28:31], v[32:47]
    s_lshl_b32 s92, s22, 10
    s_add_u32 s92, s92, s10
    buffer_load_dwordx4 a[56:59], v2, s[60:63], s92 offen offset:2048 sc1
    s_waitcnt lgkmcnt(8)
    v_mfma_f32_32x32x16_bf16 v[48:63], v[124:127], a[28:31], v[48:63]
    s_lshl_b32 s92, s22, 10
    s_add_u32 s92, s92, s10
    buffer_load_dwordx4 a[60:63], v2, s[60:63], s92 offen offset:3072 sc1
    s_barrier
    ds_read_b64_tr_b16 v[112:113], v130 offset:57344
    ds_read_b64_tr_b16 v[114:115], v130 offset:58368
    ds_read_b64_tr_b16 v[116:117], v131 offset:57344
    ds_read_b64_tr_b16 v[118:119], v131 offset:58368
    s_waitcnt vmcnt(7) lgkmcnt(10)
    v_mfma_f32_32x32x16_bf16 v[32:47], v[96:99], a[32:35], v[32:47]
    s_add_u32 s14, s13, 0x100
    ds_read_b64_tr_b16 v[120:121], v140 offset:24576
    ds_read_b64_tr_b16 v[122:123], v140 offset:25600
    s_waitcnt lgkmcnt(10)
    v_mfma_f32_32x32x16_bf16 v[48:63], v[100:103], a[32:35], v[48:63]
    ds_read_b64_tr_b16 v[124:125], v141 offset:24576
    ds_read_b64_tr_b16 v[126:127], v141 offset:25600
    s_waitcnt vmcnt(6) lgkmcnt(10)
    v_mfma_f32_32x32x16_bf16 v[32:47], v[104:107], a[36:39], v[32:47]
    s_mul_i32 s92, s24, 0x3800
    s_mov_b32 m0, s99
    s_add_u32 s92, s92, s85
    buffer_load_dwordx4 v9, s[44:47], s92 offen lds
    ds_read_b64_tr_b16 v[96:97], v128 offset:49152
    ds_read_b64_tr_b16 v[98:99], v128 offset:50176
    s_waitcnt lgkmcnt(10)
    v_mfma_f32_32x32x16_bf16 v[48:63], v[108:111], a[36:39], v[48:63]
    s_mul_i32 s92, s24, 0x3800
    s_add_u32 s92, s92, s85
    s_add_u32 m0, s99, 0x2000
    s_add_u32 s92, s92, 0x3800
    buffer_load_dwordx4 v9, s[44:47], s92 offen lds
    ds_read_b64_tr_b16 v[100:101], v129 offset:49152
    ds_read_b64_tr_b16 v[102:103], v129 offset:50176
    s_waitcnt vmcnt(7) lgkmcnt(10)
    v_mfma_f32_32x32x16_bf16 v[32:47], v[112:115], a[40:43], v[32:47]
    ds_read_b64_tr_b16 v[104:105], v130
    ds_read_b64_tr_b16 v[106:107], v130 offset:1024
    s_waitcnt lgkmcnt(10)
    v_mfma_f32_32x32x16_bf16 v[48:63], v[116:119], a[40:43], v[48:63]
    s_mul_i32 s92, s24, 0x3800
    s_add_u32 s92, s92, s85
    s_add_u32 m0, s99, 0x4000
    s_add_u32 s92, s92, 0x7000
    buffer_load_dwordx4 v9, s[44:47], s92 offen lds
    ds_read_b64_tr_b16 v[108:109], v131
    ds_read_b64_tr_b16 v[110:111], v131 offset:1024
    s_waitcnt vmcnt(7) lgkmcnt(10)
    v_mfma_f32_32x32x16_bf16 v[32:47], v[120:123], a[44:47], v[32:47]
    s_waitcnt lgkmcnt(8)
    v_mfma_f32_32x32x16_bf16 v[48:63], v[124:127], a[44:47], v[48:63]
    s_mul_i32 s92, s24, 0x3800
    s_add_u32 s92, s92, s85
    s_add_u32 m0, s99, 0x6000
    s_add_u32 s92, s92, 0xa800
    buffer_load_dwordx4 v9, s[44:47], s92 offen lds
    s_barrier
    ds_read_b64_tr_b16 v[112:113], v130 offset:16384
    ds_read_b64_tr_b16 v[114:115], v130 offset:17408
    ds_read_b64_tr_b16 v[116:117], v131 offset:16384
    ds_read_b64_tr_b16 v[118:119], v131 offset:17408
    s_waitcnt vmcnt(7) lgkmcnt(10)
    v_mfma_f32_32x32x16_bf16 v[32:47], v[96:99], a[48:51], v[32:47]
    s_lshl_b32 s92, s23, 10
    s_add_u32 s92, s92, s10
    buffer_load_dwordx4 a[64:67], v2, s[60:63], s92 offen sc1
    ds_read_b64_tr_b16 v[120:121], v130 offset:32768
    ds_read_b64_tr_b16 v[122:123], v130 offset:33792
    s_waitcnt lgkmcnt(10)
    v_mfma_f32_32x32x16_bf16 v[48:63], v[100:103], a[48:51], v[48:63]
    s_lshl_b32 s92, s23, 10
    s_add_u32 s92, s92, s10
    buffer_load_dwordx4 a[68:71], v2, s[60:63], s92 offen offset:1024 sc1
    s_lshl_b32 s92, s23, 10
    s_add_u32 s92, s92, s10
    buffer_load_dwordx4 a[72:75], v2, s[60:63], s92 offen offset:2048 sc1
    ds_read_b64_tr_b16 v[124:125], v131 offset:32768
    ds_read_b64_tr_b16 v[126:127], v131 offset:33792
    s_waitcnt vmcnt(9) lgkmcnt(10)
    v_mfma_f32_32x32x16_bf16 v[32:47], v[104:107], a[52:55], v[32:47]
    s_lshl_b32 s92, s23, 10
    s_add_u32 s92, s92, s10
    buffer_load_dwordx4 a[76:79], v2, s[60:63], s92 offen offset:3072 sc1
    s_lshl_b32 s92, s24, 10
    s_add_u32 s92, s92, s10
    buffer_load_dwordx4 a[80:83], v2, s[60:63], s92 offen sc1
    ds_read_b64_tr_b16 v[96:97], v130 offset:49152
    ds_read_b64_tr_b16 v[98:99], v130 offset:50176
    s_waitcnt lgkmcnt(10)
    v_mfma_f32_32x32x16_bf16 v[48:63], v[108:111], a[52:55], v[48:63]
    s_lshl_b32 s92, s24, 10
    s_add_u32 s92, s92, s10
    buffer_load_dwordx4 a[84:87], v2, s[60:63], s92 offen offset:1024 sc1
    ds_read_b64_tr_b16 v[100:101], v131 offset:49152
    ds_read_b64_tr_b16 v[102:103], v131 offset:50176
    s_waitcnt vmcnt(11) lgkmcnt(10)
    v_mfma_f32_32x32x16_bf16 v[32:47], v[112:115], a[56:59], v[32:47]
    s_lshl_b32 s92, s24, 10
    s_add_u32 s92, s92, s10
    buffer_load_dwordx4 a[88:91], v2, s[60:63], s92 offen offset:2048 sc1
    s_lshl_b32 s92, s24, 10
    s_add_u32 s92, s92, s10
    buffer_load_dwordx4 a[92:95], v2, s[60:63], s92 offen offset:3072 sc1
    ds_read_b64_tr_b16 v[104:105], v140
    ds_read_b64_tr_b16 v[106:107], v140 offset:1024
    s_waitcnt lgkmcnt(10)
    v_mfma_f32_32x32x16_bf16 v[48:63], v[116:119], a[56:59], v[48:63]
    s_mul_i32 s92, s25, 0x3800
    s_add_u32 m0, s99, 0x8000
    s_add_u32 s92, s92, s85
    buffer_load_dwordx4 v9, s[44:47], s92 offen lds
    ds_read_b64_tr_b16 v[108:109], v141
    ds_read_b64_tr_b16 v[110:111], v141 offset:1024
    s_waitcnt vmcnt(13) lgkmcnt(10)
    v_mfma_f32_32x32x16_bf16 v[32:47], v[120:123], a[60:63], v[32:47]
    s_mul_i32 s92, s25, 0x3800
    s_add_u32 s92, s92, s85
    s_add_u32 m0, s99, 0xa000
    s_add_u32 s92, s92, 0x3800
    buffer_load_dwordx4 v9, s[44:47], s92 offen lds
    s_mul_i32 s92, s25, 0x3800
    s_add_u32 s92, s92, s85
    s_add_u32 m0, s99, 0xe000
    s_add_u32 s92, s92, 0x7000
    buffer_load_dwordx4 v9, s[44:47], s92 offen lds
    s_waitcnt lgkmcnt(8)
    v_mfma_f32_32x32x16_bf16 v[48:63], v[124:127], a[60:63], v[48:63]
    s_mul_i32 s92, s25, 0x3800
    s_add_u32 s92, s92, s85
    s_add_u32 m0, s99, 0x12000
    s_add_u32 s92, s92, 0xa800
    buffer_load_dwordx4 v9, s[44:47], s92 offen lds
    s_waitcnt vmcnt(14)
    s_barrier
    ds_read_b64_tr_b16 v[112:113], v140 offset:8192
    ds_read_b64_tr_b16 v[114:115], v140 offset:9216
    ds_read_b64_tr_b16 v[116:117], v141 offset:8192
    ds_read_b64_tr_b16 v[118:119], v141 offset:9216
    s_waitcnt vmcnt(11) lgkmcnt(10)
    v_mfma_f32_32x32x16_bf16 v[32:47], v[96:99], a[64:67], v[32:47]
    s_add_u32 s14, s13, 0x100
    ds_read_b64_tr_b16 v[120:121], v140 offset:16384
    ds_read_b64_tr_b16 v[122:123], v140 offset:17408
    s_waitcnt lgkmcnt(10)
    v_mfma_f32_32x32x16_bf16 v[48:63], v[100:103], a[64:67], v[48:63]
    ds_read_b64_tr_b16 v[124:125], v141 offset:16384
    ds_read_b64_tr_b16 v[126:127], v141 offset:17408
    s_waitcnt vmcnt(10) lgkmcnt(10)
    v_mfma_f32_32x32x16_bf16 v[32:47], v[104:107], a[68:71], v[32:47]
    s_mul_i32 s92, s26, 0x6200
    s_add_u32 m0, s99, 0x16000
    s_add_u32 s92, s92, s86
    buffer_load_dwordx4 v9, s[48:51], s92 offen lds
    ds_read_b64_tr_b16 v[96:97], v128
    ds_read_b64_tr_b16 v[98:99], v128 offset:1024
    s_waitcnt lgkmcnt(10)
    v_mfma_f32_32x32x16_bf16 v[48:63], v[108:111], a[68:71], v[48:63]
    s_mul_i32 s92, s26, 0x6200
    s_add_u32 s92, s92, s86
    s_add_u32 m0, s99, 0x1a000
    s_add_u32 s92, s92, 0x3800
    buffer_load_dwordx4 v9, s[48:51], s92 offen lds
    ds_read_b64_tr_b16 v[100:101], v129
    ds_read_b64_tr_b16 v[102:103], v129 offset:1024
    s_waitcnt vmcnt(11) lgkmcnt(10)
    v_mfma_f32_32x32x16_bf16 v[32:47], v[112:115], a[72:75], v[32:47]
    ds_read_b64_tr_b16 v[104:105], v128 offset:8192
    ds_read_b64_tr_b16 v[106:107], v128 offset:9216
    s_waitcnt lgkmcnt(10)
    v_mfma_f32_32x32x16_bf16 v[48:63], v[116:119], a[72:75], v[48:63]
    s_mul_i32 s92, s26, 0x6200
    s_add_u32 s92, s92, s86
    s_add_u32 m0, s99, 0x1e000
    s_add_u32 s92, s92, 0x6200
    buffer_load_dwordx4 v9, s[48:51], s92 offen lds
    ds_read_b64_tr_b16 v[108:109], v129 offset:8192
    ds_read_b64_tr_b16 v[110:111], v129 offset:9216
    s_waitcnt vmcnt(11) lgkmcnt(10)
    v_mfma_f32_32x32x16_bf16 v[32:47], v[120:123], a[76:79], v[32:47]
    s_waitcnt lgkmcnt(8)
    v_mfma_f32_32x32x16_bf16 v[48:63], v[124:127], a[76:79], v[48:63]
    s_mul_i32 s92, s26, 0x6200
    s_add_u32 s92, s92, s86
    s_add_u32 m0, s99, 0x26000
    s_add_u32 s92, s92, 0x9a00
    buffer_load_dwordx4 v9, s[48:51], s92 offen lds
    s_waitcnt vmcnt(6)
    s_barrier
    ds_read_b64_tr_b16 v[112:113], v128 offset:16384
    ds_read_b64_tr_b16 v[114:115], v128 offset:17408
    ds_read_b64_tr_b16 v[116:117], v129 offset:16384
    ds_read_b64_tr_b16 v[118:119], v129 offset:17408
    s_waitcnt lgkmcnt(10)
    v_mfma_f32_32x32x16_bf16 v[32:47], v[96:99], a[80:83], v[32:47]
    s_add_u32 s14, s13, 0x180
    s_lshl_b32 s92, s25, 10
    s_add_u32 s92, s92, s10
    buffer_load_dwordx4 a[96:99], v2, s[60:63], s92 offen sc1
    ds_read_b64_tr_b16 v[120:121], v128 offset:24576
    ds_read_b64_tr_b16 v[122:123], v128 offset:25600
    s_waitcnt lgkmcnt(10)
    v_mfma_f32_32x32x16_bf16 v[48:63], v[100:103], a[80:83], v[48:63]
    s_lshl_b32 s92, s25, 10
    s_add_u32 s92, s92, s10
    buffer_load_dwordx4 a[100:103], v2, s[60:63], s92 offen offset:1024 sc1
    s_lshl_b32 s92, s25, 10
    s_add_u32 s92, s92, s10
    buffer_load_dwordx4 a[104:107], v2, s[60:63], s92 offen offset:2048 sc1
    ds_read_b64_tr_b16 v[124:125], v129 offset:24576
    ds_read_b64_tr_b16 v[126:127], v129 offset:25600
    s_waitcnt lgkmcnt(10)
    v_mfma_f32_32x32x16_bf16 v[32:47], v[104:107], a[84:87], v[32:47]
    s_lshl_b32 s92, s25, 10
    s_add_u32 s92, s92, s10
    buffer_load_dwordx4 a[108:111], v2, s[60:63], s92 offen offset:3072 sc1
    ds_read_b64_tr_b16 v[96:97], v128 offset:32768
    ds_read_b64_tr_b16 v[98:99], v128 offset:33792
    s_waitcnt lgkmcnt(10)
    v_mfma_f32_32x32x16_bf16 v[48:63], v[108:111], a[84:87], v[48:63]
    s_mul_i32 s92, s27, 0x6200
    s_add_u32 m0, s99, 0xc000
    s_add_u32 s92, s92, s86
    buffer_load_dwordx4 v9, s[48:51], s92 offen lds
    ds_read_b64_tr_b16 v[100:101], v129 offset:32768
    ds_read_b64_tr_b16 v[102:103], v129 offset:33792
    s_waitcnt lgkmcnt(10)
    v_mfma_f32_32x32x16_bf16 v[32:47], v[112:115], a[88:91], v[32:47]
    s_mul_i32 s92, s27, 0x6200
    s_add_u32 s92, s92, s86
    s_add_u32 m0, s99, 0x10000
    s_add_u32 s92, s92, 0x3800
    buffer_load_dwordx4 v9, s[48:51], s92 offen lds
    ds_read_b64_tr_b16 v[104:105], v128 offset:40960
    ds_read_b64_tr_b16 v[106:107], v128 offset:41984
    s_waitcnt lgkmcnt(10)
    v_mfma_f32_32x32x16_bf16 v[48:63], v[116:119], a[88:91], v[48:63]
    s_mul_i32 s92, s27, 0x6200
    s_add_u32 s92, s92, s86
    s_add_u32 m0, s99, 0x14000
    s_add_u32 s92, s92, 0x6200
    buffer_load_dwordx4 v9, s[48:51], s92 offen lds
    s_mul_i32 s92, s27, 0x6200
    s_add_u32 s92, s92, s86
    s_add_u32 m0, s99, 0x18000
    s_add_u32 s92, s92, 0x9a00
    buffer_load_dwordx4 v9, s[48:51], s92 offen lds
    ds_read_b64_tr_b16 v[108:109], v129 offset:40960
    ds_read_b64_tr_b16 v[110:111], v129 offset:41984
    s_waitcnt lgkmcnt(10)
    v_mfma_f32_32x32x16_bf16 v[32:47], v[120:123], a[92:95], v[32:47]
    s_waitcnt lgkmcnt(8)
    v_mfma_f32_32x32x16_bf16 v[48:63], v[124:127], a[92:95], v[48:63]
    v_lshrrev_b32 v20, 3, v1
    v_and_b32 v21, 7, v1
    v_xor_b32 v21, v21, v20
    s_lshl_b32 s93, s97, 6
    s_lshl_b32 s94, s68, 3
    s_add_u32 s93, s93, s94
    v_add_u32 v20, s93, v20
    v_mul_u32_u24 v20, 0x380, v20
    v_lshl_add_u32 v20, v21, 4, v20
    s_lshl_b32 s92, s98, 7
    s_add_u32 m0, s87, 0x1c000
    s_nop 0
    buffer_load_dwordx4 v20, s[28:31], s92 offen lds
    s_waitcnt vmcnt(11)
    s_barrier
    ds_read_b64_tr_b16 v[112:113], v128 offset:57344
    ds_read_b64_tr_b16 v[114:115], v128 offset:58368
    ds_read_b64_tr_b16 v[116:117], v129 offset:57344
    ds_read_b64_tr_b16 v[118:119], v129 offset:58368
    s_waitcnt vmcnt(8) lgkmcnt(10)
    v_mfma_f32_32x32x16_bf16 v[32:47], v[96:99], a[96:99], v[32:47]
    v_and_b32 v20, 7, v1
    v_lshrrev_b32 v21, 5, v1
    v_xor_b32 v21, v21, v20
    v_lshlrev_b32 v21, 4, v21
    v_and_b32 v20, 31, v1
    v_lshl_add_u32 v21, v20, 8, v21
    s_mov_b32 s94, 0x8000
    s_cmp_eq_u32 s69, 1
    s_cselect_b32 s94, 0xa000, s94
    s_cmp_eq_u32 s69, 2
    s_cselect_b32 s94, 0xe000, s94
    s_cmp_eq_u32 s69, 3
    s_cselect_b32 s94, 0x12000, s94
    v_add_u32 v14, s94, v21
    ds_read_b64_tr_b16 v[120:121], v130 offset:8192
    ds_read_b64_tr_b16 v[122:123], v130 offset:9216
    s_waitcnt lgkmcnt(10)
    v_mfma_f32_32x32x16_bf16 v[48:63], v[100:103], a[96:99], v[48:63]
    ds_read_b64_tr_b16 v[124:125], v131 offset:8192
    ds_read_b64_tr_b16 v[126:127], v131 offset:9216
    s_waitcnt vmcnt(7) lgkmcnt(10)
    v_mfma_f32_32x32x16_bf16 v[32:47], v[104:107], a[100:103], v[32:47]
    v_lshrrev_b32 v20, 3, v1
    v_and_b32 v21, 7, v1
    v_lshlrev_b32 v21, 1, v21
    v_xor_b32 v21, v21, v20
    v_lshlrev_b32 v21, 4, v21
    s_lshl_b32 s93, s69, 3
    v_add_u32 v20, s93, v20
    v_lshl_add_u32 v16, v20, 8, v21
    v_xor_b32 v17, 16, v16
    ds_read_b64_tr_b16 v[96:97], v130 offset:24576
    ds_read_b64_tr_b16 v[98:99], v130 offset:25600
    s_waitcnt lgkmcnt(10)
    v_mfma_f32_32x32x16_bf16 v[48:63], v[108:111], a[100:103], v[48:63]
    s_lshl_b32 s92, s26, 11
    s_add_u32 s92, s92, s11
    buffer_load_dwordx4 a[0:3], v2, s[60:63], s92 offen sc1
    s_lshl_b32 s92, s26, 11
    s_add_u32 s92, s92, s11
    buffer_load_dwordx4 a[4:7], v2, s[60:63], s92 offen offset:1024 sc1
    ds_read_b64_tr_b16 v[100:101], v131 offset:24576
    ds_read_b64_tr_b16 v[102:103], v131 offset:25600
    s_waitcnt vmcnt(8) lgkmcnt(10)
    v_mfma_f32_32x32x16_bf16 v[32:47], v[112:115], a[104:107], v[32:47]
    s_lshl_b32 s92, s26, 11
    s_add_u32 s92, s92, s11
    buffer_load_dwordx4 a[8:11], v2, s[60:63], s92 offen offset:2048 sc1
    ds_read_b64_tr_b16 v[104:105], v130 offset:40960
    ds_read_b64_tr_b16 v[106:107], v130 offset:41984
    s_waitcnt lgkmcnt(10)
    v_mfma_f32_32x32x16_bf16 v[48:63], v[116:119], a[104:107], v[48:63]
    s_lshl_b32 s92, s26, 11
    s_add_u32 s92, s92, s11
    buffer_load_dwordx4 a[12:15], v2, s[60:63], s92 offen offset:3072 sc1
    s_lshl_b32 s92, s27, 11
    s_add_u32 s92, s92, s11
    buffer_load_dwordx4 a[16:19], v2, s[60:63], s92 offen sc1
    ds_read_b64_tr_b16 v[108:109], v131 offset:40960
    ds_read_b64_tr_b16 v[110:111], v131 offset:41984
    s_waitcnt vmcnt(10) lgkmcnt(10)
    v_mfma_f32_32x32x16_bf16 v[32:47], v[120:123], a[108:111], v[32:47]
    s_lshl_b32 s92, s27, 11
    s_add_u32 s92, s92, s11
    buffer_load_dwordx4 a[20:23], v2, s[60:63], s92 offen offset:1024 sc1
    s_waitcnt lgkmcnt(8)
    v_mfma_f32_32x32x16_bf16 v[48:63], v[124:127], a[108:111], v[48:63]
    s_lshl_b32 s92, s27, 11
    s_add_u32 s92, s92, s11
    buffer_load_dwordx4 a[24:27], v2, s[60:63], s92 offen offset:2048 sc1
    s_lshl_b32 s92, s27, 11
    s_add_u32 s92, s92, s11
    buffer_load_dwordx4 a[28:31], v2, s[60:63], s92 offen offset:3072 sc1
    s_waitcnt vmcnt(11)
    s_waitcnt vmcnt(8)
    s_barrier
    ds_read_b64_tr_b16 v[112:113], v130 offset:57344
    ds_read_b64_tr_b16 v[114:115], v130 offset:58368
    ds_read_b64_tr_b16 v[116:117], v131 offset:57344
    ds_read_b64_tr_b16 v[118:119], v131 offset:58368
    s_waitcnt vmcnt(7) lgkmcnt(10)
    v_mfma_f32_32x32x16_bf16 v[64:79], v[96:99], a[0:3], 0
    ds_read_b64_tr_b16 v[120:121], v140 offset:24576
    ds_read_b64_tr_b16 v[122:123], v140 offset:25600
    s_waitcnt lgkmcnt(10)
    v_mfma_f32_32x32x16_bf16 v[80:95], v[100:103], a[0:3], 0
    ds_write_b128 v14, v[32:35]
    v_xor_b32 v22, 32, v14
    ds_write_b128 v22, v[36:39]
    ds_read_b64_tr_b16 v[124:125], v141 offset:24576
    ds_read_b64_tr_b16 v[126:127], v141 offset:25600
    s_waitcnt vmcnt(6) lgkmcnt(12)
    v_mfma_f32_32x32x16_bf16 v[64:79], v[104:107], a[4:7], v[64:79]
    v_xor_b32 v23, 64, v14
    ds_write_b128 v23, v[40:43]
    v_xor_b32 v22, 0x60, v14
    ds_write_b128 v22, v[44:47]
    ds_read_b64_tr_b16 v[96:97], v128 offset:49152
    ds_read_b64_tr_b16 v[98:99], v128 offset:50176
    s_waitcnt lgkmcnt(14)
    v_mfma_f32_32x32x16_bf16 v[80:95], v[108:111], a[4:7], v[80:95]
    v_xor_b32 v23, 0x80, v14
    ds_write_b128 v23, v[48:51]
    ds_read_b64_tr_b16 v[100:101], v129 offset:49152
    ds_read_b64_tr_b16 v[102:103], v129 offset:50176
    s_waitcnt vmcnt(5) lgkmcnt(15)
    v_mfma_f32_32x32x16_bf16 v[64:79], v[112:115], a[8:11], v[64:79]
    v_xor_b32 v22, 0xa0, v14
    ds_write_b128 v22, v[52:55]
    v_xor_b32 v23, 0xc0, v14
    ds_write_b128 v23, v[56:59]
    ds_read_b64_tr_b16 v[104:105], v130
    ds_read_b64_tr_b16 v[106:107], v130 offset:1024
    s_waitcnt lgkmcnt(15)
    v_mfma_f32_32x32x16_bf16 v[80:95], v[116:119], a[8:11], v[80:95]
    v_xor_b32 v22, 0xe0, v14
    ds_write_b128 v22, v[60:63]
    ds_read_b64_tr_b16 v[108:109], v131
    ds_read_b64_tr_b16 v[110:111], v131 offset:1024
    s_waitcnt vmcnt(4) lgkmcnt(15)
    v_mfma_f32_32x32x16_bf16 v[64:79], v[120:123], a[12:15], v[64:79]
    v_lshrrev_b32 v20, 3, v1
    v_and_b32 v21, 7, v1
    v_xor_b32 v21, v21, v20
    v_lshlrev_b32 v21, 4, v21
    v_lshl_add_u32 v21, v20, 7, v21
    s_lshl_b32 s93, s69, 10
    s_add_u32 s93, s93, 0x1d000
    v_add_u32 v21, s93, v21
    ds_read_b128 v[24:27], v21
    s_waitcnt lgkmcnt(15)
    v_mfma_f32_32x32x16_bf16 v[80:95], v[124:127], a[12:15], v[80:95]
    s_waitcnt lgkmcnt(0)
    s_barrier
    ds_read_b64_tr_b16 v[112:113], v130 offset:16384
    ds_read_b64_tr_b16 v[114:115], v130 offset:17408
    ds_read_b64_tr_b16 v[116:117], v131 offset:16384
    ds_read_b64_tr_b16 v[118:119], v131 offset:17408
    s_waitcnt vmcnt(3)
    v_mfma_f32_32x32x16_bf16 v[64:79], v[96:99], a[16:19], v[64:79]
    v_add_u32 v20, 0x8000, v16
    ds_read_b128 v[32:35], v20
    v_add_u32 v21, 0x8000, v17
    ds_read_b128 v[36:39], v21
    v_add_u32 v20, 0xa000, v16
    ds_read_b128 v[40:43], v20
    v_add_u32 v21, 0xa000, v17
    ds_read_b128 v[44:47], v21
    v_add_u32 v20, 0xe000, v16
    ds_read_b128 v[48:51], v20
    v_add_u32 v21, 0xe000, v17
    ds_read_b128 v[52:55], v21
    v_add_u32 v20, 0x12000, v16
    ds_read_b128 v[56:59], v20
    v_add_u32 v21, 0x12000, v17
    ds_read_b128 v[60:63], v21
    ds_read_b64_tr_b16 v[120:121], v130 offset:32768
    ds_read_b64_tr_b16 v[122:123], v130 offset:33792
    v_mfma_f32_32x32x16_bf16 v[80:95], v[100:103], a[16:19], v[80:95]
    s_waitcnt lgkmcnt(7)
    v_add_f32 v32, v32, v40
    v_add_f32 v33, v33, v41
    v_add_f32 v34, v34, v42
    v_add_f32 v35, v35, v43
    s_waitcnt lgkmcnt(6)
    v_add_f32 v36, v36, v44
    v_add_f32 v37, v37, v45
    v_add_f32 v38, v38, v46
    v_add_f32 v39, v39, v47
    s_waitcnt lgkmcnt(3)
    v_add_f32 v48, v48, v56
    v_add_f32 v49, v49, v57
    v_add_f32 v50, v50, v58
    v_add_f32 v51, v51, v59
    ds_read_b64_tr_b16 v[124:125], v131 offset:32768
    ds_read_b64_tr_b16 v[126:127], v131 offset:33792
    s_waitcnt vmcnt(2)
    v_mfma_f32_32x32x16_bf16 v[64:79], v[104:107], a[20:23], v[64:79]
    s_waitcnt lgkmcnt(4)
    v_add_f32 v52, v52, v60
    v_add_f32 v53, v53, v61
    v_add_f32 v54, v54, v62
    v_add_f32 v55, v55, v63
    v_add_f32 v32, v32, v48
    v_add_f32 v33, v33, v49
    v_add_f32 v34, v34, v50
    v_add_f32 v35, v35, v51
    v_add_f32 v36, v36, v52
    v_add_f32 v37, v37, v53
    v_add_f32 v38, v38, v54
    v_add_f32 v39, v39, v55
    v_mul_f32 v40, s82, v32
    v_mul_f32 v41, s82, v33
    v_mfma_f32_32x32x16_bf16 v[80:95], v[108:111], a[20:23], v[80:95]
    v_mul_f32 v42, s82, v34
    v_mul_f32 v43, s82, v35
    v_mul_f32 v44, s82, v36
    v_mul_f32 v45, s82, v37
    v_mul_f32 v46, s82, v38
    v_mul_f32 v47, s82, v39
    v_exp_f32 v40, v40
    v_exp_f32 v41, v41
    v_exp_f32 v42, v42
    v_exp_f32 v43, v43
    s_waitcnt vmcnt(1)
    v_mfma_f32_32x32x16_bf16 v[64:79], v[112:115], a[24:27], v[64:79]
    v_exp_f32 v44, v44
    v_exp_f32 v45, v45
    v_exp_f32 v46, v46
    v_exp_f32 v47, v47
    v_fma_f32 v40, v40, s83, s83
    v_fma_f32 v41, v41, s83, s83
    v_fma_f32 v42, v42, s83, s83
    v_fma_f32 v43, v43, s83, s83
    v_fma_f32 v44, v44, s83, s83
    v_fma_f32 v45, v45, s83, s83
    v_mfma_f32_32x32x16_bf16 v[80:95], v[116:119], a[24:27], v[80:95]
    v_fma_f32 v46, v46, s83, s83
    v_fma_f32 v47, v47, s83, s83
    v_rcp_f32 v40, v40
    v_rcp_f32 v41, v41
    v_rcp_f32 v42, v42
    v_rcp_f32 v43, v43
    v_rcp_f32 v44, v44
    v_rcp_f32 v45, v45
    s_waitcnt vmcnt(0) lgkmcnt(2)
    v_mfma_f32_32x32x16_bf16 v[64:79], v[120:123], a[28:31], v[64:79]
    v_rcp_f32 v46, v46
    v_rcp_f32 v47, v47
    v_mul_f32 v32, v32, v40
    v_mul_f32 v33, v33, v41
    v_mul_f32 v34, v34, v42
    v_mul_f32 v35, v35, v43
    v_mul_f32 v36, v36, v44
    v_mul_f32 v37, v37, v45
    v_mul_f32 v38, v38, v46
    v_mul_f32 v39, v39, v47
    v_lshlrev_b32 v48, 16, v24
    v_and_b32 v49, s81, v24
    v_lshlrev_b32 v50, 16, v25
    s_waitcnt lgkmcnt(0)
    v_mfma_f32_32x32x16_bf16 v[80:95], v[124:127], a[28:31], v[80:95]
    v_and_b32 v51, s81, v25
    v_lshlrev_b32 v52, 16, v26
    v_and_b32 v53, s81, v26
    v_lshlrev_b32 v54, 16, v27
    v_and_b32 v55, s81, v27
    v_and_b32 v20, 7, v1
    v_lshrrev_b32 v21, 5, v1
    v_xor_b32 v21, v21, v20
    v_lshlrev_b32 v21, 4, v21
    v_and_b32 v20, 31, v1
    v_lshl_add_u32 v21, v20, 8, v21
    s_mov_b32 s94, 0x16000
    s_cmp_eq_u32 s69, 1
    s_cselect_b32 s94, 0x1a000, s94
    s_cmp_eq_u32 s69, 2
    s_cselect_b32 s94, 0x1e000, s94
    s_cmp_eq_u32 s69, 3
    s_cselect_b32 s94, 0x26000, s94
    v_add_u32 v15, s94, v21
    ds_write_b128 v15, v[64:67]
    v_xor_b32 v22, 32, v15
    ds_write_b128 v22, v[68:71]
    v_xor_b32 v23, 64, v15
    ds_write_b128 v23, v[72:75]
    v_xor_b32 v22, 0x60, v15
    ds_write_b128 v22, v[76:79]
    v_xor_b32 v23, 0x80, v15
    ds_write_b128 v23, v[80:83]
    v_xor_b32 v22, 0xa0, v15
    ds_write_b128 v22, v[84:87]
    v_xor_b32 v23, 0xc0, v15
    ds_write_b128 v23, v[88:91]
    v_xor_b32 v22, 0xe0, v15
    ds_write_b128 v22, v[92:95]
    s_waitcnt lgkmcnt(0)
    s_barrier
    v_add_u32 v20, 0x16000, v16
    ds_read_b128 v[96:99], v20
    v_add_u32 v21, 0x16000, v17
    ds_read_b128 v[100:103], v21
    v_add_u32 v20, 0x1a000, v16
    ds_read_b128 v[104:107], v20
    v_add_u32 v21, 0x1a000, v17
    ds_read_b128 v[108:111], v21
    v_add_u32 v20, 0x1e000, v16
    ds_read_b128 v[112:115], v20
    v_add_u32 v21, 0x1e000, v17
    ds_read_b128 v[116:119], v21
    v_add_u32 v20, 0x26000, v16
    ds_read_b128 v[120:123], v20
    v_add_u32 v21, 0x26000, v17
    ds_read_b128 v[124:127], v21
    s_waitcnt lgkmcnt(5)
    v_add_f32 v96, v96, v104
    v_add_f32 v97, v97, v105
    v_add_f32 v98, v98, v106
    v_add_f32 v99, v99, v107
    s_waitcnt lgkmcnt(4)
    v_add_f32 v100, v100, v108
    v_add_f32 v101, v101, v109
    v_add_f32 v102, v102, v110
    v_add_f32 v103, v103, v111
    s_waitcnt lgkmcnt(1)
    v_add_f32 v112, v112, v120
    v_add_f32 v113, v113, v121
    v_add_f32 v114, v114, v122
    v_add_f32 v115, v115, v123
    s_waitcnt lgkmcnt(0)
    v_add_f32 v116, v116, v124
    v_add_f32 v117, v117, v125
    v_add_f32 v118, v118, v126
    v_add_f32 v119, v119, v127
    v_add_f32 v96, v96, v112
    v_add_f32 v97, v97, v113
    v_add_f32 v98, v98, v114
    v_add_f32 v99, v99, v115
    v_add_f32 v100, v100, v116
    v_add_f32 v101, v101, v117
    v_add_f32 v102, v102, v118
    v_add_f32 v103, v103, v119
    v_fma_f32 v96, v96, v32, v48
    v_fma_f32 v97, v97, v33, v49
    v_fma_f32 v98, v98, v34, v50
    v_fma_f32 v99, v99, v35, v51
    v_fma_f32 v100, v100, v36, v52
    v_fma_f32 v101, v101, v37, v53
    v_fma_f32 v102, v102, v38, v54
    v_fma_f32 v103, v103, v39, v55
    v_cvt_pk_bf16_f32 v64, v96, v97
    v_cvt_pk_bf16_f32 v65, v98, v99
    v_cvt_pk_bf16_f32 v66, v100, v101
    v_cvt_pk_bf16_f32 v67, v102, v103
    buffer_store_dwordx4 v[64:67], v8, s[56:59], 0 offen
L_fin_2001:
    s_endpgm
.p2align 3
L_PROG2:
    s_waitcnt vmcnt(3)
    v_dot2c_f32_bf16 v128, s84, v44
    v_dot2c_f32_bf16 v130, v44, v44
    s_waitcnt vmcnt(2)
    v_dot2c_f32_bf16 v129, s84, v72
    v_dot2c_f32_bf16 v131, v72, v72
    s_add_u32 m0, s87, 0xc000
    s_mul_i32 s92, s74, 0x2a000
    buffer_load_dwordx4 v9, s[32:35], s92 offen lds
    v_dot2c_f32_bf16 v128, s84, v45
    v_dot2c_f32_bf16 v130, v45, v45
    v_dot2c_f32_bf16 v129, s84, v73
    v_dot2c_f32_bf16 v131, v73, v73
    v_dot2c_f32_bf16 v128, s84, v46
    v_dot2c_f32_bf16 v130, v46, v46
    s_and_b32 s93, s68, 3
    s_lshl_b32 s27, s93, 10
    v_add_u32 v22, s27, v2
    s_mul_i32 s92, s72, 0xc40
    s_add_u32 m0, s27, 0x8000
    s_nop 0
    buffer_load_dwordx4 v22, s[52:55], s92 offen lds
    v_dot2c_f32_bf16 v129, s84, v74
    v_dot2c_f32_bf16 v131, v74, v74
    v_dot2c_f32_bf16 v128, s84, v47
    v_dot2c_f32_bf16 v130, v47, v47
    v_dot2c_f32_bf16 v129, s84, v75
    v_dot2c_f32_bf16 v131, v75, v75
    s_mul_i32 s93, s72, 0x1c0
    s_bitcmp1_b32 s72, 0
    s_cselect_b32 s88, 0xc0, 0
    s_add_u32 s89, s88, 0x80
    s_add_u32 s88, s88, s93
    s_add_u32 s89, s89, s93
    s_waitcnt vmcnt(3)
    v_dot2c_f32_bf16 v128, s84, v48
    v_dot2c_f32_bf16 v130, v48, v48
    s_waitcnt vmcnt(2)
    v_dot2c_f32_bf16 v129, s84, v76
    v_dot2c_f32_bf16 v131, v76, v76
    v_dot2c_f32_bf16 v128, s84, v49
    v_dot2c_f32_bf16 v130, v49, v49
    v_dot2c_f32_bf16 v129, s84, v77
    s_sub_u32 s93, s91, 0x920000
    s_lshl_b32 s93, s93, 2
    s_add_u32 s16, s93, 0x930000
    v_dot2c_f32_bf16 v131, v77, v77
    v_dot2c_f32_bf16 v128, s84, v50
    v_dot2c_f32_bf16 v130, v50, v50
    v_dot2c_f32_bf16 v129, s84, v78
    v_dot2c_f32_bf16 v131, v78, v78
    v_dot2c_f32_bf16 v128, s84, v51
    s_cmp_lg_u32 s68, 0
    s_cbranch_scc1 L_zero_3001
    v_mov_b32 v92, 0
    v_mov_b32 v93, 0
    v_mov_b32 v94, 0
    v_mov_b32 v95, 0
    s_mov_b32 exec_lo, -1
    s_mov_b32 exec_hi, 0
    buffer_store_dwordx4 v[92:95], v2, s[60:63], s16 offen sc1
    s_mov_b64 exec, -1
L_zero_3001:
    v_dot2c_f32_bf16 v130, v51, v51
    v_dot2c_f32_bf16 v129, s84, v79
    v_dot2c_f32_bf16 v131, v79, v79
    v_add_f32_dpp v128, v128, v128 quad_perm:[1,0,3,2] row_mask:0xf bank_mask:0xf
    v_add_f32_dpp v130, v130, v130 quad_perm:[1,0,3,2] row_mask:0xf bank_mask:0xf
    v_add_f32_dpp v129, v129, v129 quad_perm:[1,0,3,2] row_mask:0xf bank_mask:0xf
    v_add_f32_dpp v131, v131, v131 quad_perm:[1,0,3,2] row_mask:0xf bank_mask:0xf
    v_add_f32_dpp v128, v128, v128 quad_perm:[2,3,0,1] row_mask:0xf bank_mask:0xf
    v_add_f32_dpp v130, v130, v130 quad_perm:[2,3,0,1] row_mask:0xf bank_mask:0xf
    v_add_f32_dpp v129, v129, v129 quad_perm:[2,3,0,1] row_mask:0xf bank_mask:0xf
    v_add_f32_dpp v131, v131, v131 quad_perm:[2,3,0,1] row_mask:0xf bank_mask:0xf
    v_add_f32_dpp v128, v128, v128 row_half_mirror row_mask:0xf bank_mask:0xf
    v_add_f32_dpp v130, v130, v130 row_half_mirror row_mask:0xf bank_mask:0xf
    v_add_f32_dpp v129, v129, v129 row_half_mirror row_mask:0xf bank_mask:0xf
    v_add_f32_dpp v131, v131, v131 row_half_mirror row_mask:0xf bank_mask:0xf
    v_mul_f32 v128, 0xbb124925, v128
    v_mul_f32 v130, 0x3b124925, v130
    v_mul_f32 v129, 0xbb124925, v129
    v_mul_f32 v131, 0x3b124925, v131
    v_fma_f32 v130, -v128, v128, v130
    v_fma_f32 v131, -v129, v129, v131
    v_max_f32 v130, 0, v130
    v_max_f32 v131, 0, v131
    v_add_f32 v130, 0x3727c5ac, v130
    v_add_f32 v131, 0x3727c5ac, v131
    v_rsq_f32 v130, v130
    v_rsq_f32 v131, v131
    s_nop 0
    v_mul_f32 v130, 0xbfb8aa3b, v130
    v_mul_f32 v131, 0xbfb8aa3b, v131
    v_mul_f32 v128, v128, v130
    v_mul_f32 v129, v129, v131
    v_lshlrev_b32 v120, 16, v24
    v_and_b32 v121, s81, v24
    v_lshlrev_b32 v122, 16, v25
    v_and_b32 v123, s81, v25
    v_lshlrev_b32 v124, 16, v26
    v_and_b32 v125, s81, v26
    v_lshlrev_b32 v126, 16, v27
    v_and_b32 v127, s81, v27
    v_fma_f32 v120, v120, v130, v128
    v_fma_f32 v121, v121, v130, v128
    v_fma_f32 v122, v122, v130, v128
    v_fma_f32 v123, v123, v130, v128
    v_fma_f32 v124, v124, v130, v128
    v_fma_f32 v125, v125, v130, v128
    v_fma_f32 v126, v126, v130, v128
    v_fma_f32 v127, v127, v130, v128
    v_cvt_pk_bf16_f32 v24, v120, v121
    v_cvt_pk_bf16_f32 v25, v122, v123
    v_cvt_pk_bf16_f32 v26, v124, v125
    v_cvt_pk_bf16_f32 v27, v126, v127
    ds_write_b128 v3, v[24:27]
    v_lshlrev_b32 v120, 16, v52
    v_and_b32 v121, s81, v52
    v_lshlrev_b32 v122, 16, v53
    v_and_b32 v123, s81, v53
    v_lshlrev_b32 v124, 16, v54
    v_and_b32 v125, s81, v54
    v_lshlrev_b32 v126, 16, v55
    v_and_b32 v127, s81, v55
    v_fma_f32 v120, v120, v131, v129
    v_fma_f32 v121, v121, v131, v129
    v_fma_f32 v122, v122, v131, v129
    v_fma_f32 v123, v123, v131, v129
    v_fma_f32 v124, v124, v131, v129
    v_fma_f32 v125, v125, v131, v129
    v_fma_f32 v126, v126, v131, v129
    v_fma_f32 v127, v127, v131, v129
    v_cvt_pk_bf16_f32 v52, v120, v121
    v_cvt_pk_bf16_f32 v53, v122, v123
    v_cvt_pk_bf16_f32 v54, v124, v125
    v_cvt_pk_bf16_f32 v55, v126, v127
    ds_write_b128 v3, v[52:55] offset:128
    s_waitcnt lgkmcnt(0)
    s_barrier
    ds_read_b128 a[0:3], v4
    ds_read_b128 a[4:7], v5
    ds_read_b128 a[8:11], v6
    ds_read_b128 a[12:15], v7
    v_lshlrev_b32 v120, 16, v28
    v_and_b32 v121, s81, v28
    s_add_u32 m0, s87, 0xe000
    s_mul_i32 s92, s75, 0x2a000
    buffer_load_dwordx4 v9, s[32:35], s92 offen lds
    v_lshlrev_b32 v122, 16, v29
    v_and_b32 v123, s81, v29
    v_lshlrev_b32 v124, 16, v30
    v_and_b32 v125, s81, v30
    v_lshlrev_b32 v126, 16, v31
    v_and_b32 v127, s81, v31
    v_fma_f32 v120, v120, v130, v128
    v_fma_f32 v121, v121, v130, v128
    v_fma_f32 v122, v122, v130, v128
    v_fma_f32 v123, v123, v130, v128
    v_fma_f32 v124, v124, v130, v128
    v_fma_f32 v125, v125, v130, v128
    v_fma_f32 v126, v126, v130, v128
    v_fma_f32 v127, v127, v130, v128
    v_cvt_pk_bf16_f32 v28, v120, v121
    v_cvt_pk_bf16_f32 v29, v122, v123
    v_cvt_pk_bf16_f32 v30, v124, v125
    v_cvt_pk_bf16_f32 v31, v126, v127
    s_add_u32 m0, s87, 0x10000
    s_mul_i32 s92, s76, 0x2a000
    buffer_load_dwordx4 v9, s[32:35], s92 offen lds
    ds_write_b128 v3, v[28:31] offset:16384
    v_lshlrev_b32 v120, 16, v56
    v_and_b32 v121, s81, v56
    v_lshlrev_b32 v122, 16, v57
    v_and_b32 v123, s81, v57
    v_lshlrev_b32 v124, 16, v58
    v_and_b32 v125, s81, v58
    v_lshlrev_b32 v126, 16, v59
    v_and_b32 v127, s81, v59
    v_fma_f32 v120, v120, v131, v129
    v_fma_f32 v121, v121, v131, v129
    v_fma_f32 v122, v122, v131, v129
    v_fma_f32 v123, v123, v131, v129
    v_fma_f32 v124, v124, v131, v129
    v_fma_f32 v125, v125, v131, v129
    v_fma_f32 v126, v126, v131, v129
    v_fma_f32 v127, v127, v131, v129
    v_cvt_pk_bf16_f32 v56, v120, v121
    v_cvt_pk_bf16_f32 v57, v122, v123
    v_cvt_pk_bf16_f32 v58, v124, v125
    v_cvt_pk_bf16_f32 v59, v126, v127
    ds_write_b128 v3, v[56:59] offset:16512
    s_waitcnt vmcnt(2)
    s_waitcnt lgkmcnt(0)
    s_barrier
    ds_read_b64_tr_b16 v[132:133], v143
    ds_read_b64_tr_b16 v[134:135], v143 offset:448
    ds_read_b64_tr_b16 v[136:137], v143 offset:896
    ds_read_b64_tr_b16 v[138:139], v143 offset:1344
    v_add_u32 v22, 0xc000, v8
    ds_read_b64_tr_b16 v[112:113], v22
    ds_read_b64_tr_b16 v[114:115], v22 offset:512
    ds_read_b64_tr_b16 v[116:117], v22 offset:2048
    ds_read_b64_tr_b16 v[118:119], v22 offset:2560
    ds_read_b64_tr_b16 v[24:25], v22 offset:4096
    ds_read_b64_tr_b16 v[26:27], v22 offset:4608
    ds_read_b64_tr_b16 v[52:53], v22 offset:6144
    ds_read_b64_tr_b16 v[54:55], v22 offset:6656
    s_waitcnt lgkmcnt(6)
    v_mfma_f32_32x32x16_bf16 v[80:95], v[112:115], a[0:3], 0
    ds_read_b128 a[16:19], v4 offset:16384
    ds_read_b128 a[20:23], v5 offset:16384
    s_add_u32 m0, s87, 0x12000
    s_mul_i32 s92, s77, 0x2a000
    buffer_load_dwordx4 v9, s[32:35], s92 offen lds
    ds_read_b128 a[24:27], v6 offset:16384
    ds_read_b128 a[28:31], v7 offset:16384
    v_lshlrev_b32 v120, 16, v32
    v_and_b32 v121, s81, v32
    v_lshlrev_b32 v122, 16, v33
    v_and_b32 v123, s81, v33
    v_lshlrev_b32 v124, 16, v34
    v_and_b32 v125, s81, v34
    v_lshlrev_b32 v126, 16, v35
    s_waitcnt lgkmcnt(8)
    v_mfma_f32_32x32x16_bf16 v[80:95], v[116:119], a[4:7], v[80:95]
    v_and_b32 v127, s81, v35
    s_mul_i32 s92, s74, 0x38000
    s_add_u32 m0, s87, 0x1a000
    s_add_u32 s92, s92, s88
    buffer_load_dwordx4 v10, s[36:39], s92 offen lds
    v_fma_f32 v120, v120, v130, v128
    v_fma_f32 v121, v121, v130, v128
    v_fma_f32 v122, v122, v130, v128
    v_fma_f32 v123, v123, v130, v128
    v_fma_f32 v124, v124, v130, v128
    v_fma_f32 v125, v125, v130, v128
    v_fma_f32 v126, v126, v130, v128
    v_fma_f32 v127, v127, v130, v128
    v_cvt_pk_bf16_f32 v32, v120, v121
    v_cvt_pk_bf16_f32 v33, v122, v123
    s_waitcnt lgkmcnt(6)
    v_mfma_f32_32x32x16_bf16 v[80:95], v[24:27], a[8:11], v[80:95]
    v_cvt_pk_bf16_f32 v34, v124, v125
    s_mul_i32 s92, s74, 0x38000
    s_add_u32 m0, s87, 0x1c000
    s_add_u32 s92, s92, s88
    buffer_load_dwordx4 v11, s[40:43], s92 offen lds
    v_cvt_pk_bf16_f32 v35, v126, v127
    ds_write_b128 v3, v[32:35]
    v_lshlrev_b32 v120, 16, v60
    v_and_b32 v121, s81, v60
    v_lshlrev_b32 v122, 16, v61
    v_and_b32 v123, s81, v61
    v_lshlrev_b32 v124, 16, v62
    v_and_b32 v125, s81, v62
    v_lshlrev_b32 v126, 16, v63
    v_and_b32 v127, s81, v63
    s_waitcnt lgkmcnt(5)
    v_mfma_f32_32x32x16_bf16 v[80:95], v[52:55], a[12:15], v[80:95]
    v_fma_f32 v120, v120, v131, v129
    v_fma_f32 v121, v121, v131, v129
    v_fma_f32 v122, v122, v131, v129
    v_fma_f32 v123, v123, v131, v129
    v_fma_f32 v124, v124, v131, v129
    v_fma_f32 v125, v125, v131, v129
    v_fma_f32 v126, v126, v131, v129
    v_fma_f32 v127, v127, v131, v129
    v_cvt_pk_bf16_f32 v60, v120, v121
    v_cvt_pk_bf16_f32 v61, v122, v123
    v_cvt_pk_bf16_f32 v62, v124, v125
    v_cvt_pk_bf16_f32 v63, v126, v127
    ds_write_b128 v3, v[60:63] offset:128
    v_and_b32 v138, v16, v138
    v_and_b32 v139, v16, v139
    s_waitcnt vmcnt(4)
    s_waitcnt vmcnt(3)
    s_waitcnt lgkmcnt(0)
    s_barrier
    v_add_u32 v23, 0xe000, v8
    ds_read_b64_tr_b16 v[112:113], v23
    ds_read_b64_tr_b16 v[114:115], v23 offset:512
    ds_read_b64_tr_b16 v[116:117], v23 offset:2048
    ds_read_b64_tr_b16 v[118:119], v23 offset:2560
    ds_read_b64_tr_b16 v[24:25], v23 offset:4096
    ds_read_b64_tr_b16 v[26:27], v23 offset:4608
    ds_read_b64_tr_b16 v[52:53], v23 offset:6144
    ds_read_b64_tr_b16 v[54:55], v23 offset:6656
    s_waitcnt lgkmcnt(6)
    v_mfma_f32_32x32x16_bf16 v[80:95], v[112:115], a[16:19], v[80:95]
    ds_read_b128 a[32:35], v4
    ds_read_b128 a[36:39], v5
    s_add_u32 m0, s87, 0x14000
    s_mul_i32 s92, s78, 0x2a000
    buffer_load_dwordx4 v9, s[32:35], s92 offen lds
    ds_read_b128 a[40:43], v6
    ds_read_b128 a[44:47], v7
    v_lshlrev_b32 v120, 16, v36
    v_and_b32 v121, s81, v36
    v_lshlrev_b32 v122, 16, v37
    v_and_b32 v123, s81, v37
    v_lshlrev_b32 v124, 16, v38
    s_mul_i32 s92, s75, 0x38000
    s_add_u32 m0, s87, 0x1e000
    s_add_u32 s92, s92, s88
    buffer_load_dwordx4 v10, s[36:39], s92 offen lds
    v_add_u32 v22, 0x10000, v8
    ds_read_b64_tr_b16 v[112:113], v22
    ds_read_b64_tr_b16 v[114:115], v22 offset:512
    s_waitcnt lgkmcnt(10)
    v_mfma_f32_32x32x16_bf16 v[80:95], v[116:119], a[20:23], v[80:95]
    v_and_b32 v125, s81, v38
    v_lshlrev_b32 v126, 16, v39
    v_and_b32 v127, s81, v39
    v_fma_f32 v120, v120, v130, v128
    v_fma_f32 v121, v121, v130, v128
    v_fma_f32 v122, v122, v130, v128
    s_mul_i32 s92, s75, 0x38000
    s_add_u32 m0, s87, 0x20000
    s_add_u32 s92, s92, s88
    buffer_load_dwordx4 v11, s[40:43], s92 offen lds
    v_fma_f32 v123, v123, v130, v128
    v_fma_f32 v124, v124, v130, v128
    v_fma_f32 v125, v125, v130, v128
    v_fma_f32 v126, v126, v130, v128
    v_fma_f32 v127, v127, v130, v128
    v_cvt_pk_bf16_f32 v36, v120, v121
    ds_read_b64_tr_b16 v[116:117], v22 offset:2048
    ds_read_b64_tr_b16 v[118:119], v22 offset:2560
    s_waitcnt lgkmcnt(10)
    v_mfma_f32_32x32x16_bf16 v[80:95], v[24:27], a[24:27], v[80:95]
    v_cvt_pk_bf16_f32 v37, v122, v123
    s_cmp_lg_u32 s68, 0
    s_cbranch_scc1 L_zsig_3002
    v_mov_b32 v20, 1
    v_mov_b32 v21, 0
    s_and_b32 s93, s2, 3
    s_lshl_b32 s93, s93, 6
    s_mov_b64 exec, 1
    buffer_atomic_add v20, v21, s[64:67], s93 offen
    s_mov_b64 exec, -1
L_zsig_3002:
    v_cvt_pk_bf16_f32 v38, v124, v125
    v_cvt_pk_bf16_f32 v39, v126, v127
    ds_write_b128 v3, v[36:39] offset:16384
    v_lshlrev_b32 v120, 16, v64
    v_and_b32 v121, s81, v64
    v_lshlrev_b32 v122, 16, v65
    v_and_b32 v123, s81, v65
    v_lshlrev_b32 v124, 16, v66
    ds_read_b64_tr_b16 v[24:25], v22 offset:4096
    ds_read_b64_tr_b16 v[26:27], v22 offset:4608
    s_waitcnt lgkmcnt(11)
    v_mfma_f32_32x32x16_bf16 v[80:95], v[52:55], a[28:31], v[80:95]
    v_and_b32 v125, s81, v66
    v_lshlrev_b32 v126, 16, v67
    v_and_b32 v127, s81, v67
    v_fma_f32 v120, v120, v131, v129
    v_fma_f32 v121, v121, v131, v129
    v_fma_f32 v122, v122, v131, v129
    v_fma_f32 v123, v123, v131, v129
    v_fma_f32 v124, v124, v131, v129
    v_fma_f32 v125, v125, v131, v129
    v_fma_f32 v126, v126, v131, v129
    v_fma_f32 v127, v127, v131, v129
    v_cvt_pk_bf16_f32 v64, v120, v121
    v_cvt_pk_bf16_f32 v65, v122, v123
    v_cvt_pk_bf16_f32 v66, v124, v125
    v_cvt_pk_bf16_f32 v67, v126, v127
    ds_write_b128 v3, v[64:67] offset:16512
    s_waitcnt vmcnt(5)
    s_waitcnt lgkmcnt(0)
    s_barrier
    ds_read_b64_tr_b16 v[52:53], v22 offset:6144
    ds_read_b64_tr_b16 v[54:55], v22 offset:6656
    v_mfma_f32_32x32x16_bf16 v[80:95], v[112:115], a[32:35], v[80:95]
    ds_read_b128 a[48:51], v4 offset:16384
    ds_read_b128 a[52:55], v5 offset:16384
    s_add_u32 m0, s87, 0x16000
    s_mul_i32 s92, s79, 0x2a000
    buffer_load_dwordx4 v9, s[32:35], s92 offen lds
    ds_read_b128 a[56:59], v6 offset:16384
    ds_read_b128 a[60:63], v7 offset:16384
    v_lshlrev_b32 v120, 16, v40
    v_and_b32 v121, s81, v40
    v_lshlrev_b32 v122, 16, v41
    v_and_b32 v123, s81, v41
    v_lshlrev_b32 v124, 16, v42
    v_and_b32 v125, s81, v42
    v_lshlrev_b32 v126, 16, v43
    v_add_u32 v23, 0x12000, v8
    ds_read_b64_tr_b16 v[112:113], v23
    ds_read_b64_tr_b16 v[114:115], v23 offset:512
    v_mfma_f32_32x32x16_bf16 v[80:95], v[116:119], a[36:39], v[80:95]
    v_and_b32 v127, s81, v43
    s_mul_i32 s92, s76, 0x38000
    s_add_u32 m0, s87, 0x22000
    s_add_u32 s92, s92, s88
    buffer_load_dwordx4 v10, s[36:39], s92 offen lds
    v_fma_f32 v120, v120, v130, v128
    v_fma_f32 v121, v121, v130, v128
    v_fma_f32 v122, v122, v130, v128
    v_fma_f32 v123, v123, v130, v128
    v_fma_f32 v124, v124, v130, v128
    v_fma_f32 v125, v125, v130, v128
    v_fma_f32 v126, v126, v130, v128
    v_fma_f32 v127, v127, v130, v128
    v_cvt_pk_bf16_f32 v40, v120, v121
    ds_read_b64_tr_b16 v[116:117], v23 offset:2048
    ds_read_b64_tr_b16 v[118:119], v23 offset:2560
    v_mfma_f32_32x32x16_bf16 v[80:95], v[24:27], a[40:43], v[80:95]
    v_cvt_pk_bf16_f32 v41, v122, v123
    s_mul_i32 s92, s76, 0x38000
    s_add_u32 m0, s87, 0x24000
    s_add_u32 s92, s92, s88
    buffer_load_dwordx4 v11, s[40:43], s92 offen lds
    v_cvt_pk_bf16_f32 v42, v124, v125
    v_cvt_pk_bf16_f32 v43, v126, v127
    ds_write_b128 v3, v[40:43]
    v_lshlrev_b32 v120, 16, v68
    v_and_b32 v121, s81, v68
    v_lshlrev_b32 v122, 16, v69
    v_and_b32 v123, s81, v69
    v_lshlrev_b32 v124, 16, v70
    v_and_b32 v125, s81, v70
    v_lshlrev_b32 v126, 16, v71
    ds_read_b64_tr_b16 v[24:25], v23 offset:4096
    ds_read_b64_tr_b16 v[26:27], v23 offset:4608
    s_waitcnt lgkmcnt(11)
    v_mfma_f32_32x32x16_bf16 v[80:95], v[52:55], a[44:47], v[80:95]
    v_and_b32 v127, s81, v71
    v_fma_f32 v120, v120, v131, v129
    v_fma_f32 v121, v121, v131, v129
    v_fma_f32 v122, v122, v131, v129
    v_fma_f32 v123, v123, v131, v129
    v_fma_f32 v124, v124, v131, v129
    v_fma_f32 v125, v125, v131, v129
    v_fma_f32 v126, v126, v131, v129
    v_fma_f32 v127, v127, v131, v129
    v_cvt_pk_bf16_f32 v68, v120, v121
    v_cvt_pk_bf16_f32 v69, v122, v123
    v_cvt_pk_bf16_f32 v70, v124, v125
    v_cvt_pk_bf16_f32 v71, v126, v127
    ds_write_b128 v3, v[68:71] offset:128
    s_waitcnt vmcnt(5)
    s_waitcnt lgkmcnt(0)
    s_barrier
    ds_read_b64_tr_b16 v[52:53], v23 offset:6144
    ds_read_b64_tr_b16 v[54:55], v23 offset:6656
    v_mfma_f32_32x32x16_bf16 v[80:95], v[112:115], a[48:51], v[80:95]
    ds_read_b128 a[64:67], v4
    ds_read_b128 a[68:71], v5
    s_add_u32 m0, s87, 0x18000
    s_mul_i32 s92, s80, 0x2a000
    buffer_load_dwordx4 v9, s[32:35], s92 offen lds
    ds_read_b128 a[72:75], v6
    ds_read_b128 a[76:79], v7
    v_lshlrev_b32 v120, 16, v44
    v_and_b32 v121, s81, v44
    v_lshlrev_b32 v122, 16, v45
    v_and_b32 v123, s81, v45
    v_lshlrev_b32 v124, 16, v46
    v_and_b32 v125, s81, v46
    v_lshlrev_b32 v126, 16, v47
    v_add_u32 v22, 0x14000, v8
    ds_read_b64_tr_b16 v[112:113], v22
    ds_read_b64_tr_b16 v[114:115], v22 offset:512
    v_mfma_f32_32x32x16_bf16 v[80:95], v[116:119], a[52:55], v[80:95]
    v_and_b32 v127, s81, v47
    s_mul_i32 s92, s77, 0x38000
    s_add_u32 m0, s87, 0xc000
    s_add_u32 s92, s92, s88
    buffer_load_dwordx4 v10, s[36:39], s92 offen lds
    v_fma_f32 v120, v120, v130, v128
    v_fma_f32 v121, v121, v130, v128
    v_fma_f32 v122, v122, v130, v128
    v_fma_f32 v123, v123, v130, v128
    v_fma_f32 v124, v124, v130, v128
    v_fma_f32 v125, v125, v130, v128
    v_fma_f32 v126, v126, v130, v128
    v_fma_f32 v127, v127, v130, v128
    v_cvt_pk_bf16_f32 v44, v120, v121
    ds_read_b64_tr_b16 v[116:117], v22 offset:2048
    ds_read_b64_tr_b16 v[118:119], v22 offset:2560
    v_mfma_f32_32x32x16_bf16 v[80:95], v[24:27], a[56:59], v[80:95]
    v_cvt_pk_bf16_f32 v45, v122, v123
    s_mul_i32 s92, s77, 0x38000
    s_add_u32 m0, s87, 0xe000
    s_add_u32 s92, s92, s88
    buffer_load_dwordx4 v11, s[40:43], s92 offen lds
    v_cvt_pk_bf16_f32 v46, v124, v125
    v_cvt_pk_bf16_f32 v47, v126, v127
    ds_write_b128 v3, v[44:47] offset:16384
    v_lshlrev_b32 v120, 16, v72
    v_and_b32 v121, s81, v72
    v_lshlrev_b32 v122, 16, v73
    v_and_b32 v123, s81, v73
    v_lshlrev_b32 v124, 16, v74
    v_and_b32 v125, s81, v74
    v_lshlrev_b32 v126, 16, v75
    ds_read_b64_tr_b16 v[24:25], v22 offset:4096
    ds_read_b64_tr_b16 v[26:27], v22 offset:4608
    s_waitcnt lgkmcnt(11)
    v_mfma_f32_32x32x16_bf16 v[80:95], v[52:55], a[60:63], v[80:95]
    v_and_b32 v127, s81, v75
    v_fma_f32 v120, v120, v131, v129
    v_fma_f32 v121, v121, v131, v129
    v_fma_f32 v122, v122, v131, v129
    v_fma_f32 v123, v123, v131, v129
    v_fma_f32 v124, v124, v131, v129
    v_fma_f32 v125, v125, v131, v129
    v_fma_f32 v126, v126, v131, v129
    v_fma_f32 v127, v127, v131, v129
    v_cvt_pk_bf16_f32 v72, v120, v121
    v_cvt_pk_bf16_f32 v73, v122, v123
    v_cvt_pk_bf16_f32 v74, v124, v125
    v_cvt_pk_bf16_f32 v75, v126, v127
    ds_write_b128 v3, v[72:75] offset:16512
    s_waitcnt vmcnt(5)
    s_waitcnt lgkmcnt(0)
    s_barrier
    ds_read_b64_tr_b16 v[52:53], v22 offset:6144
    ds_read_b64_tr_b16 v[54:55], v22 offset:6656
    v_mfma_f32_32x32x16_bf16 v[80:95], v[112:115], a[64:67], v[80:95]
    ds_read_b128 a[80:83], v4 offset:16384
    ds_read_b128 a[84:87], v5 offset:16384
    ds_read_b128 a[88:91], v6 offset:16384
    ds_read_b128 a[92:95], v7 offset:16384
    v_lshlrev_b32 v120, 16, v48
    v_and_b32 v121, s81, v48
    v_lshlrev_b32 v122, 16, v49
    v_and_b32 v123, s81, v49
    v_lshlrev_b32 v124, 16, v50
    v_and_b32 v125, s81, v50
    v_lshlrev_b32 v126, 16, v51
    v_and_b32 v127, s81, v51
    v_add_u32 v23, 0x16000, v8
    ds_read_b64_tr_b16 v[112:113], v23
    ds_read_b64_tr_b16 v[114:115], v23 offset:512
    v_mfma_f32_32x32x16_bf16 v[80:95], v[116:119], a[68:71], v[80:95]
    v_fma_f32 v120, v120, v130, v128
    v_fma_f32 v121, v121, v130, v128
    v_fma_f32 v122, v122, v130, v128
    v_fma_f32 v123, v123, v130, v128
    v_fma_f32 v124, v124, v130, v128
    v_fma_f32 v125, v125, v130, v128
    v_fma_f32 v126, v126, v130, v128
    v_fma_f32 v127, v127, v130, v128
    v_cvt_pk_bf16_f32 v48, v120, v121
    v_cvt_pk_bf16_f32 v49, v122, v123
    v_cvt_pk_bf16_f32 v50, v124, v125
    ds_read_b64_tr_b16 v[116:117], v23 offset:2048
    ds_read_b64_tr_b16 v[118:119], v23 offset:2560
    v_mfma_f32_32x32x16_bf16 v[80:95], v[24:27], a[72:75], v[80:95]
    v_cvt_pk_bf16_f32 v51, v126, v127
    ds_write_b128 v3, v[48:51]
    v_lshlrev_b32 v120, 16, v76
    v_and_b32 v121, s81, v76
    v_lshlrev_b32 v122, 16, v77
    v_and_b32 v123, s81, v77
    v_lshlrev_b32 v124, 16, v78
    v_and_b32 v125, s81, v78
    v_lshlrev_b32 v126, 16, v79
    v_and_b32 v127, s81, v79
    v_fma_f32 v120, v120, v131, v129
    v_fma_f32 v121, v121, v131, v129
    ds_read_b64_tr_b16 v[24:25], v23 offset:4096
    ds_read_b64_tr_b16 v[26:27], v23 offset:4608
    s_waitcnt lgkmcnt(11)
    v_mfma_f32_32x32x16_bf16 v[80:95], v[52:55], a[76:79], v[80:95]
    v_fma_f32 v122, v122, v131, v129
    v_fma_f32 v123, v123, v131, v129
    v_fma_f32 v124, v124, v131, v129
    v_fma_f32 v125, v125, v131, v129
    v_fma_f32 v126, v126, v131, v129
    v_fma_f32 v127, v127, v131, v129
    v_cvt_pk_bf16_f32 v76, v120, v121
    v_cvt_pk_bf16_f32 v77, v122, v123
    v_cvt_pk_bf16_f32 v78, v124, v125
    v_cvt_pk_bf16_f32 v79, v126, v127
    ds_write_b128 v3, v[76:79] offset:128
    s_waitcnt vmcnt(2)
    s_waitcnt lgkmcnt(0)
    s_barrier
    ds_read_b64_tr_b16 v[52:53], v23 offset:6144
    ds_read_b64_tr_b16 v[54:55], v23 offset:6656
    v_mfma_f32_32x32x16_bf16 v[80:95], v[112:115], a[80:83], v[80:95]
    ds_read_b128 a[96:99], v4
    v_lshlrev_b32 v141, 6, v1
    s_cmp_lg_u32 s68, 0
    s_cbranch_scc1 L_pi_3003
    buffer_load_dword v142, v141, s[64:67], 0 offen sc1
L_pi_3003:
    ds_read_b128 a[100:103], v5
    ds_read_b128 a[104:107], v6
    v_add_u32 v22, 0x18000, v8
    ds_read_b64_tr_b16 v[112:113], v22
    ds_read_b64_tr_b16 v[114:115], v22 offset:512
    v_mfma_f32_32x32x16_bf16 v[80:95], v[116:119], a[84:87], v[80:95]
    ds_read_b128 a[108:111], v7
    v_lshrrev_b32 v20, 3, v1
    s_mul_i32 s92, s78, 0x38000
    s_add_u32 m0, s87, 0x10000
    s_add_u32 s92, s92, s88
    buffer_load_dwordx4 v10, s[36:39], s92 offen lds
    v_bfe_u32 v21, v20, 1, 1
    ds_read_b64_tr_b16 v[116:117], v22 offset:2048
    ds_read_b64_tr_b16 v[118:119], v22 offset:2560
    v_mfma_f32_32x32x16_bf16 v[80:95], v[24:27], a[88:91], v[80:95]
    v_lshlrev_b32 v21, 2, v21
    v_and_b32 v18, 7, v1
    s_mul_i32 s92, s78, 0x38000
    s_add_u32 m0, s87, 0x12000
    s_add_u32 s92, s92, s88
    buffer_load_dwordx4 v11, s[40:43], s92 offen lds
    v_xor_b32 v21, v21, v18
    s_lshl_b32 s93, s70, 3
    ds_read_b64_tr_b16 v[24:25], v22 offset:4096
    ds_read_b64_tr_b16 v[26:27], v22 offset:4608
    s_waitcnt lgkmcnt(10)
    v_mfma_f32_32x32x16_bf16 v[80:95], v[52:55], a[92:95], v[80:95]
    v_add_u32 v20, s93, v20
    v_mul_u32_u24 v20, 0x380, v20
    v_lshl_add_u32 v20, v21, 4, v20
    s_lshl_b32 s93, s98, 7
    v_add_u32 v9, s93, v20
    s_and_b32 s93, s97, 3
    s_add_u32 s93, s93, s98
    s_bitcmp1_b32 s93, 0
    s_cselect_b32 s8, 20, 0
    s_cselect_b32 s9, 0, 20
    s_cselect_b32 s24, 24, 4
    s_cselect_b32 s23, 4, 24
    s_bitcmp1_b32 s93, 1
    s_cselect_b32 s19, 16, 8
    s_cselect_b32 s22, 8, 16
    s_mov_b32 s25, 12
    s_and_b32 s94, s93, 1
    s_lshl_b32 s26, s94, 1
    s_xor_b32 s27, s26, 2
    s_waitcnt lgkmcnt(4)
    s_barrier
    ds_read_b64_tr_b16 v[52:53], v22 offset:6144
    ds_read_b64_tr_b16 v[54:55], v22 offset:6656
    v_mfma_f32_32x32x16_bf16 v[80:95], v[112:115], a[96:99], v[80:95]
    s_mul_i32 s92, s79, 0x38000
    s_add_u32 m0, s87, 0x14000
    s_add_u32 s92, s92, s88
    buffer_load_dwordx4 v10, s[36:39], s92 offen lds
    s_waitcnt lgkmcnt(4)
    v_mfma_f32_32x32x16_bf16 v[80:95], v[116:119], a[100:103], v[80:95]
    s_mul_i32 s92, s79, 0x38000
    s_add_u32 m0, s87, 0x16000
    s_add_u32 s92, s92, s88
    buffer_load_dwordx4 v11, s[40:43], s92 offen lds
    s_mul_i32 s92, s80, 0x38000
    s_add_u32 m0, s87, 0x4000
    s_add_u32 s92, s92, s88
    buffer_load_dwordx4 v10, s[36:39], s92 offen lds
    s_waitcnt lgkmcnt(2)
    v_mfma_f32_32x32x16_bf16 v[80:95], v[24:27], a[104:107], v[80:95]
    s_mul_i32 s92, s80, 0x38000
    s_add_u32 m0, s87, 0x6000
    s_add_u32 s92, s92, s88
    buffer_load_dwordx4 v11, s[40:43], s92 offen lds
    s_waitcnt lgkmcnt(0)
    v_mfma_f32_32x32x16_bf16 v[80:95], v[52:55], a[108:111], v[80:95]
    s_cmp_lg_u32 s68, 0
    s_cbranch_scc1 L_pc_3004
    s_waitcnt vmcnt(6)
    v_cmp_le_u32 vcc, 64, v142
    s_nop 0
    s_and_b32 s93, vcc_lo, 0xf
    s_cmp_eq_u32 s93, 15
    s_cbranch_scc1 L_poll_3005_done
    s_mov_b32 s100, 0x186a0
L_poll_3005:
    s_sleep 2
    buffer_load_dword v142, v141, s[64:67], 0 offen sc1
    s_waitcnt vmcnt(0)
    v_cmp_le_u32 vcc, 64, v142
    s_nop 0
    s_and_b32 s93, vcc_lo, 0xf
    s_cmp_eq_u32 s93, 15
    s_cbranch_scc1 L_poll_3005_done
    s_sub_u32 s100, s100, 1
    s_cmp_lg_u32 s100, 0
    s_cbranch_scc1 L_poll_3005
L_poll_3005_done:
L_pc_3004:
    s_barrier
    v_add_u32 v4, 0x1a000, v12
    ds_read_b64_tr_b16 v[56:57], v4
    ds_read_b64_tr_b16 v[58:59], v4 offset:512
    v_add_u32 v6, 0x1a000, v13
    ds_read_b64_tr_b16 v[60:61], v6
    ds_read_b64_tr_b16 v[62:63], v6 offset:512
    ds_read_b64_tr_b16 v[64:65], v4 offset:2048
    ds_read_b64_tr_b16 v[66:67], v4 offset:2560
    ds_read_b64_tr_b16 v[68:69], v6 offset:2048
    ds_read_b64_tr_b16 v[70:71], v6 offset:2560
    s_waitcnt lgkmcnt(6)
    v_mfma_f32_32x32x16_bf16 v[24:39], v[56:59], a[0:3], 0
    v_cvt_pk_bf16_f32 v72, v80, v81
    v_cvt_pk_bf16_f32 v73, v82, v83
    s_mul_i32 s92, s80, 0x38000
    s_mov_b32 m0, s87
    s_add_u32 s92, s92, s89
    buffer_load_dwordx4 v10, s[36:39], s92 offen lds
    ds_read_b64_tr_b16 v[56:57], v4 offset:4096
    ds_read_b64_tr_b16 v[58:59], v4 offset:4608
    s_waitcnt lgkmcnt(6)
    v_mfma_f32_32x32x16_bf16 v[40:55], v[60:63], a[0:3], 0
    v_cvt_pk_bf16_f32 v74, v84, v85
    v_cvt_pk_bf16_f32 v75, v86, v87
    v_cvt_pk_bf16_f32 v76, v88, v89
    v_cvt_pk_bf16_f32 v77, v90, v91
    v_cvt_pk_bf16_f32 v78, v92, v93
    ds_read_b64_tr_b16 v[60:61], v6 offset:4096
    ds_read_b64_tr_b16 v[62:63], v6 offset:4608
    s_waitcnt lgkmcnt(6)
    v_mfma_f32_32x32x16_bf16 v[24:39], v[64:67], a[4:7], v[24:39]
    v_cvt_pk_bf16_f32 v79, v94, v95
    v_mfma_f32_32x32x16_bf16 v[112:127], v[132:135], v[72:75], 0
    s_nop 0
    v_mfma_f32_32x32x16_bf16 v[112:127], v[136:139], v[76:79], v[112:127]
    ds_read_b64_tr_b16 v[64:65], v4 offset:6144
    ds_read_b64_tr_b16 v[66:67], v4 offset:6656
    s_waitcnt lgkmcnt(6)
    v_mfma_f32_32x32x16_bf16 v[40:55], v[68:71], a[4:7], v[40:55]
    ds_read_b64_tr_b16 v[68:69], v6 offset:6144
    ds_read_b64_tr_b16 v[70:71], v6 offset:6656
    s_waitcnt lgkmcnt(6)
    v_mfma_f32_32x32x16_bf16 v[24:39], v[56:59], a[8:11], v[24:39]
    v_add_u32 v5, 0x1e000, v12
    ds_read_b64_tr_b16 v[56:57], v5
    ds_read_b64_tr_b16 v[58:59], v5 offset:512
    s_waitcnt lgkmcnt(6)
    v_mfma_f32_32x32x16_bf16 v[40:55], v[60:63], a[8:11], v[40:55]
    s_mul_i32 s92, s80, 0x38000
    s_add_u32 m0, s87, 0x2000
    s_add_u32 s92, s92, s89
    buffer_load_dwordx4 v11, s[40:43], s92 offen lds
    v_max3_f32 v128, v112, v113, v114
    v_add_u32 v7, 0x1e000, v13
    ds_read_b64_tr_b16 v[60:61], v7
    ds_read_b64_tr_b16 v[62:63], v7 offset:512
    s_waitcnt lgkmcnt(6)
    v_mfma_f32_32x32x16_bf16 v[24:39], v[64:67], a[12:15], v[24:39]
    v_min3_f32 v129, v112, v113, v114
    v_max3_f32 v128, v128, v115, v116
    v_min3_f32 v129, v129, v115, v116
    v_max3_f32 v128, v128, v117, v118
    v_min3_f32 v129, v129, v117, v118
    ds_read_b64_tr_b16 v[64:65], v5 offset:2048
    ds_read_b64_tr_b16 v[66:67], v5 offset:2560
    s_waitcnt lgkmcnt(6)
    v_mfma_f32_32x32x16_bf16 v[40:55], v[68:71], a[12:15], v[40:55]
    v_max3_f32 v128, v128, v119, v120
    v_min3_f32 v129, v129, v119, v120
    v_max3_f32 v128, v128, v121, v122
    v_min3_f32 v129, v129, v121, v122
    v_max3_f32 v128, v128, v123, v124
    s_barrier
    ds_read_b64_tr_b16 v[68:69], v7 offset:2048
    ds_read_b64_tr_b16 v[70:71], v7 offset:2560
    s_waitcnt lgkmcnt(6)
    v_mfma_f32_32x32x16_bf16 v[24:39], v[56:59], a[16:19], v[24:39]
    v_min3_f32 v129, v129, v123, v124
    v_max3_f32 v128, v128, v125, v126
    s_mul_i32 s92, s74, 0x38000
    s_add_u32 m0, s87, 0x1a000
    s_add_u32 s92, s92, s89
    buffer_load_dwordx4 v10, s[36:39], s92 offen lds
    ds_read_b64_tr_b16 v[56:57], v5 offset:4096
    ds_read_b64_tr_b16 v[58:59], v5 offset:4608
    s_waitcnt lgkmcnt(6)
    v_mfma_f32_32x32x16_bf16 v[40:55], v[60:63], a[16:19], v[40:55]
    v_min3_f32 v129, v129, v125, v126
    v_max_f32 v128, v128, v127
    v_min_f32 v129, v129, v127
    v_mov_b32 v130, v128
    ds_read_b64_tr_b16 v[60:61], v7 offset:4096
    ds_read_b64_tr_b16 v[62:63], v7 offset:4608
    s_waitcnt lgkmcnt(6)
    v_mfma_f32_32x32x16_bf16 v[24:39], v[64:67], a[20:23], v[24:39]
    v_mov_b32 v131, v129
    s_nop 0
    v_permlane32_swap_b32 v128, v130
    v_permlane32_swap_b32 v129, v131
    v_max_f32 v128, v128, v130
    v_min_f32 v129, v129, v131
    ds_read_b64_tr_b16 v[64:65], v5 offset:6144
    ds_read_b64_tr_b16 v[66:67], v5 offset:6656
    s_waitcnt lgkmcnt(6)
    v_mfma_f32_32x32x16_bf16 v[40:55], v[68:71], a[20:23], v[40:55]
    v_sub_f32 v80, v129, v112
    v_sub_f32 v112, v112, v128
    v_sub_f32 v81, v129, v113
    v_sub_f32 v113, v113, v128
    v_sub_f32 v82, v129, v114
    ds_read_b64_tr_b16 v[68:69], v7 offset:6144
    ds_read_b64_tr_b16 v[70:71], v7 offset:6656
    s_waitcnt lgkmcnt(6)
    v_mfma_f32_32x32x16_bf16 v[24:39], v[56:59], a[24:27], v[24:39]
    s_mul_i32 s92, s74, 0x38000
    s_add_u32 m0, s87, 0x1c000
    s_add_u32 s92, s92, s89
    buffer_load_dwordx4 v11, s[40:43], s92 offen lds
    v_sub_f32 v114, v114, v128
    v_sub_f32 v83, v129, v115
    v_add_u32 v4, 0x22000, v12
    ds_read_b64_tr_b16 v[56:57], v4
    ds_read_b64_tr_b16 v[58:59], v4 offset:512
    s_waitcnt lgkmcnt(6)
    v_mfma_f32_32x32x16_bf16 v[40:55], v[60:63], a[24:27], v[40:55]
    v_sub_f32 v115, v115, v128
    v_exp_f32 v80, v80
    v_exp_f32 v112, v112
    v_add_u32 v6, 0x22000, v13
    ds_read_b64_tr_b16 v[60:61], v6
    ds_read_b64_tr_b16 v[62:63], v6 offset:512
    s_waitcnt lgkmcnt(6)
    v_mfma_f32_32x32x16_bf16 v[24:39], v[64:67], a[28:31], v[24:39]
    v_exp_f32 v81, v81
    v_exp_f32 v113, v113
    ds_read_b64_tr_b16 v[64:65], v4 offset:2048
    ds_read_b64_tr_b16 v[66:67], v4 offset:2560
    s_waitcnt lgkmcnt(6)
    v_mfma_f32_32x32x16_bf16 v[40:55], v[68:71], a[28:31], v[40:55]
    v_exp_f32 v82, v82
    v_exp_f32 v114, v114
    v_exp_f32 v83, v83
    s_waitcnt vmcnt(10)
    s_barrier
    ds_read_b64_tr_b16 v[68:69], v6 offset:2048
    ds_read_b64_tr_b16 v[70:71], v6 offset:2560
    s_waitcnt lgkmcnt(6)
    v_mfma_f32_32x32x16_bf16 v[24:39], v[56:59], a[32:35], v[24:39]
    v_exp_f32 v115, v115
    s_mul_i32 s92, s75, 0x38000
    s_add_u32 m0, s87, 0x1e000
    s_add_u32 s92, s92, s89
    buffer_load_dwordx4 v10, s[36:39], s92 offen lds
    ds_read_b64_tr_b16 v[56:57], v4 offset:4096
    ds_read_b64_tr_b16 v[58:59], v4 offset:4608
    s_waitcnt lgkmcnt(6)
    v_mfma_f32_32x32x16_bf16 v[40:55], v[60:63], a[32:35], v[40:55]
    v_sub_f32 v84, v129, v116
    v_sub_f32 v116, v116, v128
    v_sub_f32 v85, v129, v117
    v_sub_f32 v117, v117, v128
    v_sub_f32 v86, v129, v118
    v_sub_f32 v118, v118, v128
    ds_read_b64_tr_b16 v[60:61], v6 offset:4096
    ds_read_b64_tr_b16 v[62:63], v6 offset:4608
    s_waitcnt lgkmcnt(6)
    v_mfma_f32_32x32x16_bf16 v[24:39], v[64:67], a[36:39], v[24:39]
    v_sub_f32 v87, v129, v119
    s_mul_i32 s92, s75, 0x38000
    s_add_u32 m0, s87, 0x20000
    s_add_u32 s92, s92, s89
    buffer_load_dwordx4 v11, s[40:43], s92 offen lds
    ds_read_b64_tr_b16 v[64:65], v4 offset:6144
    ds_read_b64_tr_b16 v[66:67], v4 offset:6656
    s_waitcnt lgkmcnt(6)
    v_mfma_f32_32x32x16_bf16 v[40:55], v[68:71], a[36:39], v[40:55]
    v_sub_f32 v119, v119, v128
    v_exp_f32 v84, v84
    v_exp_f32 v116, v116
    v_exp_f32 v85, v85
    ds_read_b64_tr_b16 v[68:69], v6 offset:6144
    ds_read_b64_tr_b16 v[70:71], v6 offset:6656
    s_waitcnt lgkmcnt(6)
    v_mfma_f32_32x32x16_bf16 v[24:39], v[56:59], a[40:43], v[24:39]
    s_mul_i32 s92, s8, 0x3800
    s_add_u32 m0, s99, 0x8000
    s_add_u32 s92, s92, s85
    buffer_load_dwordx4 v9, s[44:47], s92 offen lds
    v_exp_f32 v117, v117
    v_add_u32 v5, 0xc000, v12
    ds_read_b64_tr_b16 v[56:57], v5
    ds_read_b64_tr_b16 v[58:59], v5 offset:512
    s_waitcnt lgkmcnt(6)
    v_mfma_f32_32x32x16_bf16 v[40:55], v[60:63], a[40:43], v[40:55]
    v_exp_f32 v86, v86
    v_exp_f32 v118, v118
    v_add_u32 v7, 0xc000, v13
    ds_read_b64_tr_b16 v[60:61], v7
    ds_read_b64_tr_b16 v[62:63], v7 offset:512
    s_waitcnt lgkmcnt(6)
    v_mfma_f32_32x32x16_bf16 v[24:39], v[64:67], a[44:47], v[24:39]
    v_exp_f32 v87, v87
    v_exp_f32 v119, v119
    v_sub_f32 v88, v129, v120
    v_sub_f32 v120, v120, v128
    ds_read_b64_tr_b16 v[64:65], v5 offset:2048
    ds_read_b64_tr_b16 v[66:67], v5 offset:2560
    s_waitcnt lgkmcnt(6)
    v_mfma_f32_32x32x16_bf16 v[40:55], v[68:71], a[44:47], v[40:55]
    v_sub_f32 v89, v129, v121
    v_sub_f32 v121, v121, v128
    v_sub_f32 v90, v129, v122
    v_sub_f32 v122, v122, v128
    v_sub_f32 v91, v129, v123
    v_sub_f32 v123, v123, v128
    s_waitcnt vmcnt(11)
    s_barrier
    ds_read_b64_tr_b16 v[68:69], v7 offset:2048
    ds_read_b64_tr_b16 v[70:71], v7 offset:2560
    s_waitcnt lgkmcnt(6)
    v_mfma_f32_32x32x16_bf16 v[24:39], v[56:59], a[48:51], v[24:39]
    v_exp_f32 v88, v88
    s_mul_i32 s92, s76, 0x38000
    s_add_u32 m0, s87, 0x22000
    s_add_u32 s92, s92, s89
    buffer_load_dwordx4 v10, s[36:39], s92 offen lds
    ds_read_b64_tr_b16 v[56:57], v5 offset:4096
    ds_read_b64_tr_b16 v[58:59], v5 offset:4608
    s_waitcnt lgkmcnt(6)
    v_mfma_f32_32x32x16_bf16 v[40:55], v[60:63], a[48:51], v[40:55]
    v_exp_f32 v120, v120
    v_exp_f32 v89, v89
    v_exp_f32 v121, v121
    ds_read_b64_tr_b16 v[60:61], v7 offset:4096
    ds_read_b64_tr_b16 v[62:63], v7 offset:4608
    s_waitcnt lgkmcnt(6)
    v_mfma_f32_32x32x16_bf16 v[24:39], v[64:67], a[52:55], v[24:39]
    v_exp_f32 v90, v90
    s_mul_i32 s92, s76, 0x38000
    s_add_u32 m0, s87, 0x24000
    s_add_u32 s92, s92, s89
    buffer_load_dwordx4 v11, s[40:43], s92 offen lds
    ds_read_b64_tr_b16 v[64:65], v5 offset:6144
    ds_read_b64_tr_b16 v[66:67], v5 offset:6656
    s_waitcnt lgkmcnt(6)
    v_mfma_f32_32x32x16_bf16 v[40:55], v[68:71], a[52:55], v[40:55]
    v_exp_f32 v122, v122
    v_exp_f32 v91, v91
    v_exp_f32 v123, v123
    ds_read_b64_tr_b16 v[68:69], v7 offset:6144
    ds_read_b64_tr_b16 v[70:71], v7 offset:6656
    s_waitcnt lgkmcnt(6)
    v_mfma_f32_32x32x16_bf16 v[24:39], v[56:59], a[56:59], v[24:39]
    s_mul_i32 s92, s8, 0x3800
    s_add_u32 s92, s92, s85
    s_add_u32 m0, s99, 0xa000
    s_add_u32 s92, s92, 0x3800
    buffer_load_dwordx4 v9, s[44:47], s92 offen lds
    v_sub_f32 v92, v129, v124
    v_add_u32 v4, 0x10000, v12
    ds_read_b64_tr_b16 v[56:57], v4
    ds_read_b64_tr_b16 v[58:59], v4 offset:512
    s_waitcnt lgkmcnt(6)
    v_mfma_f32_32x32x16_bf16 v[40:55], v[60:63], a[56:59], v[40:55]
    v_sub_f32 v124, v124, v128
    v_sub_f32 v93, v129, v125
    v_sub_f32 v125, v125, v128
    v_sub_f32 v94, v129, v126
    v_sub_f32 v126, v126, v128
    v_sub_f32 v95, v129, v127
    v_add_u32 v6, 0x10000, v13
    ds_read_b64_tr_b16 v[60:61], v6
    ds_read_b64_tr_b16 v[62:63], v6 offset:512
    s_waitcnt lgkmcnt(6)
    v_mfma_f32_32x32x16_bf16 v[24:39], v[64:67], a[60:63], v[24:39]
    v_sub_f32 v127, v127, v128
    v_exp_f32 v92, v92
    v_exp_f32 v124, v124
    ds_read_b64_tr_b16 v[64:65], v4 offset:2048
    ds_read_b64_tr_b16 v[66:67], v4 offset:2560
    s_waitcnt lgkmcnt(6)
    v_mfma_f32_32x32x16_bf16 v[40:55], v[68:71], a[60:63], v[40:55]
    v_exp_f32 v93, v93
    v_exp_f32 v125, v125
    v_exp_f32 v94, v94
    s_waitcnt vmcnt(12)
    s_barrier
    ds_read_b64_tr_b16 v[68:69], v6 offset:2048
    ds_read_b64_tr_b16 v[70:71], v6 offset:2560
    s_waitcnt lgkmcnt(6)
    v_mfma_f32_32x32x16_bf16 v[24:39], v[56:59], a[64:67], v[24:39]
    v_exp_f32 v126, v126
    s_mul_i32 s92, s77, 0x38000
    s_add_u32 m0, s87, 0xc000
    s_add_u32 s92, s92, s89
    buffer_load_dwordx4 v10, s[36:39], s92 offen lds
    ds_read_b64_tr_b16 v[56:57], v4 offset:4096
    ds_read_b64_tr_b16 v[58:59], v4 offset:4608
    s_waitcnt lgkmcnt(6)
    v_mfma_f32_32x32x16_bf16 v[40:55], v[60:63], a[64:67], v[40:55]
    v_exp_f32 v95, v95
    v_exp_f32 v127, v127
    v_add_f32 v140, v92, v93
    v_add_f32 v141, v124, v125
    v_add_f32 v130, v94, v95
    ds_read_b64_tr_b16 v[60:61], v6 offset:4096
    ds_read_b64_tr_b16 v[62:63], v6 offset:4608
    s_waitcnt lgkmcnt(6)
    v_mfma_f32_32x32x16_bf16 v[24:39], v[64:67], a[68:71], v[24:39]
    s_mul_i32 s92, s77, 0x38000
    s_add_u32 m0, s87, 0xe000
    s_add_u32 s92, s92, s89
    buffer_load_dwordx4 v11, s[40:43], s92 offen lds
    v_add_f32 v131, v126, v127
    v_add_f32 v140, v140, v130
    v_add_f32 v141, v141, v131
    v_add_f32 v130, v81, v82
    ds_read_b64_tr_b16 v[64:65], v4 offset:6144
    ds_read_b64_tr_b16 v[66:67], v4 offset:6656
    s_waitcnt lgkmcnt(6)
    v_mfma_f32_32x32x16_bf16 v[40:55], v[68:71], a[68:71], v[40:55]
    v_add_f32 v131, v113, v114
    v_fma_f32 v140, v140, v17, v80
    v_fma_f32 v141, v141, v17, v112
    ds_read_b64_tr_b16 v[68:69], v6 offset:6144
    ds_read_b64_tr_b16 v[70:71], v6 offset:6656
    s_waitcnt lgkmcnt(6)
    v_mfma_f32_32x32x16_bf16 v[24:39], v[56:59], a[72:75], v[24:39]
    s_and_b32 s93, s97, 3
    s_add_u32 s94, s93, 12
    s_mul_i32 s94, s94, 0x3800
    s_mul_i32 s93, s93, 0x6200
    s_cmp_ge_u32 s69, 2
    s_cselect_b32 s95, 0x3800, 0
    s_add_u32 s93, s93, s95
    s_mov_b32 s95, 0x70
    s_cmp_eq_u32 s69, 0
    s_cselect_b32 s93, s94, s93
    s_cselect_b32 s95, 0x1c0, s95
    s_cselect_b32 s4, s44, s48
    s_cselect_b32 s5, s45, s49
    s_cselect_b32 s6, s46, s50
    s_mov_b32 s7, 0x20000
    s_lshl_b32 s94, s98, 7
    s_add_u32 s93, s93, s94
    v_lshrrev_b32 v20, 4, v1
    v_mul_u32_u24 v20, s95, v20
    v_and_b32 v21, 15, v1
    v_add_u32 v20, v20, v21
    v_mul_u32_u24 v20, 0x380, v20
    buffer_load_dword v18, v20, s[4:7], s93 offen
    v_add_u32 v5, 0x14000, v12
    ds_read_b64_tr_b16 v[56:57], v5
    ds_read_b64_tr_b16 v[58:59], v5 offset:512
    s_waitcnt lgkmcnt(6)
    v_mfma_f32_32x32x16_bf16 v[40:55], v[60:63], a[72:75], v[40:55]
    v_add_f32 v130, v130, v84
    v_add_f32 v131, v131, v116
    v_add_f32 v140, v140, v83
    v_add_f32 v141, v141, v115
    v_add_f32 v130, v130, v86
    v_add_u32 v7, 0x14000, v13
    ds_read_b64_tr_b16 v[60:61], v7
    ds_read_b64_tr_b16 v[62:63], v7 offset:512
    s_waitcnt lgkmcnt(6)
    v_mfma_f32_32x32x16_bf16 v[24:39], v[64:67], a[76:79], v[24:39]
    v_add_f32 v131, v131, v118
    v_add_f32 v140, v140, v85
    v_add_f32 v141, v141, v117
    v_add_f32 v130, v130, v88
    v_add_f32 v131, v131, v120
    v_add_f32 v140, v140, v87
    ds_read_b64_tr_b16 v[64:65], v5 offset:2048
    ds_read_b64_tr_b16 v[66:67], v5 offset:2560
    s_waitcnt lgkmcnt(6)
    v_mfma_f32_32x32x16_bf16 v[40:55], v[68:71], a[76:79], v[40:55]
    v_add_f32 v141, v141, v119
    v_add_f32 v130, v130, v90
    v_add_f32 v131, v131, v122
    v_add_f32 v140, v140, v89
    v_add_f32 v141, v141, v121
    v_add_f32 v140, v140, v91
    v_add_f32 v141, v141, v123
    s_waitcnt vmcnt(13)
    s_barrier
    ds_read_b64_tr_b16 v[68:69], v7 offset:2048
    ds_read_b64_tr_b16 v[70:71], v7 offset:2560
    s_waitcnt lgkmcnt(6)
    v_mfma_f32_32x32x16_bf16 v[24:39], v[56:59], a[80:83], v[24:39]
    v_add_f32 v140, v140, v130
    v_add_f32 v141, v141, v131
    s_mul_i32 s92, s78, 0x38000
    s_add_u32 m0, s87, 0x10000
    s_add_u32 s92, s92, s89
    buffer_load_dwordx4 v10, s[36:39], s92 offen lds
    ds_read_b64_tr_b16 v[56:57], v5 offset:4096
    ds_read_b64_tr_b16 v[58:59], v5 offset:4608
    s_waitcnt lgkmcnt(6)
    v_mfma_f32_32x32x16_bf16 v[40:55], v[60:63], a[80:83], v[40:55]
    v_mov_b32 v130, v140
    v_mov_b32 v131, v141
    s_nop 0
    v_permlane32_swap_b32 v140, v130
    v_permlane32_swap_b32 v141, v131
    v_add_f32 v140, v140, v130
    ds_read_b64_tr_b16 v[60:61], v7 offset:4096
    ds_read_b64_tr_b16 v[62:63], v7 offset:4608
    s_waitcnt lgkmcnt(6)
    v_mfma_f32_32x32x16_bf16 v[24:39], v[64:67], a[84:87], v[24:39]
    v_add_f32 v141, v141, v131
    v_rcp_f32 v140, v140
    v_rcp_f32 v141, v141
    ds_read_b64_tr_b16 v[64:65], v5 offset:6144
    ds_read_b64_tr_b16 v[66:67], v5 offset:6656
    s_waitcnt lgkmcnt(6)
    v_mfma_f32_32x32x16_bf16 v[40:55], v[68:71], a[84:87], v[40:55]
    s_nop 0
    v_mul_f32 v142, v140, v17
    v_mul_f32 v143, v141, v17
    v_mul_f32 v80, v80, v140
    v_mul_f32 v112, v112, v141
    ds_read_b64_tr_b16 v[68:69], v7 offset:6144
    ds_read_b64_tr_b16 v[70:71], v7 offset:6656
    s_waitcnt lgkmcnt(6)
    v_mfma_f32_32x32x16_bf16 v[24:39], v[56:59], a[88:91], v[24:39]
    s_mul_i32 s92, s78, 0x38000
    s_add_u32 m0, s87, 0x12000
    s_add_u32 s92, s92, s89
    buffer_load_dwordx4 v11, s[40:43], s92 offen lds
    v_mul_f32 v81, v81, v140
    v_mul_f32 v113, v113, v141
    v_add_u32 v4, 0x4000, v12
    ds_read_b64_tr_b16 v[56:57], v4
    ds_read_b64_tr_b16 v[58:59], v4 offset:512
    s_waitcnt lgkmcnt(6)
    v_mfma_f32_32x32x16_bf16 v[40:55], v[60:63], a[88:91], v[40:55]
    v_mul_f32 v82, v82, v140
    v_mul_f32 v114, v114, v141
    v_mul_f32 v83, v83, v140
    v_mul_f32 v115, v115, v141
    v_mul_f32 v84, v84, v140
    v_mul_f32 v116, v116, v141
    v_add_u32 v6, 0x4000, v13
    ds_read_b64_tr_b16 v[60:61], v6
    ds_read_b64_tr_b16 v[62:63], v6 offset:512
    s_waitcnt lgkmcnt(6)
    v_mfma_f32_32x32x16_bf16 v[24:39], v[64:67], a[92:95], v[24:39]
    v_mul_f32 v85, v85, v140
    v_mul_f32 v117, v117, v141
    v_mul_f32 v86, v86, v140
    v_mul_f32 v118, v118, v141
    v_mul_f32 v87, v87, v140
    ds_read_b64_tr_b16 v[64:65], v4 offset:2048
    ds_read_b64_tr_b16 v[66:67], v4 offset:2560
    s_waitcnt lgkmcnt(6)
    v_mfma_f32_32x32x16_bf16 v[40:55], v[68:71], a[92:95], v[40:55]
    v_mul_f32 v119, v119, v141
    v_mul_f32 v88, v88, v140
    v_mul_f32 v120, v120, v141
    v_mul_f32 v89, v89, v140
    v_mul_f32 v121, v121, v141
    s_barrier
    ds_read_b64_tr_b16 v[68:69], v6 offset:2048
    ds_read_b64_tr_b16 v[70:71], v6 offset:2560
    s_waitcnt lgkmcnt(6)
    v_mfma_f32_32x32x16_bf16 v[24:39], v[56:59], a[96:99], v[24:39]
    v_mul_f32 v90, v90, v140
    v_mul_f32 v122, v122, v141
    s_mul_i32 s92, s79, 0x38000
    s_add_u32 m0, s87, 0x14000
    s_add_u32 s92, s92, s89
    buffer_load_dwordx4 v10, s[36:39], s92 offen lds
    ds_read_b64_tr_b16 v[56:57], v4 offset:4096
    ds_read_b64_tr_b16 v[58:59], v4 offset:4608
    s_waitcnt lgkmcnt(6)
    v_mfma_f32_32x32x16_bf16 v[40:55], v[60:63], a[96:99], v[40:55]
    v_mul_f32 v91, v91, v140
    v_mul_f32 v123, v123, v141
    v_mul_f32 v92, v92, v142
    ds_read_b64_tr_b16 v[60:61], v6 offset:4096
    ds_read_b64_tr_b16 v[62:63], v6 offset:4608
    s_waitcnt lgkmcnt(6)
    v_mfma_f32_32x32x16_bf16 v[24:39], v[64:67], a[100:103], v[24:39]
    v_mul_f32 v124, v124, v143
    v_mul_f32 v93, v93, v142
    v_mul_f32 v125, v125, v143
    v_mul_f32 v94, v94, v142
    v_mul_f32 v126, v126, v143
    ds_read_b64_tr_b16 v[64:65], v4 offset:6144
    ds_read_b64_tr_b16 v[66:67], v4 offset:6656
    s_waitcnt lgkmcnt(6)
    v_mfma_f32_32x32x16_bf16 v[40:55], v[68:71], a[100:103], v[40:55]
    v_mul_f32 v95, v95, v142
    v_mul_f32 v127, v127, v143
    v_cvt_pk_bf16_f32 v96, v80, v81
    ds_read_b64_tr_b16 v[68:69], v6 offset:6144
    ds_read_b64_tr_b16 v[70:71], v6 offset:6656
    s_waitcnt lgkmcnt(6)
    v_mfma_f32_32x32x16_bf16 v[24:39], v[56:59], a[104:107], v[24:39]
    s_mul_i32 s92, s79, 0x38000
    s_add_u32 m0, s87, 0x16000
    s_add_u32 s92, s92, s89
    buffer_load_dwordx4 v11, s[40:43], s92 offen lds
    v_cvt_pk_bf16_f32 v97, v82, v83
    v_cvt_pk_bf16_f32 v98, v84, v85
    s_waitcnt lgkmcnt(4)
    v_mfma_f32_32x32x16_bf16 v[40:55], v[60:63], a[104:107], v[40:55]
    v_cvt_pk_bf16_f32 v99, v86, v87
    v_cvt_pk_bf16_f32 v100, v88, v89
    v_cvt_pk_bf16_f32 v101, v90, v91
    v_cvt_pk_bf16_f32 v102, v92, v93
    s_waitcnt lgkmcnt(2)
    v_mfma_f32_32x32x16_bf16 v[24:39], v[64:67], a[108:111], v[24:39]
    v_cvt_pk_bf16_f32 v103, v94, v95
    v_cvt_pk_bf16_f32 v104, v112, v113
    v_cvt_pk_bf16_f32 v105, v114, v115
    v_cvt_pk_bf16_f32 v106, v116, v117
    v_cvt_pk_bf16_f32 v107, v118, v119
    s_waitcnt lgkmcnt(0)
    v_mfma_f32_32x32x16_bf16 v[40:55], v[68:71], a[108:111], v[40:55]
    v_cvt_pk_bf16_f32 v108, v120, v121
    v_cvt_pk_bf16_f32 v109, v122, v123
    v_cvt_pk_bf16_f32 v110, v124, v125
    v_cvt_pk_bf16_f32 v111, v126, v127
    s_waitcnt vmcnt(11)
    s_barrier
    v_add_u32 v4, 0x1a000, v12
    ds_read_b64_tr_b16 v[56:57], v4
    ds_read_b64_tr_b16 v[58:59], v4 offset:512
    v_add_u32 v6, 0x1a000, v13
    ds_read_b64_tr_b16 v[60:61], v6
    ds_read_b64_tr_b16 v[62:63], v6 offset:512
    ds_read_b64_tr_b16 v[64:65], v4 offset:2048
    ds_read_b64_tr_b16 v[66:67], v4 offset:2560
    ds_read_b64_tr_b16 v[68:69], v6 offset:2048
    ds_read_b64_tr_b16 v[70:71], v6 offset:2560
    s_waitcnt lgkmcnt(6)
    v_mfma_f32_32x32x16_bf16 v[80:95], v[56:59], a[0:3], 0
    s_mul_i32 s92, s8, 0x3800
    s_add_u32 s92, s92, s85
    s_add_u32 m0, s99, 0x4000
    s_add_u32 s92, s92, 0x7000
    buffer_load_dwordx4 v9, s[44:47], s92 offen lds
    ds_read_b64_tr_b16 v[56:57], v4 offset:4096
    ds_read_b64_tr_b16 v[58:59], v4 offset:4608
    s_waitcnt lgkmcnt(6)
    v_mfma_f32_32x32x16_bf16 v[112:127], v[60:63], a[0:3], 0
    v_exp_f32 v72, v24
    v_exp_f32 v73, v25
    ds_read_b64_tr_b16 v[60:61], v6 offset:4096
    ds_read_b64_tr_b16 v[62:63], v6 offset:4608
    s_waitcnt lgkmcnt(6)
    v_mfma_f32_32x32x16_bf16 v[80:95], v[64:67], a[4:7], v[80:95]
    v_exp_f32 v74, v26
    v_exp_f32 v75, v27
    v_exp_f32 v76, v28
    ds_read_b64_tr_b16 v[64:65], v4 offset:6144
    ds_read_b64_tr_b16 v[66:67], v4 offset:6656
    s_waitcnt lgkmcnt(6)
    v_mfma_f32_32x32x16_bf16 v[112:127], v[68:71], a[4:7], v[112:127]
    v_exp_f32 v77, v29
    v_exp_f32 v78, v30
    ds_read_b64_tr_b16 v[68:69], v6 offset:6144
    ds_read_b64_tr_b16 v[70:71], v6 offset:6656
    s_waitcnt lgkmcnt(6)
    v_mfma_f32_32x32x16_bf16 v[80:95], v[56:59], a[8:11], v[80:95]
    s_mul_i32 s92, s8, 0x3800
    s_add_u32 s92, s92, s85
    s_add_u32 m0, s99, 0x6000
    s_add_u32 s92, s92, 0xa800
    buffer_load_dwordx4 v9, s[44:47], s92 offen lds
    v_exp_f32 v79, v31
    v_add_u32 v5, 0x1e000, v12
    ds_read_b64_tr_b16 v[56:57], v5
    ds_read_b64_tr_b16 v[58:59], v5 offset:512
    s_waitcnt lgkmcnt(6)
    v_mfma_f32_32x32x16_bf16 v[112:127], v[60:63], a[8:11], v[112:127]
    v_mul_f32 v24, v24, v32
    v_mul_f32 v25, v25, v33
    v_mul_f32 v26, v26, v34
    v_mul_f32 v27, v27, v35
    v_mul_f32 v28, v28, v36
    v_mul_f32 v29, v29, v37
    v_add_u32 v7, 0x1e000, v13
    ds_read_b64_tr_b16 v[60:61], v7
    ds_read_b64_tr_b16 v[62:63], v7 offset:512
    s_waitcnt lgkmcnt(6)
    v_mfma_f32_32x32x16_bf16 v[80:95], v[64:67], a[12:15], v[80:95]
    v_mul_f32 v30, v30, v38
    v_mul_f32 v31, v31, v39
    v_add_f32 v72, 1.0, v72
    v_add_f32 v73, 1.0, v73
    v_add_f32 v74, 1.0, v74
    ds_read_b64_tr_b16 v[64:65], v5 offset:2048
    ds_read_b64_tr_b16 v[66:67], v5 offset:2560
    s_waitcnt lgkmcnt(6)
    v_mfma_f32_32x32x16_bf16 v[112:127], v[68:71], a[12:15], v[112:127]
    v_add_f32 v75, 1.0, v75
    v_add_f32 v76, 1.0, v76
    v_add_f32 v77, 1.0, v77
    v_add_f32 v78, 1.0, v78
    v_add_f32 v79, 1.0, v79
    s_waitcnt vmcnt(10)
    s_barrier
    ds_read_b64_tr_b16 v[68:69], v7 offset:2048
    ds_read_b64_tr_b16 v[70:71], v7 offset:2560
    s_waitcnt lgkmcnt(6)
    v_mfma_f32_32x32x16_bf16 v[80:95], v[56:59], a[16:19], v[80:95]
    v_rcp_f32 v72, v72
    s_mul_i32 s92, s9, 0x3800
    s_add_u32 m0, s99, 0x1a000
    s_add_u32 s92, s92, s85
    buffer_load_dwordx4 v9, s[44:47], s92 offen lds
    ds_read_b64_tr_b16 v[56:57], v5 offset:4096
    ds_read_b64_tr_b16 v[58:59], v5 offset:4608
    s_waitcnt lgkmcnt(6)
    v_mfma_f32_32x32x16_bf16 v[112:127], v[60:63], a[16:19], v[112:127]
    v_rcp_f32 v73, v73
    v_rcp_f32 v74, v74
    ds_read_b64_tr_b16 v[60:61], v7 offset:4096
    ds_read_b64_tr_b16 v[62:63], v7 offset:4608
    s_waitcnt lgkmcnt(6)
    v_mfma_f32_32x32x16_bf16 v[80:95], v[64:67], a[20:23], v[80:95]
    v_rcp_f32 v75, v75
    v_rcp_f32 v76, v76
    v_rcp_f32 v77, v77
    ds_read_b64_tr_b16 v[64:65], v5 offset:6144
    ds_read_b64_tr_b16 v[66:67], v5 offset:6656
    s_waitcnt lgkmcnt(6)
    v_mfma_f32_32x32x16_bf16 v[112:127], v[68:71], a[20:23], v[112:127]
    v_rcp_f32 v78, v78
    v_rcp_f32 v79, v79
    ds_read_b64_tr_b16 v[68:69], v7 offset:6144
    ds_read_b64_tr_b16 v[70:71], v7 offset:6656
    s_waitcnt lgkmcnt(6)
    v_mfma_f32_32x32x16_bf16 v[80:95], v[56:59], a[24:27], v[80:95]
    s_mul_i32 s92, s9, 0x3800
    s_add_u32 s92, s92, s85
    s_add_u32 m0, s99, 0x1c000
    s_add_u32 s92, s92, 0x3800
    buffer_load_dwordx4 v9, s[44:47], s92 offen lds
    v_mul_f32 v24, v24, v72
    v_mul_f32 v25, v25, v73
    v_add_u32 v4, 0x22000, v12
    ds_read_b64_tr_b16 v[56:57], v4
    ds_read_b64_tr_b16 v[58:59], v4 offset:512
    s_waitcnt lgkmcnt(6)
    v_mfma_f32_32x32x16_bf16 v[112:127], v[60:63], a[24:27], v[112:127]
    v_mul_f32 v26, v26, v74
    v_mul_f32 v27, v27, v75
    v_mul_f32 v28, v28, v76
    v_mul_f32 v29, v29, v77
    v_mul_f32 v30, v30, v78
    v_mul_f32 v31, v31, v79
    v_add_u32 v6, 0x22000, v13
    ds_read_b64_tr_b16 v[60:61], v6
    ds_read_b64_tr_b16 v[62:63], v6 offset:512
    s_waitcnt lgkmcnt(6)
    v_mfma_f32_32x32x16_bf16 v[80:95], v[64:67], a[28:31], v[80:95]
    v_cvt_pk_bf16_f32 v132, v24, v25
    v_cvt_pk_bf16_f32 v133, v26, v27
    v_cvt_pk_bf16_f32 v134, v28, v29
    v_cvt_pk_bf16_f32 v135, v30, v31
    ds_read_b64_tr_b16 v[64:65], v4 offset:2048
    ds_read_b64_tr_b16 v[66:67], v4 offset:2560
    s_waitcnt lgkmcnt(6)
    v_mfma_f32_32x32x16_bf16 v[112:127], v[68:71], a[28:31], v[112:127]
    s_lshl_b32 s93, s88, 5
    s_add_u32 s93, s93, s90
    s_mul_i32 s94, s70, 0x800
    s_add_u32 s93, s93, s94
    buffer_store_dwordx4 v[132:135], v2, s[60:63], s93 offen sc1
    v_exp_f32 v72, v40
    s_waitcnt vmcnt(10)
    s_barrier
    ds_read_b64_tr_b16 v[68:69], v6 offset:2048
    ds_read_b64_tr_b16 v[70:71], v6 offset:2560
    s_waitcnt lgkmcnt(6)
    v_mfma_f32_32x32x16_bf16 v[80:95], v[56:59], a[32:35], v[80:95]
    v_exp_f32 v73, v41
    s_mul_i32 s92, s9, 0x3800
    s_add_u32 s92, s92, s85
    s_add_u32 m0, s99, 0x1e000
    s_add_u32 s92, s92, 0x7000
    buffer_load_dwordx4 v9, s[44:47], s92 offen lds
    ds_read_b64_tr_b16 v[56:57], v4 offset:4096
    ds_read_b64_tr_b16 v[58:59], v4 offset:4608
    s_waitcnt lgkmcnt(6)
    v_mfma_f32_32x32x16_bf16 v[112:127], v[60:63], a[32:35], v[112:127]
    v_exp_f32 v74, v42
    v_exp_f32 v75, v43
    ds_read_b64_tr_b16 v[60:61], v6 offset:4096
    ds_read_b64_tr_b16 v[62:63], v6 offset:4608
    s_waitcnt lgkmcnt(6)
    v_mfma_f32_32x32x16_bf16 v[80:95], v[64:67], a[36:39], v[80:95]
    v_exp_f32 v76, v44
    v_exp_f32 v77, v45
    v_exp_f32 v78, v46
    ds_read_b64_tr_b16 v[64:65], v4 offset:6144
    ds_read_b64_tr_b16 v[66:67], v4 offset:6656
    s_waitcnt lgkmcnt(6)
    v_mfma_f32_32x32x16_bf16 v[112:127], v[68:71], a[36:39], v[112:127]
    v_exp_f32 v79, v47
    v_mul_f32 v40, v40, v48
    v_mul_f32 v41, v41, v49
    ds_read_b64_tr_b16 v[68:69], v6 offset:6144
    ds_read_b64_tr_b16 v[70:71], v6 offset:6656
    s_waitcnt lgkmcnt(6)
    v_mfma_f32_32x32x16_bf16 v[80:95], v[56:59], a[40:43], v[80:95]
    s_mul_i32 s92, s9, 0x3800
    s_add_u32 s92, s92, s85
    s_add_u32 m0, s99, 0x20000
    s_add_u32 s92, s92, 0xa800
    buffer_load_dwordx4 v9, s[44:47], s92 offen lds
    v_mul_f32 v42, v42, v50
    v_mul_f32 v43, v43, v51
    v_add_u32 v5, 0xc000, v12
    ds_read_b64_tr_b16 v[56:57], v5
    ds_read_b64_tr_b16 v[58:59], v5 offset:512
    s_waitcnt lgkmcnt(6)
    v_mfma_f32_32x32x16_bf16 v[112:127], v[60:63], a[40:43], v[112:127]
    v_mul_f32 v44, v44, v52
    v_mul_f32 v45, v45, v53
    v_mul_f32 v46, v46, v54
    v_mul_f32 v47, v47, v55
    v_add_f32 v72, 1.0, v72
    v_add_f32 v73, 1.0, v73
    v_add_u32 v7, 0xc000, v13
    ds_read_b64_tr_b16 v[60:61], v7
    ds_read_b64_tr_b16 v[62:63], v7 offset:512
    s_waitcnt lgkmcnt(6)
    v_mfma_f32_32x32x16_bf16 v[80:95], v[64:67], a[44:47], v[80:95]
    v_add_f32 v74, 1.0, v74
    v_add_f32 v75, 1.0, v75
    v_add_f32 v76, 1.0, v76
    v_add_f32 v77, 1.0, v77
    v_add_f32 v78, 1.0, v78
    ds_read_b64_tr_b16 v[64:65], v5 offset:2048
    ds_read_b64_tr_b16 v[66:67], v5 offset:2560
    s_waitcnt lgkmcnt(6)
    v_mfma_f32_32x32x16_bf16 v[112:127], v[68:71], a[44:47], v[112:127]
    v_add_f32 v79, 1.0, v79
    v_rcp_f32 v72, v72
    v_rcp_f32 v73, v73
    s_waitcnt vmcnt(9)
    s_barrier
    ds_read_b64_tr_b16 v[68:69], v7 offset:2048
    ds_read_b64_tr_b16 v[70:71], v7 offset:2560
    s_waitcnt lgkmcnt(6)
    v_mfma_f32_32x32x16_bf16 v[80:95], v[56:59], a[48:51], v[80:95]
    v_rcp_f32 v74, v74
    s_mul_i32 s92, s19, 0x3800
    s_add_u32 m0, s99, 0x22000
    s_add_u32 s92, s92, s85
    buffer_load_dwordx4 v9, s[44:47], s92 offen lds
    ds_read_b64_tr_b16 v[56:57], v5 offset:4096
    ds_read_b64_tr_b16 v[58:59], v5 offset:4608
    s_waitcnt lgkmcnt(6)
    v_mfma_f32_32x32x16_bf16 v[112:127], v[60:63], a[48:51], v[112:127]
    v_rcp_f32 v75, v75
    v_rcp_f32 v76, v76
    v_rcp_f32 v77, v77
    v_rcp_f32 v78, v78
    ds_read_b64_tr_b16 v[60:61], v7 offset:4096
    ds_read_b64_tr_b16 v[62:63], v7 offset:4608
    s_waitcnt lgkmcnt(6)
    v_mfma_f32_32x32x16_bf16 v[80:95], v[64:67], a[52:55], v[80:95]
    v_rcp_f32 v79, v79
    v_mul_f32 v40, v40, v72
    v_mul_f32 v41, v41, v73
    v_mul_f32 v42, v42, v74
    v_mul_f32 v43, v43, v75
    ds_read_b64_tr_b16 v[64:65], v5 offset:6144
    ds_read_b64_tr_b16 v[66:67], v5 offset:6656
    s_waitcnt lgkmcnt(6)
    v_mfma_f32_32x32x16_bf16 v[112:127], v[68:71], a[52:55], v[112:127]
    v_mul_f32 v44, v44, v76
    v_mul_f32 v45, v45, v77
    v_mul_f32 v46, v46, v78
    v_mul_f32 v47, v47, v79
    v_cvt_pk_bf16_f32 v136, v40, v41
    ds_read_b64_tr_b16 v[68:69], v7 offset:6144
    ds_read_b64_tr_b16 v[70:71], v7 offset:6656
    s_waitcnt lgkmcnt(6)
    v_mfma_f32_32x32x16_bf16 v[80:95], v[56:59], a[56:59], v[80:95]
    s_mul_i32 s92, s19, 0x3800
    s_add_u32 s92, s92, s85
    s_add_u32 m0, s99, 0x24000
    s_add_u32 s92, s92, 0x3800
    buffer_load_dwordx4 v9, s[44:47], s92 offen lds
    v_cvt_pk_bf16_f32 v137, v42, v43
    v_cvt_pk_bf16_f32 v138, v44, v45
    v_cvt_pk_bf16_f32 v139, v46, v47
    v_add_u32 v4, 0x10000, v12
    ds_read_b64_tr_b16 v[56:57], v4
    ds_read_b64_tr_b16 v[58:59], v4 offset:512
    s_waitcnt lgkmcnt(6)
    v_mfma_f32_32x32x16_bf16 v[112:127], v[60:63], a[56:59], v[112:127]
    s_lshl_b32 s93, s88, 5
    s_add_u32 s93, s93, s90
    s_mul_i32 s94, s70, 0x800
    s_add_u32 s93, s93, s94
    buffer_store_dwordx4 v[136:139], v2, s[60:63], s93 offen offset:1024 sc1
    s_lshr_b32 s93, s97, 1
    s_lshl_b32 s93, s93, 2
    s_and_b32 s94, s97, 1
    s_lshl_b32 s94, s94, 1
    s_add_u32 s93, s93, s94
    s_add_u32 s93, s93, s70
    s_mul_i32 s10, s93, 0x1c000
    s_mul_i32 s94, s69, 0x7000
    s_add_u32 s10, s10, s94
    s_lshl_b32 s11, s93, 15
    s_lshl_b32 s94, s69, 13
    s_add_u32 s11, s11, s94
    s_add_u32 s11, s11, 0x700000
    s_lshr_b32 s93, s97, 1
    s_lshl_b32 s93, s93, 13
    s_add_u32 s13, s93, 0x930000
    v_and_b32 v142, 15, v1
    v_lshlrev_b32 v142, 9, v142
    v_add_u32 v6, 0x10000, v13
    ds_read_b64_tr_b16 v[60:61], v6
    ds_read_b64_tr_b16 v[62:63], v6 offset:512
    s_waitcnt lgkmcnt(6)
    v_mfma_f32_32x32x16_bf16 v[80:95], v[64:67], a[60:63], v[80:95]
    ds_read_b64_tr_b16 v[64:65], v4 offset:2048
    ds_read_b64_tr_b16 v[66:67], v4 offset:2560
    s_waitcnt lgkmcnt(6)
    v_mfma_f32_32x32x16_bf16 v[112:127], v[68:71], a[60:63], v[112:127]
    v_bfe_u32 v20, v1, 2, 2
    v_lshrrev_b32 v21, 5, v1
    v_lshl_add_u32 v21, v21, 2, v20
    v_lshrrev_b32 v20, 1, v20
    v_lshlrev_b32 v20, 6, v20
    v_lshl_add_u32 v20, v21, 7, v20
    v_bfe_u32 v21, v1, 4, 1
    v_lshl_add_u32 v20, v21, 5, v20
    v_and_b32 v21, 3, v1
    v_lshl_add_u32 v20, v21, 3, v20
    s_lshl_b32 s93, s69, 11
    v_add_u32 v128, s93, v20
    s_waitcnt vmcnt(10)
    s_barrier
    ds_read_b64_tr_b16 v[68:69], v6 offset:2048
    ds_read_b64_tr_b16 v[70:71], v6 offset:2560
    s_waitcnt lgkmcnt(6)
    v_mfma_f32_32x32x16_bf16 v[80:95], v[56:59], a[64:67], v[80:95]
    v_xor_b32 v129, 64, v128
    ds_read_b64_tr_b16 v[56:57], v4 offset:4096
    ds_read_b64_tr_b16 v[58:59], v4 offset:4608
    s_waitcnt lgkmcnt(6)
    v_mfma_f32_32x32x16_bf16 v[112:127], v[60:63], a[64:67], v[112:127]
    v_and_b32 v10, 15, v1
    v_lshlrev_b32 v10, 13, v10
    s_lshl_b32 s93, s72, 10
    s_add_u32 s12, s93, 0x930000
    s_cmp_lg_u32 s68, 0
    s_cbranch_scc1 L_pi_3006
    buffer_load_dword v11, v10, s[60:63], s12 offen sc1
L_pi_3006:
    ds_read_b64_tr_b16 v[60:61], v6 offset:4096
    ds_read_b64_tr_b16 v[62:63], v6 offset:4608
    s_waitcnt lgkmcnt(6)
    v_mfma_f32_32x32x16_bf16 v[80:95], v[64:67], a[68:71], v[80:95]
    v_add_u32 v130, 0x10000, v128
    v_add_u32 v131, 0x10000, v129
    v_add_u32 v140, 0x20000, v128
    ds_read_b64_tr_b16 v[64:65], v4 offset:6144
    ds_read_b64_tr_b16 v[66:67], v4 offset:6656
    s_waitcnt lgkmcnt(6)
    v_mfma_f32_32x32x16_bf16 v[112:127], v[68:71], a[68:71], v[112:127]
    s_mul_i32 s92, s19, 0x3800
    s_add_u32 s92, s92, s85
    s_add_u32 m0, s99, 0xc000
    s_add_u32 s92, s92, 0x7000
    buffer_load_dwordx4 v9, s[44:47], s92 offen lds
    ds_read_b64_tr_b16 v[68:69], v6 offset:6144
    ds_read_b64_tr_b16 v[70:71], v6 offset:6656
    s_waitcnt lgkmcnt(6)
    v_mfma_f32_32x32x16_bf16 v[80:95], v[56:59], a[72:75], v[80:95]
    v_add_u32 v141, 0x20000, v129
    v_add_u32 v5, 0x14000, v12
    ds_read_b64_tr_b16 v[56:57], v5
    ds_read_b64_tr_b16 v[58:59], v5 offset:512
    s_waitcnt lgkmcnt(6)
    v_mfma_f32_32x32x16_bf16 v[112:127], v[60:63], a[72:75], v[112:127]
    v_lshrrev_b32 v20, 3, v1
    s_lshl_b32 s93, s97, 6
    s_lshl_b32 s94, s70, 5
    s_add_u32 s93, s93, s94
    s_lshl_b32 s94, s69, 3
    s_add_u32 s93, s93, s94
    v_add_u32 v20, s93, v20
    v_mul_u32_u24 v20, 0x380, v20
    v_and_b32 v21, 7, v1
    v_lshl_add_u32 v20, v21, 4, v20
    s_lshl_b32 s93, s98, 7
    v_add_u32 v8, s93, v20
    v_add_u32 v7, 0x14000, v13
    ds_read_b64_tr_b16 v[60:61], v7
    ds_read_b64_tr_b16 v[62:63], v7 offset:512
    s_waitcnt lgkmcnt(6)
    v_mfma_f32_32x32x16_bf16 v[80:95], v[64:67], a[76:79], v[80:95]
    ds_read_b64_tr_b16 v[64:65], v5 offset:2048
    ds_read_b64_tr_b16 v[66:67], v5 offset:2560
    s_waitcnt lgkmcnt(6)
    v_mfma_f32_32x32x16_bf16 v[112:127], v[68:71], a[76:79], v[112:127]
    s_mul_i32 s92, s19, 0x3800
    s_add_u32 s92, s92, s85
    s_add_u32 m0, s99, 0xe000
    s_add_u32 s92, s92, 0xa800
    buffer_load_dwordx4 v9, s[44:47], s92 offen lds
    s_waitcnt vmcnt(2)
    s_barrier
    ds_read_b64_tr_b16 v[68:69], v7 offset:2048
    ds_read_b64_tr_b16 v[70:71], v7 offset:2560
    s_waitcnt lgkmcnt(6)
    v_mfma_f32_32x32x16_bf16 v[80:95], v[56:59], a[80:83], v[80:95]
    ds_read_b64_tr_b16 v[56:57], v5 offset:4096
    ds_read_b64_tr_b16 v[58:59], v5 offset:4608
    s_waitcnt lgkmcnt(6)
    v_mfma_f32_32x32x16_bf16 v[112:127], v[60:63], a[80:83], v[112:127]
    s_cmp_lg_u32 s68, 0
    s_cbranch_scc1 L_sig_3007
    v_mov_b32 v20, 1
    v_mov_b32 v21, 0
    s_add_u32 s93, s16, 0x80
    s_mov_b64 exec, 1
    buffer_store_dword v20, v21, s[60:63], s93 offen sc1
    s_mov_b64 exec, -1
L_sig_3007:
    ds_read_b64_tr_b16 v[60:61], v7 offset:4096
    ds_read_b64_tr_b16 v[62:63], v7 offset:4608
    s_waitcnt lgkmcnt(6)
    v_mfma_f32_32x32x16_bf16 v[80:95], v[64:67], a[84:87], v[80:95]
    ds_read_b64_tr_b16 v[64:65], v5 offset:6144
    ds_read_b64_tr_b16 v[66:67], v5 offset:6656
    s_waitcnt lgkmcnt(6)
    v_mfma_f32_32x32x16_bf16 v[112:127], v[68:71], a[84:87], v[112:127]
    s_add_u32 s14, s13, 0x80
    s_cmp_lg_u32 s68, 0
    s_cbranch_scc1 L_pi_3008
    buffer_load_dword v143, v142, s[60:63], s14 offen sc1
L_pi_3008:
    ds_read_b64_tr_b16 v[68:69], v7 offset:6144
    ds_read_b64_tr_b16 v[70:71], v7 offset:6656
    s_waitcnt lgkmcnt(6)
    v_mfma_f32_32x32x16_bf16 v[80:95], v[56:59], a[88:91], v[80:95]
    s_mul_i32 s92, s22, 0x3800
    s_add_u32 m0, s99, 0x10000
    s_add_u32 s92, s92, s85
    buffer_load_dwordx4 v9, s[44:47], s92 offen lds
    v_add_u32 v4, 0, v12
    ds_read_b64_tr_b16 v[56:57], v4
    ds_read_b64_tr_b16 v[58:59], v4 offset:512
    s_waitcnt lgkmcnt(6)
    v_mfma_f32_32x32x16_bf16 v[112:127], v[60:63], a[88:91], v[112:127]
    s_mul_i32 s92, s22, 0x3800
    s_add_u32 s92, s92, s85
    s_add_u32 m0, s99, 0x12000
    s_add_u32 s92, s92, 0x3800
    buffer_load_dwordx4 v9, s[44:47], s92 offen lds
    v_add_u32 v6, 0, v13
    ds_read_b64_tr_b16 v[60:61], v6
    ds_read_b64_tr_b16 v[62:63], v6 offset:512
    s_waitcnt lgkmcnt(6)
    v_mfma_f32_32x32x16_bf16 v[80:95], v[64:67], a[92:95], v[80:95]
    ds_read_b64_tr_b16 v[64:65], v4 offset:2048
    ds_read_b64_tr_b16 v[66:67], v4 offset:2560
    s_waitcnt lgkmcnt(6)
    v_mfma_f32_32x32x16_bf16 v[112:127], v[68:71], a[92:95], v[112:127]
    s_cmp_lg_u32 s68, 0
    s_cbranch_scc1 L_pc_3009
    v_cmp_le_u32 vcc, 1, v11
    s_nop 0
    s_cmp_eq_u64 vcc, -1
    s_cbranch_scc1 L_poll_3010_done
    s_mov_b32 s100, 0x186a0
L_poll_3010:
    s_sleep 2
    buffer_load_dword v11, v10, s[60:63], s12 offen sc1
    s_waitcnt vmcnt(0)
    v_cmp_le_u32 vcc, 1, v11
    s_nop 0
    s_cmp_eq_u64 vcc, -1
    s_cbranch_scc1 L_poll_3010_done
    s_sub_u32 s100, s100, 1
    s_cmp_lg_u32 s100, 0
    s_cbranch_scc1 L_poll_3010
L_poll_3010_done:
L_pc_3009:
    s_barrier
    ds_read_b64_tr_b16 v[68:69], v6 offset:2048
    ds_read_b64_tr_b16 v[70:71], v6 offset:2560
    s_waitcnt lgkmcnt(6)
    v_mfma_f32_32x32x16_bf16 v[80:95], v[56:59], a[96:99], v[80:95]
    ds_read_b64_tr_b16 v[56:57], v4 offset:4096
    ds_read_b64_tr_b16 v[58:59], v4 offset:4608
    s_waitcnt lgkmcnt(6)
    v_mfma_f32_32x32x16_bf16 v[112:127], v[60:63], a[96:99], v[112:127]
    s_lshl_b32 s92, s72, 1
    s_add_u32 s92, s92, s70
    s_lshl_b32 s92, s92, 13
    s_lshl_b32 s93, s69, 11
    s_add_u32 s92, s92, s93
    s_add_u32 s92, s92, 0x900000
    s_add_u32 m0, s93, 0x18000
    s_nop 0
    buffer_load_dwordx4 v2, s[60:63], s92 offen sc1 lds
    buffer_load_dwordx4 v2, s[60:63], s92 offen offset:1024 sc1 lds
    ds_read_b64_tr_b16 v[60:61], v6 offset:4096
    ds_read_b64_tr_b16 v[62:63], v6 offset:4608
    s_waitcnt lgkmcnt(6)
    v_mfma_f32_32x32x16_bf16 v[80:95], v[64:67], a[100:103], v[80:95]
    ds_read_b64_tr_b16 v[64:65], v4 offset:6144
    ds_read_b64_tr_b16 v[66:67], v4 offset:6656
    s_waitcnt lgkmcnt(6)
    v_mfma_f32_32x32x16_bf16 v[112:127], v[68:71], a[100:103], v[112:127]
    ds_read_b64_tr_b16 v[68:69], v6 offset:6144
    ds_read_b64_tr_b16 v[70:71], v6 offset:6656
    s_waitcnt lgkmcnt(6)
    v_mfma_f32_32x32x16_bf16 v[80:95], v[56:59], a[104:107], v[80:95]
    s_waitcnt lgkmcnt(4)
    v_mfma_f32_32x32x16_bf16 v[112:127], v[60:63], a[104:107], v[112:127]
    s_waitcnt lgkmcnt(2)
    v_mfma_f32_32x32x16_bf16 v[80:95], v[64:67], a[108:111], v[80:95]
    s_waitcnt lgkmcnt(0)
    v_mfma_f32_32x32x16_bf16 v[112:127], v[68:71], a[108:111], v[112:127]
    s_waitcnt vmcnt(0)
    s_cmp_lg_u32 s68, 0
    s_cbranch_scc1 L_pc_3011
    v_cmp_le_u32 vcc, 1, v143
    s_nop 0
    s_and_b32 s93, vcc_lo, 0xaaaa
    s_cmp_eq_u32 s93, 0xaaaa
    s_cbranch_scc1 L_poll_3012_done
    s_mov_b32 s100, 0x186a0
L_poll_3012:
    s_sleep 2
    buffer_load_dword v143, v142, s[60:63], s14 offen sc1
    s_waitcnt vmcnt(0)
    v_cmp_le_u32 vcc, 1, v143
    s_nop 0
    s_and_b32 s93, vcc_lo, 0xaaaa
    s_cmp_eq_u32 s93, 0xaaaa
    s_cbranch_scc1 L_poll_3012_done
    s_sub_u32 s100, s100, 1
    s_cmp_lg_u32 s100, 0
    s_cbranch_scc1 L_poll_3012
L_poll_3012_done:
L_pc_3011:
    s_barrier
    s_lshl_b32 s92, s8, 10
    s_add_u32 s92, s92, s10
    buffer_load_dwordx4 a[0:3], v2, s[60:63], s92 offen sc1
    s_lshl_b32 s92, s8, 10
    s_add_u32 s92, s92, s10
    buffer_load_dwordx4 a[4:7], v2, s[60:63], s92 offen offset:1024 sc1
    s_lshl_b32 s92, s8, 10
    s_add_u32 s92, s92, s10
    buffer_load_dwordx4 a[8:11], v2, s[60:63], s92 offen offset:2048 sc1
    s_lshl_b32 s92, s8, 10
    s_add_u32 s92, s92, s10
    buffer_load_dwordx4 a[12:15], v2, s[60:63], s92 offen offset:3072 sc1
    s_lshl_b32 s92, s9, 10
    s_add_u32 s92, s92, s10
    buffer_load_dwordx4 a[16:19], v2, s[60:63], s92 offen sc1
    s_lshl_b32 s92, s9, 10
    s_add_u32 s92, s92, s10
    buffer_load_dwordx4 a[20:23], v2, s[60:63], s92 offen offset:1024 sc1
    s_lshl_b32 s92, s9, 10
    s_add_u32 s92, s92, s10
    buffer_load_dwordx4 a[24:27], v2, s[60:63], s92 offen offset:2048 sc1
    s_lshl_b32 s92, s9, 10
    s_add_u32 s92, s92, s10
    buffer_load_dwordx4 a[28:31], v2, s[60:63], s92 offen offset:3072 sc1
    v_bfe_u32 v22, v1, 4, 1
    v_lshlrev_b32 v22, 10, v22
    v_lshrrev_b32 v23, 5, v1
    v_lshl_add_u32 v22, v23, 6, v22
    v_and_b32 v23, 15, v1
    v_lshl_add_u32 v22, v23, 2, v22
    v_add_u32 v22, 0x18000, v22
    v_add_u32 v23, 0x80, v22
    ds_read2st64_b32 v[24:25], v22 offset0:0 offset1:1
    ds_read2st64_b32 v[26:27], v22 offset0:2 offset1:3
    ds_read2st64_b32 v[28:29], v23 offset0:0 offset1:1
    ds_read2st64_b32 v[30:31], v23 offset0:2 offset1:3
    ds_read2st64_b32 v[32:33], v22 offset0:8 offset1:9
    ds_read2st64_b32 v[34:35], v22 offset0:10 offset1:11
    ds_read2st64_b32 v[36:37], v23 offset0:8 offset1:9
    ds_read2st64_b32 v[38:39], v23 offset0:10 offset1:11
    ds_read2st64_b32 v[40:41], v22 offset0:16 offset1:17
    ds_read2st64_b32 v[42:43], v22 offset0:18 offset1:19
    ds_read2st64_b32 v[44:45], v23 offset0:16 offset1:17
    ds_read2st64_b32 v[46:47], v23 offset0:18 offset1:19
    ds_read2st64_b32 v[48:49], v22 offset0:24 offset1:25
    ds_read2st64_b32 v[50:51], v22 offset0:26 offset1:27
    ds_read2st64_b32 v[52:53], v23 offset0:24 offset1:25
    ds_read2st64_b32 v[54:55], v23 offset0:26 offset1:27
    v_exp_f32 v72, v80
    v_exp_f32 v73, v81
    v_exp_f32 v74, v82
    v_exp_f32 v75, v83
    v_exp_f32 v76, v84
    v_exp_f32 v77, v85
    v_exp_f32 v78, v86
    v_exp_f32 v79, v87
    s_mul_i32 s92, s22, 0x3800
    s_add_u32 s92, s92, s85
    s_add_u32 m0, s99, 0x14000
    s_add_u32 s92, s92, 0x7000
    buffer_load_dwordx4 v9, s[44:47], s92 offen lds
    v_mul_f32 v80, v80, v88
    v_mul_f32 v81, v81, v89
    v_mul_f32 v82, v82, v90
    v_mul_f32 v83, v83, v91
    v_mul_f32 v84, v84, v92
    v_mul_f32 v85, v85, v93
    v_mul_f32 v86, v86, v94
    v_mul_f32 v87, v87, v95
    v_add_f32 v72, 1.0, v72
    v_add_f32 v73, 1.0, v73
    v_add_f32 v74, 1.0, v74
    v_add_f32 v75, 1.0, v75
    v_add_f32 v76, 1.0, v76
    v_add_f32 v77, 1.0, v77
    v_add_f32 v78, 1.0, v78
    v_add_f32 v79, 1.0, v79
    v_rcp_f32 v72, v72
    v_rcp_f32 v73, v73
    v_rcp_f32 v74, v74
    v_rcp_f32 v75, v75
    v_rcp_f32 v76, v76
    v_rcp_f32 v77, v77
    v_rcp_f32 v78, v78
    s_mul_i32 s92, s22, 0x3800
    s_add_u32 s92, s92, s85
    s_add_u32 m0, s99, 0x16000
    s_add_u32 s92, s92, 0xa800
    buffer_load_dwordx4 v9, s[44:47], s92 offen lds
    v_rcp_f32 v79, v79
    v_mul_f32 v80, v80, v72
    v_mul_f32 v81, v81, v73
    v_mul_f32 v82, v82, v74
    v_mul_f32 v83, v83, v75
    v_mul_f32 v84, v84, v76
    v_mul_f32 v85, v85, v77
    v_mul_f32 v86, v86, v78
    v_mul_f32 v87, v87, v79
    v_cvt_pk_bf16_f32 v132, v80, v81
    v_cvt_pk_bf16_f32 v133, v82, v83
    v_cvt_pk_bf16_f32 v134, v84, v85
    v_cvt_pk_bf16_f32 v135, v86, v87
    s_lshl_b32 s93, s89, 5
    s_add_u32 s93, s93, s90
    s_mul_i32 s94, s70, 0x800
    s_add_u32 s93, s93, s94
    buffer_store_dwordx4 v[132:135], v2, s[60:63], s93 offen sc1
    s_waitcnt lgkmcnt(15)
    v_cvt_pk_bf16_f32 v56, v24, v25
    s_waitcnt lgkmcnt(14)
    v_cvt_pk_bf16_f32 v57, v26, v27
    s_waitcnt lgkmcnt(13)
    v_cvt_pk_bf16_f32 v58, v28, v29
    s_waitcnt lgkmcnt(12)
    v_cvt_pk_bf16_f32 v59, v30, v31
    s_waitcnt lgkmcnt(11)
    v_cvt_pk_bf16_f32 v60, v32, v33
    s_waitcnt lgkmcnt(10)
    v_cvt_pk_bf16_f32 v61, v34, v35
    s_waitcnt lgkmcnt(9)
    v_cvt_pk_bf16_f32 v62, v36, v37
    s_waitcnt lgkmcnt(8)
    v_cvt_pk_bf16_f32 v63, v38, v39
    s_waitcnt lgkmcnt(7)
    v_cvt_pk_bf16_f32 v64, v40, v41
    s_waitcnt lgkmcnt(6)
    v_cvt_pk_bf16_f32 v65, v42, v43
    s_waitcnt lgkmcnt(5)
    v_cvt_pk_bf16_f32 v66, v44, v45
    s_waitcnt lgkmcnt(4)
    v_cvt_pk_bf16_f32 v67, v46, v47
    s_waitcnt lgkmcnt(3)
    v_cvt_pk_bf16_f32 v68, v48, v49
    s_waitcnt lgkmcnt(2)
    v_cvt_pk_bf16_f32 v69, v50, v51
    s_waitcnt lgkmcnt(1)
    v_cvt_pk_bf16_f32 v70, v52, v53
    s_waitcnt lgkmcnt(0)
    v_cvt_pk_bf16_f32 v71, v54, v55
    v_mfma_f32_32x32x16_bf16 v[80:95], v[56:59], v[96:99], 0
    v_mfma_f32_32x32x16_bf16 v[80:95], v[60:63], v[100:103], v[80:95]
    v_mfma_f32_32x32x16_bf16 v[80:95], v[64:67], v[104:107], v[80:95]
    v_mfma_f32_32x32x16_bf16 v[80:95], v[68:71], v[108:111], v[80:95]
    s_lshl_b32 s93, s71, 2
    s_add_u32 s93, s93, s69
    s_lshl_b32 s93, s93, 4
    s_lshl_b32 s94, s72, 1
    s_add_u32 s93, s93, s94
    s_add_u32 s93, s93, s70
    s_lshl_b32 s93, s93, 11
    s_add_u32 s15, s93, 0x700000
    v_exp_f32 v72, v112
    v_exp_f32 v73, v113
    v_exp_f32 v74, v114
    v_exp_f32 v75, v115
    v_exp_f32 v76, v116
    v_exp_f32 v77, v117
    v_exp_f32 v78, v118
    v_exp_f32 v79, v119
    s_mul_i32 s92, s23, 0x3800
    s_mov_b32 m0, s99
    s_add_u32 s92, s92, s85
    buffer_load_dwordx4 v9, s[44:47], s92 offen lds
    v_mul_f32 v112, v112, v120
    v_mul_f32 v113, v113, v121
    v_mul_f32 v114, v114, v122
    v_mul_f32 v115, v115, v123
    v_mul_f32 v116, v116, v124
    v_mul_f32 v117, v117, v125
    v_mul_f32 v118, v118, v126
    v_mul_f32 v119, v119, v127
    v_add_f32 v72, 1.0, v72
    v_add_f32 v73, 1.0, v73
    v_add_f32 v74, 1.0, v74
    v_add_f32 v75, 1.0, v75
    v_add_f32 v76, 1.0, v76
    v_add_f32 v77, 1.0, v77
    v_add_f32 v78, 1.0, v78
    v_add_f32 v79, 1.0, v79
    v_rcp_f32 v72, v72
    v_rcp_f32 v73, v73
    v_rcp_f32 v74, v74
    v_rcp_f32 v75, v75
    v_rcp_f32 v76, v76
    v_rcp_f32 v77, v77
    v_rcp_f32 v78, v78
    s_mul_i32 s92, s23, 0x3800
    s_add_u32 s92, s92, s85
    s_add_u32 m0, s99, 0x2000
    s_add_u32 s92, s92, 0x3800
    buffer_load_dwordx4 v9, s[44:47], s92 offen lds
    v_rcp_f32 v79, v79
    v_mul_f32 v112, v112, v72
    v_mul_f32 v113, v113, v73
    v_mul_f32 v114, v114, v74
    v_mul_f32 v115, v115, v75
    v_mul_f32 v116, v116, v76
    v_mul_f32 v117, v117, v77
    v_mul_f32 v118, v118, v78
    v_mul_f32 v119, v119, v79
    v_cvt_pk_bf16_f32 v136, v112, v113
    v_cvt_pk_bf16_f32 v137, v114, v115
    v_cvt_pk_bf16_f32 v138, v116, v117
    v_cvt_pk_bf16_f32 v139, v118, v119
    s_lshl_b32 s93, s89, 5
    s_add_u32 s93, s93, s90
    s_mul_i32 s94, s70, 0x800
    s_add_u32 s93, s93, s94
    buffer_store_dwordx4 v[136:139], v2, s[60:63], s93 offen offset:1024 sc1
    v_mov_b32 v20, v92
    v_mov_b32 v21, v92
    s_nop 0
    s_nop 0
    v_permlane32_swap_b32 v20, v21
    v_add_f32 v21, 0x358637bd, v21
    v_rcp_f32 v21, v21
    s_nop 0
    v_mul_f32 v80, v80, v21
    v_mul_f32 v81, v81, v21
    v_mul_f32 v82, v82, v21
    v_mul_f32 v83, v83, v21
    v_mul_f32 v84, v84, v21
    v_mul_f32 v85, v85, v21
    v_mul_f32 v86, v86, v21
    v_mul_f32 v87, v87, v21
    v_mul_f32 v88, v88, v21
    v_mul_f32 v89, v89, v21
    v_mul_f32 v90, v90, v21
    v_mul_f32 v91, v91, v21
    v_mul_f32 v92, v92, v21
    v_mul_f32 v93, v93, v21
    v_mul_f32 v94, v94, v21
    v_mul_f32 v95, v95, v21
    v_and_b32 v92, v16, v92
    v_and_b32 v93, v16, v93
    v_and_b32 v94, v16, v94
    v_and_b32 v95, v16, v95
    v_cvt_pk_bf16_f32 v24, v80, v81
    v_cvt_pk_bf16_f32 v25, v82, v83
    v_cvt_pk_bf16_f32 v26, v84, v85
    v_cvt_pk_bf16_f32 v27, v86, v87
    v_cvt_pk_bf16_f32 v28, v88, v89
    v_cvt_pk_bf16_f32 v29, v90, v91
    v_cvt_pk_bf16_f32 v30, v92, v93
    v_cvt_pk_bf16_f32 v31, v94, v95
    buffer_store_dwordx4 v[24:27], v2, s[60:63], s15 offen sc1
    buffer_store_dwordx4 v[28:31], v2, s[60:63], s15 offen offset:1024 sc1
    s_waitcnt lgkmcnt(0)
    s_barrier
    s_cmp_lg_u32 s96, 0
    s_cbranch_scc1 L_nop2_3016
    s_waitcnt vmcnt(0)
    s_barrier
    s_cmp_lg_u32 s68, 0
    s_cbranch_scc1 L_sig_3014
    v_mov_b32 v20, 1
    v_mov_b32 v21, 0
    s_add_u32 s93, s16, 0x100
    s_mov_b64 exec, 1
    buffer_store_dword v20, v21, s[60:63], s93 offen sc1
    s_mov_b64 exec, -1
L_sig_3014:
    s_cmp_lg_u32 s68, 0
    s_cbranch_scc1 L_sig_3015
    v_mov_b32 v20, 1
    v_mov_b32 v21, 0
    s_add_u32 s93, s16, 0x180
    s_mov_b64 exec, 1
    buffer_store_dword v20, v21, s[60:63], s93 offen sc1
    s_mov_b64 exec, -1
L_sig_3015:
    s_branch L_fin_3013
L_nop2_3016:
    ds_read_b64_tr_b16 v[96:97], v128 offset:32768
    ds_read_b64_tr_b16 v[98:99], v128 offset:33792
    ds_read_b64_tr_b16 v[100:101], v129 offset:32768
    ds_read_b64_tr_b16 v[102:103], v129 offset:33792
    ds_read_b64_tr_b16 v[104:105], v128 offset:40960
    ds_read_b64_tr_b16 v[106:107], v128 offset:41984
    ds_read_b64_tr_b16 v[108:109], v129 offset:40960
    ds_read_b64_tr_b16 v[110:111], v129 offset:41984
    ds_read_b64_tr_b16 v[112:113], v128 offset:16384
    ds_read_b64_tr_b16 v[114:115], v128 offset:17408
    ds_read_b64_tr_b16 v[116:117], v129 offset:16384
    ds_read_b64_tr_b16 v[118:119], v129 offset:17408
    s_waitcnt vmcnt(15) lgkmcnt(10)
    v_mfma_f32_32x32x16_bf16 v[32:47], v[96:99], a[0:3], 0
    s_add_u32 s14, s13, 0x80
    s_cmp_lg_u32 s68, 0
    s_cbranch_scc1 L_pi_3017
    buffer_load_dword v143, v142, s[60:63], s14 offen sc1
L_pi_3017:
    ds_read_b64_tr_b16 v[120:121], v128 offset:24576
    ds_read_b64_tr_b16 v[122:123], v128 offset:25600
    s_waitcnt lgkmcnt(10)
    v_mfma_f32_32x32x16_bf16 v[48:63], v[100:103], a[0:3], 0
    ds_read_b64_tr_b16 v[124:125], v129 offset:24576
    ds_read_b64_tr_b16 v[126:127], v129 offset:25600
    s_waitcnt vmcnt(14) lgkmcnt(10)
    v_mfma_f32_32x32x16_bf16 v[32:47], v[104:107], a[4:7], v[32:47]
    s_mul_i32 s92, s23, 0x3800
    s_add_u32 s92, s92, s85
    s_add_u32 m0, s99, 0x18000
    s_add_u32 s92, s92, 0x7000
    buffer_load_dwordx4 v9, s[44:47], s92 offen lds
    ds_read_b64_tr_b16 v[96:97], v130 offset:40960
    ds_read_b64_tr_b16 v[98:99], v130 offset:41984
    s_waitcnt lgkmcnt(10)
    v_mfma_f32_32x32x16_bf16 v[48:63], v[108:111], a[4:7], v[48:63]
    ds_read_b64_tr_b16 v[100:101], v131 offset:40960
    ds_read_b64_tr_b16 v[102:103], v131 offset:41984
    s_waitcnt vmcnt(14) lgkmcnt(10)
    v_mfma_f32_32x32x16_bf16 v[32:47], v[112:115], a[8:11], v[32:47]
    ds_read_b64_tr_b16 v[104:105], v130 offset:49152
    ds_read_b64_tr_b16 v[106:107], v130 offset:50176
    s_waitcnt lgkmcnt(10)
    v_mfma_f32_32x32x16_bf16 v[48:63], v[116:119], a[8:11], v[48:63]
    s_mul_i32 s92, s23, 0x3800
    s_add_u32 s92, s92, s85
    s_add_u32 m0, s99, 0x26000
    s_add_u32 s92, s92, 0xa800
    buffer_load_dwordx4 v9, s[44:47], s92 offen lds
    ds_read_b64_tr_b16 v[108:109], v131 offset:49152
    ds_read_b64_tr_b16 v[110:111], v131 offset:50176
    s_waitcnt vmcnt(14) lgkmcnt(10)
    v_mfma_f32_32x32x16_bf16 v[32:47], v[120:123], a[12:15], v[32:47]
    s_waitcnt lgkmcnt(8)
    v_mfma_f32_32x32x16_bf16 v[48:63], v[124:127], a[12:15], v[48:63]
    s_waitcnt vmcnt(2)
    s_cmp_lg_u32 s68, 0
    s_cbranch_scc1 L_pc_3018
    v_cmp_le_u32 vcc, 1, v143
    s_nop 0
    s_and_b32 s93, vcc_lo, 0x5555
    s_cmp_eq_u32 s93, 0x5555
    s_cbranch_scc1 L_poll_3019_done
    s_mov_b32 s100, 0x186a0
L_poll_3019:
    s_sleep 2
    buffer_load_dword v143, v142, s[60:63], s14 offen sc1
    s_waitcnt vmcnt(0)
    v_cmp_le_u32 vcc, 1, v143
    s_nop 0
    s_and_b32 s93, vcc_lo, 0x5555
    s_cmp_eq_u32 s93, 0x5555
    s_cbranch_scc1 L_poll_3019_done
    s_sub_u32 s100, s100, 1
    s_cmp_lg_u32 s100, 0
    s_cbranch_scc1 L_poll_3019
L_poll_3019_done:
L_pc_3018:
    s_barrier
    ds_read_b64_tr_b16 v[112:113], v130 offset:57344
    ds_read_b64_tr_b16 v[114:115], v130 offset:58368
    ds_read_b64_tr_b16 v[116:117], v131 offset:57344
    ds_read_b64_tr_b16 v[118:119], v131 offset:58368
    s_waitcnt lgkmcnt(10)
    v_mfma_f32_32x32x16_bf16 v[32:47], v[96:99], a[16:19], v[32:47]
    s_cmp_lg_u32 s68, 0
    s_cbranch_scc1 L_sig_3021
    v_mov_b32 v20, 1
    v_mov_b32 v21, 0
    s_add_u32 s93, s16, 0x100
    s_mov_b64 exec, 1
    buffer_store_dword v20, v21, s[60:63], s93 offen sc1
    s_mov_b64 exec, -1
L_sig_3021:
    ds_read_b64_tr_b16 v[120:121], v140
    ds_read_b64_tr_b16 v[122:123], v140 offset:1024
    s_waitcnt lgkmcnt(10)
    v_mfma_f32_32x32x16_bf16 v[48:63], v[100:103], a[16:19], v[48:63]
    s_cmp_lg_u32 s68, 0
    s_cbranch_scc1 L_sig_3020
    v_mov_b32 v20, 1
    v_mov_b32 v21, 0
    s_add_u32 s93, s16, 0x180
    s_mov_b64 exec, 1
    buffer_store_dword v20, v21, s[60:63], s93 offen sc1
    s_mov_b64 exec, -1
L_sig_3020:
    ds_read_b64_tr_b16 v[124:125], v141
    ds_read_b64_tr_b16 v[126:127], v141 offset:1024
    s_waitcnt lgkmcnt(10)
    v_mfma_f32_32x32x16_bf16 v[32:47], v[104:107], a[20:23], v[32:47]
    s_lshl_b32 s92, s19, 10
    s_add_u32 s92, s92, s10
    buffer_load_dwordx4 a[32:35], v2, s[60:63], s92 offen sc1
    ds_read_b64_tr_b16 v[96:97], v140 offset:8192
    ds_read_b64_tr_b16 v[98:99], v140 offset:9216
    s_waitcnt lgkmcnt(10)
    v_mfma_f32_32x32x16_bf16 v[48:63], v[108:111], a[20:23], v[48:63]
    s_lshl_b32 s92, s19, 10
    s_add_u32 s92, s92, s10
    buffer_load_dwordx4 a[36:39], v2, s[60:63], s92 offen offset:1024 sc1
    ds_read_b64_tr_b16 v[100:101], v141 offset:8192
    ds_read_b64_tr_b16 v[102:103], v141 offset:9216
    s_waitcnt lgkmcnt(10)
    v_mfma_f32_32x32x16_bf16 v[32:47], v[112:115], a[24:27], v[32:47]
    s_lshl_b32 s92, s19, 10
    s_add_u32 s92, s92, s10
    buffer_load_dwordx4 a[40:43], v2, s[60:63], s92 offen offset:2048 sc1
    s_lshl_b32 s92, s19, 10
    s_add_u32 s92, s92, s10
    buffer_load_dwordx4 a[44:47], v2, s[60:63], s92 offen offset:3072 sc1
    ds_read_b64_tr_b16 v[104:105], v140 offset:16384
    ds_read_b64_tr_b16 v[106:107], v140 offset:17408
    s_waitcnt lgkmcnt(10)
    v_mfma_f32_32x32x16_bf16 v[48:63], v[116:119], a[24:27], v[48:63]
    s_lshl_b32 s92, s22, 10
    s_add_u32 s92, s92, s10
    buffer_load_dwordx4 a[48:51], v2, s[60:63], s92 offen sc1
    ds_read_b64_tr_b16 v[108:109], v141 offset:16384
    ds_read_b64_tr_b16 v[110:111], v141 offset:17408
    s_waitcnt lgkmcnt(10)
    v_mfma_f32_32x32x16_bf16 v[32:47], v[120:123], a[28:31], v[32:47]
    s_lshl_b32 s92, s22, 10
    s_add_u32 s92, s92, s10
    buffer_load_dwordx4 a[52:55], v2, s[60:63], s92 offen offset:1024 sc1
    s_waitcnt lgkmcnt(8)
    v_mfma_f32_32x32x16_bf16 v[48:63], v[124:127], a[28:31], v[48:63]
    s_lshl_b32 s92, s22, 10
    s_add_u32 s92, s92, s10
    buffer_load_dwordx4 a[56:59], v2, s[60:63], s92 offen offset:2048 sc1
    s_lshl_b32 s92, s22, 10
    s_add_u32 s92, s92, s10
    buffer_load_dwordx4 a[60:63], v2, s[60:63], s92 offen offset:3072 sc1
    s_barrier
    ds_read_b64_tr_b16 v[112:113], v128 offset:49152
    ds_read_b64_tr_b16 v[114:115], v128 offset:50176
    ds_read_b64_tr_b16 v[116:117], v129 offset:49152
    ds_read_b64_tr_b16 v[118:119], v129 offset:50176
    s_waitcnt vmcnt(7) lgkmcnt(10)
    v_mfma_f32_32x32x16_bf16 v[32:47], v[96:99], a[32:35], v[32:47]
    s_add_u32 s14, s13, 0x100
    s_cmp_lg_u32 s68, 0
    s_cbranch_scc1 L_pi_3022
    buffer_load_dword v143, v142, s[60:63], s14 offen sc1
L_pi_3022:
    ds_read_b64_tr_b16 v[120:121], v128 offset:57344
    ds_read_b64_tr_b16 v[122:123], v128 offset:58368
    s_waitcnt lgkmcnt(10)
    v_mfma_f32_32x32x16_bf16 v[48:63], v[100:103], a[32:35], v[48:63]
    s_mul_i32 s92, s24, 0x3800
    s_add_u32 m0, s99, 0x8000
    s_add_u32 s92, s92, s85
    buffer_load_dwordx4 v9, s[44:47], s92 offen lds
    ds_read_b64_tr_b16 v[124:125], v129 offset:57344
    ds_read_b64_tr_b16 v[126:127], v129 offset:58368
    s_waitcnt vmcnt(7) lgkmcnt(10)
    v_mfma_f32_32x32x16_bf16 v[32:47], v[104:107], a[36:39], v[32:47]
    ds_read_b64_tr_b16 v[96:97], v130
    ds_read_b64_tr_b16 v[98:99], v130 offset:1024
    s_waitcnt lgkmcnt(10)
    v_mfma_f32_32x32x16_bf16 v[48:63], v[108:111], a[36:39], v[48:63]
    s_mul_i32 s92, s24, 0x3800
    s_add_u32 s92, s92, s85
    s_add_u32 m0, s99, 0xa000
    s_add_u32 s92, s92, 0x3800
    buffer_load_dwordx4 v9, s[44:47], s92 offen lds
    ds_read_b64_tr_b16 v[100:101], v131
    ds_read_b64_tr_b16 v[102:103], v131 offset:1024
    s_waitcnt vmcnt(7) lgkmcnt(10)
    v_mfma_f32_32x32x16_bf16 v[32:47], v[112:115], a[40:43], v[32:47]
    s_mul_i32 s92, s24, 0x3800
    s_add_u32 s92, s92, s85
    s_add_u32 m0, s99, 0x4000
    s_add_u32 s92, s92, 0x7000
    buffer_load_dwordx4 v9, s[44:47], s92 offen lds
    ds_read_b64_tr_b16 v[104:105], v130 offset:8192
    ds_read_b64_tr_b16 v[106:107], v130 offset:9216
    s_waitcnt lgkmcnt(10)
    v_mfma_f32_32x32x16_bf16 v[48:63], v[116:119], a[40:43], v[48:63]
    s_mul_i32 s92, s24, 0x3800
    s_add_u32 s92, s92, s85
    s_add_u32 m0, s99, 0x6000
    s_add_u32 s92, s92, 0xa800
    buffer_load_dwordx4 v9, s[44:47], s92 offen lds
    ds_read_b64_tr_b16 v[108:109], v131 offset:8192
    ds_read_b64_tr_b16 v[110:111], v131 offset:9216
    s_waitcnt vmcnt(8) lgkmcnt(10)
    v_mfma_f32_32x32x16_bf16 v[32:47], v[120:123], a[44:47], v[32:47]
    s_waitcnt lgkmcnt(8)
    v_mfma_f32_32x32x16_bf16 v[48:63], v[124:127], a[44:47], v[48:63]
    s_cmp_lg_u32 s68, 0
    s_cbranch_scc1 L_pc_3023
    s_waitcnt vmcnt(4)
    v_cmp_le_u32 vcc, 1, v143
    s_nop 0
    s_and_b32 s93, vcc_lo, 0xaaaa
    s_cmp_eq_u32 s93, 0xaaaa
    s_cbranch_scc1 L_poll_3024_done
    s_mov_b32 s100, 0x186a0
L_poll_3024:
    s_sleep 2
    buffer_load_dword v143, v142, s[60:63], s14 offen sc1
    s_waitcnt vmcnt(0)
    v_cmp_le_u32 vcc, 1, v143
    s_nop 0
    s_and_b32 s93, vcc_lo, 0xaaaa
    s_cmp_eq_u32 s93, 0xaaaa
    s_cbranch_scc1 L_poll_3024_done
    s_sub_u32 s100, s100, 1
    s_cmp_lg_u32 s100, 0
    s_cbranch_scc1 L_poll_3024
L_poll_3024_done:
L_pc_3023:
    s_barrier
    ds_read_b64_tr_b16 v[112:113], v130 offset:16384
    ds_read_b64_tr_b16 v[114:115], v130 offset:17408
    ds_read_b64_tr_b16 v[116:117], v131 offset:16384
    ds_read_b64_tr_b16 v[118:119], v131 offset:17408
    s_waitcnt vmcnt(7) lgkmcnt(10)
    v_mfma_f32_32x32x16_bf16 v[32:47], v[96:99], a[48:51], v[32:47]
    s_lshl_b32 s92, s23, 10
    s_add_u32 s92, s92, s10
    buffer_load_dwordx4 a[64:67], v2, s[60:63], s92 offen sc1
    ds_read_b64_tr_b16 v[120:121], v130 offset:24576
    ds_read_b64_tr_b16 v[122:123], v130 offset:25600
    s_waitcnt lgkmcnt(10)
    v_mfma_f32_32x32x16_bf16 v[48:63], v[100:103], a[48:51], v[48:63]
    s_lshl_b32 s92, s23, 10
    s_add_u32 s92, s92, s10
    buffer_load_dwordx4 a[68:71], v2, s[60:63], s92 offen offset:1024 sc1
    s_lshl_b32 s92, s23, 10
    s_add_u32 s92, s92, s10
    buffer_load_dwordx4 a[72:75], v2, s[60:63], s92 offen offset:2048 sc1
    ds_read_b64_tr_b16 v[124:125], v131 offset:24576
    ds_read_b64_tr_b16 v[126:127], v131 offset:25600
    s_waitcnt vmcnt(9) lgkmcnt(10)
    v_mfma_f32_32x32x16_bf16 v[32:47], v[104:107], a[52:55], v[32:47]
    s_lshl_b32 s92, s23, 10
    s_add_u32 s92, s92, s10
    buffer_load_dwordx4 a[76:79], v2, s[60:63], s92 offen offset:3072 sc1
    s_lshl_b32 s92, s24, 10
    s_add_u32 s92, s92, s10
    buffer_load_dwordx4 a[80:83], v2, s[60:63], s92 offen sc1
    ds_read_b64_tr_b16 v[96:97], v128
    ds_read_b64_tr_b16 v[98:99], v128 offset:1024
    s_waitcnt lgkmcnt(10)
    v_mfma_f32_32x32x16_bf16 v[48:63], v[108:111], a[52:55], v[48:63]
    s_lshl_b32 s92, s24, 10
    s_add_u32 s92, s92, s10
    buffer_load_dwordx4 a[84:87], v2, s[60:63], s92 offen offset:1024 sc1
    ds_read_b64_tr_b16 v[100:101], v129
    ds_read_b64_tr_b16 v[102:103], v129 offset:1024
    s_waitcnt vmcnt(11) lgkmcnt(10)
    v_mfma_f32_32x32x16_bf16 v[32:47], v[112:115], a[56:59], v[32:47]
    s_lshl_b32 s92, s24, 10
    s_add_u32 s92, s92, s10
    buffer_load_dwordx4 a[88:91], v2, s[60:63], s92 offen offset:2048 sc1
    s_lshl_b32 s92, s24, 10
    s_add_u32 s92, s92, s10
    buffer_load_dwordx4 a[92:95], v2, s[60:63], s92 offen offset:3072 sc1
    ds_read_b64_tr_b16 v[104:105], v128 offset:8192
    ds_read_b64_tr_b16 v[106:107], v128 offset:9216
    s_waitcnt lgkmcnt(10)
    v_mfma_f32_32x32x16_bf16 v[48:63], v[116:119], a[56:59], v[48:63]
    s_mul_i32 s92, s25, 0x3800
    s_add_u32 m0, s99, 0x1a000
    s_add_u32 s92, s92, s85
    buffer_load_dwordx4 v9, s[44:47], s92 offen lds
    ds_read_b64_tr_b16 v[108:109], v129 offset:8192
    ds_read_b64_tr_b16 v[110:111], v129 offset:9216
    s_waitcnt vmcnt(13) lgkmcnt(10)
    v_mfma_f32_32x32x16_bf16 v[32:47], v[120:123], a[60:63], v[32:47]
    s_mul_i32 s92, s25, 0x3800
    s_add_u32 s92, s92, s85
    s_add_u32 m0, s99, 0x1c000
    s_add_u32 s92, s92, 0x3800
    buffer_load_dwordx4 v9, s[44:47], s92 offen lds
    s_mul_i32 s92, s25, 0x3800
    s_add_u32 s92, s92, s85
    s_add_u32 m0, s99, 0x1e000
    s_add_u32 s92, s92, 0x7000
    buffer_load_dwordx4 v9, s[44:47], s92 offen lds
    s_waitcnt lgkmcnt(8)
    v_mfma_f32_32x32x16_bf16 v[48:63], v[124:127], a[60:63], v[48:63]
    s_mul_i32 s92, s25, 0x3800
    s_add_u32 s92, s92, s85
    s_add_u32 m0, s99, 0x20000
    s_add_u32 s92, s92, 0xa800
    buffer_load_dwordx4 v9, s[44:47], s92 offen lds
    s_waitcnt vmcnt(14)
    s_barrier
    ds_read_b64_tr_b16 v[112:113], v130 offset:32768
    ds_read_b64_tr_b16 v[114:115], v130 offset:33792
    ds_read_b64_tr_b16 v[116:117], v131 offset:32768
    ds_read_b64_tr_b16 v[118:119], v131 offset:33792
    s_waitcnt vmcnt(11) lgkmcnt(10)
    v_mfma_f32_32x32x16_bf16 v[32:47], v[96:99], a[64:67], v[32:47]
    s_add_u32 s14, s13, 0x100
    s_cmp_lg_u32 s68, 0
    s_cbranch_scc1 L_pi_3025
    buffer_load_dword v143, v142, s[60:63], s14 offen sc1
L_pi_3025:
    ds_read_b64_tr_b16 v[120:121], v140 offset:24576
    ds_read_b64_tr_b16 v[122:123], v140 offset:25600
    s_waitcnt lgkmcnt(10)
    v_mfma_f32_32x32x16_bf16 v[48:63], v[100:103], a[64:67], v[48:63]
    s_mul_i32 s92, s26, 0x6200
    s_add_u32 m0, s99, 0x22000
    s_add_u32 s92, s92, s86
    buffer_load_dwordx4 v9, s[48:51], s92 offen lds
    ds_read_b64_tr_b16 v[124:125], v141 offset:24576
    ds_read_b64_tr_b16 v[126:127], v141 offset:25600
    s_waitcnt vmcnt(11) lgkmcnt(10)
    v_mfma_f32_32x32x16_bf16 v[32:47], v[104:107], a[68:71], v[32:47]
    ds_read_b64_tr_b16 v[96:97], v128 offset:32768
    ds_read_b64_tr_b16 v[98:99], v128 offset:33792
    s_waitcnt lgkmcnt(10)
    v_mfma_f32_32x32x16_bf16 v[48:63], v[108:111], a[68:71], v[48:63]
    s_mul_i32 s92, s26, 0x6200
    s_add_u32 s92, s92, s86
    s_add_u32 m0, s99, 0x24000
    s_add_u32 s92, s92, 0x3800
    buffer_load_dwordx4 v9, s[48:51], s92 offen lds
    ds_read_b64_tr_b16 v[100:101], v129 offset:32768
    ds_read_b64_tr_b16 v[102:103], v129 offset:33792
    s_waitcnt vmcnt(11) lgkmcnt(10)
    v_mfma_f32_32x32x16_bf16 v[32:47], v[112:115], a[72:75], v[32:47]
    s_mul_i32 s92, s26, 0x6200
    s_add_u32 s92, s92, s86
    s_add_u32 m0, s99, 0xc000
    s_add_u32 s92, s92, 0x6200
    buffer_load_dwordx4 v9, s[48:51], s92 offen lds
    ds_read_b64_tr_b16 v[104:105], v128 offset:40960
    ds_read_b64_tr_b16 v[106:107], v128 offset:41984
    s_waitcnt lgkmcnt(10)
    v_mfma_f32_32x32x16_bf16 v[48:63], v[116:119], a[72:75], v[48:63]
    s_mul_i32 s92, s26, 0x6200
    s_add_u32 s92, s92, s86
    s_add_u32 m0, s99, 0xe000
    s_add_u32 s92, s92, 0x9a00
    buffer_load_dwordx4 v9, s[48:51], s92 offen lds
    ds_read_b64_tr_b16 v[108:109], v129 offset:40960
    ds_read_b64_tr_b16 v[110:111], v129 offset:41984
    s_waitcnt vmcnt(12) lgkmcnt(10)
    v_mfma_f32_32x32x16_bf16 v[32:47], v[120:123], a[76:79], v[32:47]
    s_waitcnt lgkmcnt(8)
    v_mfma_f32_32x32x16_bf16 v[48:63], v[124:127], a[76:79], v[48:63]
    s_waitcnt vmcnt(6)
    s_cmp_lg_u32 s68, 0
    s_cbranch_scc1 L_pc_3026
    s_waitcnt vmcnt(4)
    v_cmp_le_u32 vcc, 1, v143
    s_nop 0
    s_and_b32 s93, vcc_lo, 0x5555
    s_cmp_eq_u32 s93, 0x5555
    s_cbranch_scc1 L_poll_3027_done
    s_mov_b32 s100, 0x186a0
L_poll_3027:
    s_sleep 2
    buffer_load_dword v143, v142, s[60:63], s14 offen sc1
    s_waitcnt vmcnt(0)
    v_cmp_le_u32 vcc, 1, v143
    s_nop 0
    s_and_b32 s93, vcc_lo, 0x5555
    s_cmp_eq_u32 s93, 0x5555
    s_cbranch_scc1 L_poll_3027_done
    s_sub_u32 s100, s100, 1
    s_cmp_lg_u32 s100, 0
    s_cbranch_scc1 L_poll_3027
L_poll_3027_done:
L_pc_3026:
    s_barrier
    ds_read_b64_tr_b16 v[112:113], v128 offset:16384
    ds_read_b64_tr_b16 v[114:115], v128 offset:17408
    ds_read_b64_tr_b16 v[116:117], v129 offset:16384
    ds_read_b64_tr_b16 v[118:119], v129 offset:17408
    s_waitcnt lgkmcnt(10)
    v_mfma_f32_32x32x16_bf16 v[32:47], v[96:99], a[80:83], v[32:47]
    s_add_u32 s14, s13, 0x180
    s_cmp_lg_u32 s68, 0
    s_cbranch_scc1 L_pi_3028
    buffer_load_dword v143, v142, s[60:63], s14 offen sc1
L_pi_3028:
    ds_read_b64_tr_b16 v[120:121], v128 offset:24576
    ds_read_b64_tr_b16 v[122:123], v128 offset:25600
    s_waitcnt lgkmcnt(10)
    v_mfma_f32_32x32x16_bf16 v[48:63], v[100:103], a[80:83], v[48:63]
    s_lshl_b32 s92, s25, 10
    s_add_u32 s92, s92, s10
    buffer_load_dwordx4 a[96:99], v2, s[60:63], s92 offen sc1
    s_lshl_b32 s92, s25, 10
    s_add_u32 s92, s92, s10
    buffer_load_dwordx4 a[100:103], v2, s[60:63], s92 offen offset:1024 sc1
    ds_read_b64_tr_b16 v[124:125], v129 offset:24576
    ds_read_b64_tr_b16 v[126:127], v129 offset:25600
    s_waitcnt lgkmcnt(10)
    v_mfma_f32_32x32x16_bf16 v[32:47], v[104:107], a[84:87], v[32:47]
    s_lshl_b32 s92, s25, 10
    s_add_u32 s92, s92, s10
    buffer_load_dwordx4 a[104:107], v2, s[60:63], s92 offen offset:2048 sc1
    ds_read_b64_tr_b16 v[96:97], v130 offset:40960
    ds_read_b64_tr_b16 v[98:99], v130 offset:41984
    s_waitcnt lgkmcnt(10)
    v_mfma_f32_32x32x16_bf16 v[48:63], v[108:111], a[84:87], v[48:63]
    s_lshl_b32 s92, s25, 10
    s_add_u32 s92, s92, s10
    buffer_load_dwordx4 a[108:111], v2, s[60:63], s92 offen offset:3072 sc1
    s_mul_i32 s92, s27, 0x6200
    s_add_u32 m0, s99, 0x10000
    s_add_u32 s92, s92, s86
    buffer_load_dwordx4 v9, s[48:51], s92 offen lds
    ds_read_b64_tr_b16 v[100:101], v131 offset:40960
    ds_read_b64_tr_b16 v[102:103], v131 offset:41984
    s_waitcnt lgkmcnt(10)
    v_mfma_f32_32x32x16_bf16 v[32:47], v[112:115], a[88:91], v[32:47]
    s_mul_i32 s92, s27, 0x6200
    s_add_u32 s92, s92, s86
    s_add_u32 m0, s99, 0x12000
    s_add_u32 s92, s92, 0x3800
    buffer_load_dwordx4 v9, s[48:51], s92 offen lds
    ds_read_b64_tr_b16 v[104:105], v130 offset:49152
    ds_read_b64_tr_b16 v[106:107], v130 offset:50176
    s_waitcnt lgkmcnt(10)
    v_mfma_f32_32x32x16_bf16 v[48:63], v[116:119], a[88:91], v[48:63]
    s_mul_i32 s92, s27, 0x6200
    s_add_u32 s92, s92, s86
    s_add_u32 m0, s99, 0x14000
    s_add_u32 s92, s92, 0x6200
    buffer_load_dwordx4 v9, s[48:51], s92 offen lds
    ds_read_b64_tr_b16 v[108:109], v131 offset:49152
    ds_read_b64_tr_b16 v[110:111], v131 offset:50176
    s_waitcnt lgkmcnt(10)
    v_mfma_f32_32x32x16_bf16 v[32:47], v[120:123], a[92:95], v[32:47]
    s_mul_i32 s92, s27, 0x6200
    s_add_u32 s92, s92, s86
    s_add_u32 m0, s99, 0x16000
    s_add_u32 s92, s92, 0x9a00
    buffer_load_dwordx4 v9, s[48:51], s92 offen lds
    s_waitcnt lgkmcnt(8)
    v_mfma_f32_32x32x16_bf16 v[48:63], v[124:127], a[92:95], v[48:63]
    v_lshrrev_b32 v20, 3, v1
    v_and_b32 v21, 7, v1
    v_xor_b32 v21, v21, v20
    s_lshl_b32 s93, s97, 6
    s_lshl_b32 s94, s68, 3
    s_add_u32 s93, s93, s94
    v_add_u32 v20, s93, v20
    v_mul_u32_u24 v20, 0x380, v20
    v_lshl_add_u32 v20, v21, 4, v20
    s_lshl_b32 s92, s98, 7
    s_add_u32 m0, s87, 0
    s_nop 0
    buffer_load_dwordx4 v20, s[28:31], s92 offen lds
    s_waitcnt vmcnt(11)
    s_cmp_lg_u32 s68, 0
    s_cbranch_scc1 L_pc_3029
    s_waitcnt vmcnt(9)
    v_cmp_le_u32 vcc, 1, v143
    s_nop 0
    s_and_b32 s93, vcc_lo, 0xaaaa
    s_cmp_eq_u32 s93, 0xaaaa
    s_cbranch_scc1 L_poll_3030_done
    s_mov_b32 s100, 0x186a0
L_poll_3030:
    s_sleep 2
    buffer_load_dword v143, v142, s[60:63], s14 offen sc1
    s_waitcnt vmcnt(0)
    v_cmp_le_u32 vcc, 1, v143
    s_nop 0
    s_and_b32 s93, vcc_lo, 0xaaaa
    s_cmp_eq_u32 s93, 0xaaaa
    s_cbranch_scc1 L_poll_3030_done
    s_sub_u32 s100, s100, 1
    s_cmp_lg_u32 s100, 0
    s_cbranch_scc1 L_poll_3030
L_poll_3030_done:
L_pc_3029:
    s_barrier
    ds_read_b64_tr_b16 v[112:113], v130 offset:57344
    ds_read_b64_tr_b16 v[114:115], v130 offset:58368
    ds_read_b64_tr_b16 v[116:117], v131 offset:57344
    ds_read_b64_tr_b16 v[118:119], v131 offset:58368
    s_waitcnt vmcnt(8) lgkmcnt(10)
    v_mfma_f32_32x32x16_bf16 v[32:47], v[96:99], a[96:99], v[32:47]
    v_and_b32 v20, 7, v1
    v_lshrrev_b32 v21, 5, v1
    v_xor_b32 v21, v21, v20
    v_lshlrev_b32 v21, 4, v21
    v_and_b32 v20, 31, v1
    v_lshl_add_u32 v21, v20, 8, v21
    s_mov_b32 s94, 0x8000
    s_cmp_eq_u32 s69, 1
    s_cselect_b32 s94, 0xa000, s94
    s_cmp_eq_u32 s69, 2
    s_cselect_b32 s94, 0x4000, s94
    s_cmp_eq_u32 s69, 3
    s_cselect_b32 s94, 0x6000, s94
    v_add_u32 v14, s94, v21
    ds_read_b64_tr_b16 v[120:121], v140
    ds_read_b64_tr_b16 v[122:123], v140 offset:1024
    s_waitcnt lgkmcnt(10)
    v_mfma_f32_32x32x16_bf16 v[48:63], v[100:103], a[96:99], v[48:63]
    s_lshl_b32 s92, s26, 11
    s_add_u32 s92, s92, s11
    buffer_load_dwordx4 a[0:3], v2, s[60:63], s92 offen sc1
    ds_read_b64_tr_b16 v[124:125], v141
    ds_read_b64_tr_b16 v[126:127], v141 offset:1024
    s_waitcnt vmcnt(8) lgkmcnt(10)
    v_mfma_f32_32x32x16_bf16 v[32:47], v[104:107], a[100:103], v[32:47]
    s_lshl_b32 s92, s26, 11
    s_add_u32 s92, s92, s11
    buffer_load_dwordx4 a[4:7], v2, s[60:63], s92 offen offset:1024 sc1
    ds_read_b64_tr_b16 v[96:97], v140 offset:8192
    ds_read_b64_tr_b16 v[98:99], v140 offset:9216
    s_waitcnt lgkmcnt(10)
    v_mfma_f32_32x32x16_bf16 v[48:63], v[108:111], a[100:103], v[48:63]
    s_lshl_b32 s92, s26, 11
    s_add_u32 s92, s92, s11
    buffer_load_dwordx4 a[8:11], v2, s[60:63], s92 offen offset:2048 sc1
    s_lshl_b32 s92, s26, 11
    s_add_u32 s92, s92, s11
    buffer_load_dwordx4 a[12:15], v2, s[60:63], s92 offen offset:3072 sc1
    ds_read_b64_tr_b16 v[100:101], v141 offset:8192
    ds_read_b64_tr_b16 v[102:103], v141 offset:9216
    s_waitcnt vmcnt(10) lgkmcnt(10)
    v_mfma_f32_32x32x16_bf16 v[32:47], v[112:115], a[104:107], v[32:47]
    s_lshl_b32 s92, s27, 11
    s_add_u32 s92, s92, s11
    buffer_load_dwordx4 a[16:19], v2, s[60:63], s92 offen sc1
    s_lshl_b32 s92, s27, 11
    s_add_u32 s92, s92, s11
    buffer_load_dwordx4 a[20:23], v2, s[60:63], s92 offen offset:1024 sc1
    ds_read_b64_tr_b16 v[104:105], v140 offset:16384
    ds_read_b64_tr_b16 v[106:107], v140 offset:17408
    s_waitcnt lgkmcnt(10)
    v_mfma_f32_32x32x16_bf16 v[48:63], v[116:119], a[104:107], v[48:63]
    s_lshl_b32 s92, s27, 11
    s_add_u32 s92, s92, s11
    buffer_load_dwordx4 a[24:27], v2, s[60:63], s92 offen offset:2048 sc1
    ds_read_b64_tr_b16 v[108:109], v141 offset:16384
    ds_read_b64_tr_b16 v[110:111], v141 offset:17408
    s_waitcnt vmcnt(12) lgkmcnt(10)
    v_mfma_f32_32x32x16_bf16 v[32:47], v[120:123], a[108:111], v[32:47]
    s_lshl_b32 s92, s27, 11
    s_add_u32 s92, s92, s11
    buffer_load_dwordx4 a[28:31], v2, s[60:63], s92 offen offset:3072 sc1
    s_waitcnt lgkmcnt(8)
    v_mfma_f32_32x32x16_bf16 v[48:63], v[124:127], a[108:111], v[48:63]
    v_lshrrev_b32 v20, 3, v1
    v_and_b32 v21, 7, v1
    v_lshlrev_b32 v21, 1, v21
    v_xor_b32 v21, v21, v20
    v_lshlrev_b32 v21, 4, v21
    s_lshl_b32 s93, s69, 3
    v_add_u32 v20, s93, v20
    v_lshl_add_u32 v16, v20, 8, v21
    v_xor_b32 v17, 16, v16
    s_waitcnt vmcnt(11)
    s_waitcnt vmcnt(8)
    s_barrier
    ds_read_b64_tr_b16 v[112:113], v128 offset:49152
    ds_read_b64_tr_b16 v[114:115], v128 offset:50176
    ds_read_b64_tr_b16 v[116:117], v129 offset:49152
    ds_read_b64_tr_b16 v[118:119], v129 offset:50176
    s_waitcnt vmcnt(7) lgkmcnt(10)
    v_mfma_f32_32x32x16_bf16 v[64:79], v[96:99], a[0:3], 0
    ds_read_b64_tr_b16 v[120:121], v128 offset:57344
    ds_read_b64_tr_b16 v[122:123], v128 offset:58368
    s_waitcnt lgkmcnt(10)
    v_mfma_f32_32x32x16_bf16 v[80:95], v[100:103], a[0:3], 0
    ds_write_b128 v14, v[32:35]
    v_xor_b32 v22, 32, v14
    ds_write_b128 v22, v[36:39]
    ds_read_b64_tr_b16 v[124:125], v129 offset:57344
    ds_read_b64_tr_b16 v[126:127], v129 offset:58368
    s_waitcnt vmcnt(6) lgkmcnt(12)
    v_mfma_f32_32x32x16_bf16 v[64:79], v[104:107], a[4:7], v[64:79]
    v_xor_b32 v23, 64, v14
    ds_write_b128 v23, v[40:43]
    v_xor_b32 v22, 0x60, v14
    ds_write_b128 v22, v[44:47]
    ds_read_b64_tr_b16 v[96:97], v130
    ds_read_b64_tr_b16 v[98:99], v130 offset:1024
    s_waitcnt lgkmcnt(14)
    v_mfma_f32_32x32x16_bf16 v[80:95], v[108:111], a[4:7], v[80:95]
    v_xor_b32 v23, 0x80, v14
    ds_write_b128 v23, v[48:51]
    ds_read_b64_tr_b16 v[100:101], v131
    ds_read_b64_tr_b16 v[102:103], v131 offset:1024
    s_waitcnt vmcnt(5) lgkmcnt(15)
    v_mfma_f32_32x32x16_bf16 v[64:79], v[112:115], a[8:11], v[64:79]
    v_xor_b32 v22, 0xa0, v14
    ds_write_b128 v22, v[52:55]
    v_xor_b32 v23, 0xc0, v14
    ds_write_b128 v23, v[56:59]
    ds_read_b64_tr_b16 v[104:105], v130 offset:8192
    ds_read_b64_tr_b16 v[106:107], v130 offset:9216
    s_waitcnt lgkmcnt(15)
    v_mfma_f32_32x32x16_bf16 v[80:95], v[116:119], a[8:11], v[80:95]
    v_xor_b32 v22, 0xe0, v14
    ds_write_b128 v22, v[60:63]
    ds_read_b64_tr_b16 v[108:109], v131 offset:8192
    ds_read_b64_tr_b16 v[110:111], v131 offset:9216
    s_waitcnt vmcnt(4) lgkmcnt(15)
    v_mfma_f32_32x32x16_bf16 v[64:79], v[120:123], a[12:15], v[64:79]
    v_lshrrev_b32 v20, 3, v1
    v_and_b32 v21, 7, v1
    v_xor_b32 v21, v21, v20
    v_lshlrev_b32 v21, 4, v21
    v_lshl_add_u32 v21, v20, 7, v21
    s_lshl_b32 s93, s69, 10
    s_add_u32 s93, s93, 0
    v_add_u32 v21, s93, v21
    ds_read_b128 v[24:27], v21
    s_waitcnt lgkmcnt(15)
    v_mfma_f32_32x32x16_bf16 v[80:95], v[124:127], a[12:15], v[80:95]
    s_waitcnt lgkmcnt(0)
    s_barrier
    ds_read_b64_tr_b16 v[112:113], v130 offset:16384
    ds_read_b64_tr_b16 v[114:115], v130 offset:17408
    ds_read_b64_tr_b16 v[116:117], v131 offset:16384
    ds_read_b64_tr_b16 v[118:119], v131 offset:17408
    s_waitcnt vmcnt(3)
    v_mfma_f32_32x32x16_bf16 v[64:79], v[96:99], a[16:19], v[64:79]
    v_add_u32 v20, 0x8000, v16
    ds_read_b128 v[32:35], v20
    v_add_u32 v21, 0x8000, v17
    ds_read_b128 v[36:39], v21
    v_add_u32 v20, 0xa000, v16
    ds_read_b128 v[40:43], v20
    v_add_u32 v21, 0xa000, v17
    ds_read_b128 v[44:47], v21
    v_add_u32 v20, 0x4000, v16
    ds_read_b128 v[48:51], v20
    v_add_u32 v21, 0x4000, v17
    ds_read_b128 v[52:55], v21
    v_add_u32 v20, 0x6000, v16
    ds_read_b128 v[56:59], v20
    v_add_u32 v21, 0x6000, v17
    ds_read_b128 v[60:63], v21
    ds_read_b64_tr_b16 v[120:121], v130 offset:24576
    ds_read_b64_tr_b16 v[122:123], v130 offset:25600
    v_mfma_f32_32x32x16_bf16 v[80:95], v[100:103], a[16:19], v[80:95]
    s_waitcnt lgkmcnt(7)
    v_add_f32 v32, v32, v40
    v_add_f32 v33, v33, v41
    v_add_f32 v34, v34, v42
    v_add_f32 v35, v35, v43
    s_waitcnt lgkmcnt(6)
    v_add_f32 v36, v36, v44
    v_add_f32 v37, v37, v45
    v_add_f32 v38, v38, v46
    v_add_f32 v39, v39, v47
    s_waitcnt lgkmcnt(3)
    v_add_f32 v48, v48, v56
    v_add_f32 v49, v49, v57
    v_add_f32 v50, v50, v58
    v_add_f32 v51, v51, v59
    ds_read_b64_tr_b16 v[124:125], v131 offset:24576
    ds_read_b64_tr_b16 v[126:127], v131 offset:25600
    s_waitcnt vmcnt(2)
    v_mfma_f32_32x32x16_bf16 v[64:79], v[104:107], a[20:23], v[64:79]
    s_waitcnt lgkmcnt(4)
    v_add_f32 v52, v52, v60
    v_add_f32 v53, v53, v61
    v_add_f32 v54, v54, v62
    v_add_f32 v55, v55, v63
    v_add_f32 v32, v32, v48
    v_add_f32 v33, v33, v49
    v_add_f32 v34, v34, v50
    v_add_f32 v35, v35, v51
    v_add_f32 v36, v36, v52
    v_add_f32 v37, v37, v53
    v_add_f32 v38, v38, v54
    v_add_f32 v39, v39, v55
    v_mul_f32 v40, s82, v32
    v_mul_f32 v41, s82, v33
    v_mfma_f32_32x32x16_bf16 v[80:95], v[108:111], a[20:23], v[80:95]
    v_mul_f32 v42, s82, v34
    v_mul_f32 v43, s82, v35
    v_mul_f32 v44, s82, v36
    v_mul_f32 v45, s82, v37
    v_mul_f32 v46, s82, v38
    v_mul_f32 v47, s82, v39
    v_exp_f32 v40, v40
    v_exp_f32 v41, v41
    v_exp_f32 v42, v42
    v_exp_f32 v43, v43
    s_waitcnt vmcnt(1)
    v_mfma_f32_32x32x16_bf16 v[64:79], v[112:115], a[24:27], v[64:79]
    v_exp_f32 v44, v44
    v_exp_f32 v45, v45
    v_exp_f32 v46, v46
    v_exp_f32 v47, v47
    v_fma_f32 v40, v40, s83, s83
    v_fma_f32 v41, v41, s83, s83
    v_fma_f32 v42, v42, s83, s83
    v_fma_f32 v43, v43, s83, s83
    v_fma_f32 v44, v44, s83, s83
    v_fma_f32 v45, v45, s83, s83
    v_mfma_f32_32x32x16_bf16 v[80:95], v[116:119], a[24:27], v[80:95]
    v_fma_f32 v46, v46, s83, s83
    v_fma_f32 v47, v47, s83, s83
    v_rcp_f32 v40, v40
    v_rcp_f32 v41, v41
    v_rcp_f32 v42, v42
    v_rcp_f32 v43, v43
    v_rcp_f32 v44, v44
    v_rcp_f32 v45, v45
    s_waitcnt vmcnt(0) lgkmcnt(2)
    v_mfma_f32_32x32x16_bf16 v[64:79], v[120:123], a[28:31], v[64:79]
    v_rcp_f32 v46, v46
    v_rcp_f32 v47, v47
    v_mul_f32 v32, v32, v40
    v_mul_f32 v33, v33, v41
    v_mul_f32 v34, v34, v42
    v_mul_f32 v35, v35, v43
    v_mul_f32 v36, v36, v44
    v_mul_f32 v37, v37, v45
    v_mul_f32 v38, v38, v46
    v_mul_f32 v39, v39, v47
    v_lshlrev_b32 v48, 16, v24
    v_and_b32 v49, s81, v24
    v_lshlrev_b32 v50, 16, v25
    s_waitcnt lgkmcnt(0)
    v_mfma_f32_32x32x16_bf16 v[80:95], v[124:127], a[28:31], v[80:95]
    v_and_b32 v51, s81, v25
    v_lshlrev_b32 v52, 16, v26
    v_and_b32 v53, s81, v26
    v_lshlrev_b32 v54, 16, v27
    v_and_b32 v55, s81, v27
    v_and_b32 v20, 7, v1
    v_lshrrev_b32 v21, 5, v1
    v_xor_b32 v21, v21, v20
    v_lshlrev_b32 v21, 4, v21
    v_and_b32 v20, 31, v1
    v_lshl_add_u32 v21, v20, 8, v21
    s_mov_b32 s94, 0
    s_cmp_eq_u32 s69, 1
    s_cselect_b32 s94, 0x2000, s94
    s_cmp_eq_u32 s69, 2
    s_cselect_b32 s94, 0x18000, s94
    s_cmp_eq_u32 s69, 3
    s_cselect_b32 s94, 0x26000, s94
    v_add_u32 v15, s94, v21
    ds_write_b128 v15, v[64:67]
    v_xor_b32 v22, 32, v15
    ds_write_b128 v22, v[68:71]
    v_xor_b32 v23, 64, v15
    ds_write_b128 v23, v[72:75]
    v_xor_b32 v22, 0x60, v15
    ds_write_b128 v22, v[76:79]
    v_xor_b32 v23, 0x80, v15
    ds_write_b128 v23, v[80:83]
    v_xor_b32 v22, 0xa0, v15
    ds_write_b128 v22, v[84:87]
    v_xor_b32 v23, 0xc0, v15
    ds_write_b128 v23, v[88:91]
    v_xor_b32 v22, 0xe0, v15
    ds_write_b128 v22, v[92:95]
    s_waitcnt lgkmcnt(0)
    s_barrier
    v_add_u32 v20, 0, v16
    ds_read_b128 v[96:99], v20
    v_add_u32 v21, 0, v17
    ds_read_b128 v[100:103], v21
    v_add_u32 v20, 0x2000, v16
    ds_read_b128 v[104:107], v20
    v_add_u32 v21, 0x2000, v17
    ds_read_b128 v[108:111], v21
    v_add_u32 v20, 0x18000, v16
    ds_read_b128 v[112:115], v20
    v_add_u32 v21, 0x18000, v17
    ds_read_b128 v[116:119], v21
    v_add_u32 v20, 0x26000, v16
    ds_read_b128 v[120:123], v20
    v_add_u32 v21, 0x26000, v17
    ds_read_b128 v[124:127], v21
    s_waitcnt lgkmcnt(5)
    v_add_f32 v96, v96, v104
    v_add_f32 v97, v97, v105
    v_add_f32 v98, v98, v106
    v_add_f32 v99, v99, v107
    s_waitcnt lgkmcnt(4)
    v_add_f32 v100, v100, v108
    v_add_f32 v101, v101, v109
    v_add_f32 v102, v102, v110
    v_add_f32 v103, v103, v111
    s_waitcnt lgkmcnt(1)
    v_add_f32 v112, v112, v120
    v_add_f32 v113, v113, v121
    v_add_f32 v114, v114, v122
    v_add_f32 v115, v115, v123
    s_waitcnt lgkmcnt(0)
    v_add_f32 v116, v116, v124
    v_add_f32 v117, v117, v125
    v_add_f32 v118, v118, v126
    v_add_f32 v119, v119, v127
    v_add_f32 v96, v96, v112
    v_add_f32 v97, v97, v113
    v_add_f32 v98, v98, v114
    v_add_f32 v99, v99, v115
    v_add_f32 v100, v100, v116
    v_add_f32 v101, v101, v117
    v_add_f32 v102, v102, v118
    v_add_f32 v103, v103, v119
    v_fma_f32 v96, v96, v32, v48
    v_fma_f32 v97, v97, v33, v49
    v_fma_f32 v98, v98, v34, v50
    v_fma_f32 v99, v99, v35, v51
    v_fma_f32 v100, v100, v36, v52
    v_fma_f32 v101, v101, v37, v53
    v_fma_f32 v102, v102, v38, v54
    v_fma_f32 v103, v103, v39, v55
    v_cvt_pk_bf16_f32 v64, v96, v97
    v_cvt_pk_bf16_f32 v65, v98, v99
    v_cvt_pk_bf16_f32 v66, v100, v101
    v_cvt_pk_bf16_f32 v67, v102, v103
    buffer_store_dwordx4 v[64:67], v8, s[56:59], 0 offen
L_fin_3013:
    s_endpgm
.p2align 3
L_PROG3:
    s_waitcnt vmcnt(3)
    v_dot2c_f32_bf16 v128, s84, v44
    v_dot2c_f32_bf16 v130, v44, v44
    s_waitcnt vmcnt(2)
    v_dot2c_f32_bf16 v129, s84, v72
    v_dot2c_f32_bf16 v131, v72, v72
    s_add_u32 m0, s87, 0xc000
    s_mul_i32 s92, s74, 0x2a000
    buffer_load_dwordx4 v9, s[32:35], s92 offen lds
    v_dot2c_f32_bf16 v128, s84, v45
    v_dot2c_f32_bf16 v130, v45, v45
    v_dot2c_f32_bf16 v129, s84, v73
    v_dot2c_f32_bf16 v131, v73, v73
    v_dot2c_f32_bf16 v128, s84, v46
    v_dot2c_f32_bf16 v130, v46, v46
    s_and_b32 s93, s68, 3
    s_lshl_b32 s27, s93, 10
    v_add_u32 v22, s27, v2
    s_mul_i32 s92, s72, 0xc40
    s_add_u32 m0, s27, 0x8000
    s_nop 0
    buffer_load_dwordx4 v22, s[52:55], s92 offen lds
    v_dot2c_f32_bf16 v129, s84, v74
    v_dot2c_f32_bf16 v131, v74, v74
    v_dot2c_f32_bf16 v128, s84, v47
    v_dot2c_f32_bf16 v130, v47, v47
    v_dot2c_f32_bf16 v129, s84, v75
    v_dot2c_f32_bf16 v131, v75, v75
    s_mul_i32 s93, s72, 0x1c0
    s_bitcmp1_b32 s72, 0
    s_cselect_b32 s88, 0xc0, 0
    s_add_u32 s89, s88, 0x80
    s_add_u32 s88, s88, s93
    s_add_u32 s89, s89, s93
    s_waitcnt vmcnt(3)
    v_dot2c_f32_bf16 v128, s84, v48
    v_dot2c_f32_bf16 v130, v48, v48
    s_waitcnt vmcnt(2)
    v_dot2c_f32_bf16 v129, s84, v76
    v_dot2c_f32_bf16 v131, v76, v76
    v_dot2c_f32_bf16 v128, s84, v49
    v_dot2c_f32_bf16 v130, v49, v49
    v_dot2c_f32_bf16 v129, s84, v77
    s_sub_u32 s93, s91, 0x920000
    s_lshl_b32 s93, s93, 2
    s_add_u32 s16, s93, 0x930000
    v_dot2c_f32_bf16 v131, v77, v77
    v_dot2c_f32_bf16 v128, s84, v50
    v_dot2c_f32_bf16 v130, v50, v50
    v_dot2c_f32_bf16 v129, s84, v78
    v_dot2c_f32_bf16 v131, v78, v78
    v_dot2c_f32_bf16 v128, s84, v51
    v_dot2c_f32_bf16 v130, v51, v51
    v_dot2c_f32_bf16 v129, s84, v79
    v_dot2c_f32_bf16 v131, v79, v79
    v_add_f32_dpp v128, v128, v128 quad_perm:[1,0,3,2] row_mask:0xf bank_mask:0xf
    v_add_f32_dpp v130, v130, v130 quad_perm:[1,0,3,2] row_mask:0xf bank_mask:0xf
    v_add_f32_dpp v129, v129, v129 quad_perm:[1,0,3,2] row_mask:0xf bank_mask:0xf
    v_add_f32_dpp v131, v131, v131 quad_perm:[1,0,3,2] row_mask:0xf bank_mask:0xf
    v_add_f32_dpp v128, v128, v128 quad_perm:[2,3,0,1] row_mask:0xf bank_mask:0xf
    v_add_f32_dpp v130, v130, v130 quad_perm:[2,3,0,1] row_mask:0xf bank_mask:0xf
    v_add_f32_dpp v129, v129, v129 quad_perm:[2,3,0,1] row_mask:0xf bank_mask:0xf
    v_add_f32_dpp v131, v131, v131 quad_perm:[2,3,0,1] row_mask:0xf bank_mask:0xf
    v_add_f32_dpp v128, v128, v128 row_half_mirror row_mask:0xf bank_mask:0xf
    v_add_f32_dpp v130, v130, v130 row_half_mirror row_mask:0xf bank_mask:0xf
    v_add_f32_dpp v129, v129, v129 row_half_mirror row_mask:0xf bank_mask:0xf
    v_add_f32_dpp v131, v131, v131 row_half_mirror row_mask:0xf bank_mask:0xf
    v_mul_f32 v128, 0xbb124925, v128
    v_mul_f32 v130, 0x3b124925, v130
    v_mul_f32 v129, 0xbb124925, v129
    v_mul_f32 v131, 0x3b124925, v131
    v_fma_f32 v130, -v128, v128, v130
    v_fma_f32 v131, -v129, v129, v131
    v_max_f32 v130, 0, v130
    v_max_f32 v131, 0, v131
    v_add_f32 v130, 0x3727c5ac, v130
    v_add_f32 v131, 0x3727c5ac, v131
    v_rsq_f32 v130, v130
    v_rsq_f32 v131, v131
    s_nop 0
    v_mul_f32 v130, 0xbfb8aa3b, v130
    v_mul_f32 v131, 0xbfb8aa3b, v131
    v_mul_f32 v128, v128, v130
    v_mul_f32 v129, v129, v131
    v_lshlrev_b32 v120, 16, v24
    v_and_b32 v121, s81, v24
    v_lshlrev_b32 v122, 16, v25
    v_and_b32 v123, s81, v25
    v_lshlrev_b32 v124, 16, v26
    v_and_b32 v125, s81, v26
    v_lshlrev_b32 v126, 16, v27
    v_and_b32 v127, s81, v27
    v_fma_f32 v120, v120, v130, v128
    v_fma_f32 v121, v121, v130, v128
    v_fma_f32 v122, v122, v130, v128
    v_fma_f32 v123, v123, v130, v128
    v_fma_f32 v124, v124, v130, v128
    v_fma_f32 v125, v125, v130, v128
    v_fma_f32 v126, v126, v130, v128
    v_fma_f32 v127, v127, v130, v128
    v_cvt_pk_bf16_f32 v24, v120, v121
    v_cvt_pk_bf16_f32 v25, v122, v123
    v_cvt_pk_bf16_f32 v26, v124, v125
    v_cvt_pk_bf16_f32 v27, v126, v127
    ds_write_b128 v3, v[24:27]
    v_lshlrev_b32 v120, 16, v52
    v_and_b32 v121, s81, v52
    v_lshlrev_b32 v122, 16, v53
    v_and_b32 v123, s81, v53
    v_lshlrev_b32 v124, 16, v54
    v_and_b32 v125, s81, v54
    v_lshlrev_b32 v126, 16, v55
    v_and_b32 v127, s81, v55
    v_fma_f32 v120, v120, v131, v129
    v_fma_f32 v121, v121, v131, v129
    v_fma_f32 v122, v122, v131, v129
    v_fma_f32 v123, v123, v131, v129
    v_fma_f32 v124, v124, v131, v129
    v_fma_f32 v125, v125, v131, v129
    v_fma_f32 v126, v126, v131, v129
    v_fma_f32 v127, v127, v131, v129
    v_cvt_pk_bf16_f32 v52, v120, v121
    v_cvt_pk_bf16_f32 v53, v122, v123
    v_cvt_pk_bf16_f32 v54, v124, v125
    v_cvt_pk_bf16_f32 v55, v126, v127
    ds_write_b128 v3, v[52:55] offset:128
    s_waitcnt lgkmcnt(0)
    s_barrier
    ds_read_b128 a[0:3], v4
    ds_read_b128 a[4:7], v5
    ds_read_b128 a[8:11], v6
    ds_read_b128 a[12:15], v7
    v_lshlrev_b32 v120, 16, v28
    v_and_b32 v121, s81, v28
    v_lshlrev_b32 v122, 16, v29
    v_and_b32 v123, s81, v29
    v_lshlrev_b32 v124, 16, v30
    v_and_b32 v125, s81, v30
    v_lshlrev_b32 v126, 16, v31
    v_and_b32 v127, s81, v31
    v_fma_f32 v120, v120, v130, v128
    v_fma_f32 v121, v121, v130, v128
    v_fma_f32 v122, v122, v130, v128
    v_fma_f32 v123, v123, v130, v128
    v_fma_f32 v124, v124, v130, v128
    v_fma_f32 v125, v125, v130, v128
    v_fma_f32 v126, v126, v130, v128
    v_fma_f32 v127, v127, v130, v128
    v_cvt_pk_bf16_f32 v28, v120, v121
    v_cvt_pk_bf16_f32 v29, v122, v123
    v_cvt_pk_bf16_f32 v30, v124, v125
    v_cvt_pk_bf16_f32 v31, v126, v127
    ds_write_b128 v3, v[28:31] offset:16384
    v_lshlrev_b32 v120, 16, v56
    s_add_u32 m0, s87, 0xe000
    s_mul_i32 s92, s75, 0x2a000
    buffer_load_dwordx4 v9, s[32:35], s92 offen lds
    v_and_b32 v121, s81, v56
    v_lshlrev_b32 v122, 16, v57
    v_and_b32 v123, s81, v57
    v_lshlrev_b32 v124, 16, v58
    v_and_b32 v125, s81, v58
    v_lshlrev_b32 v126, 16, v59
    v_and_b32 v127, s81, v59
    v_fma_f32 v120, v120, v131, v129
    v_fma_f32 v121, v121, v131, v129
    v_fma_f32 v122, v122, v131, v129
    v_fma_f32 v123, v123, v131, v129
    v_fma_f32 v124, v124, v131, v129
    v_fma_f32 v125, v125, v131, v129
    v_fma_f32 v126, v126, v131, v129
    v_fma_f32 v127, v127, v131, v129
    v_cvt_pk_bf16_f32 v56, v120, v121
    v_cvt_pk_bf16_f32 v57, v122, v123
    v_cvt_pk_bf16_f32 v58, v124, v125
    s_add_u32 m0, s87, 0x10000
    s_mul_i32 s92, s76, 0x2a000
    buffer_load_dwordx4 v9, s[32:35], s92 offen lds
    v_cvt_pk_bf16_f32 v59, v126, v127
    ds_write_b128 v3, v[56:59] offset:16512
    s_waitcnt vmcnt(2)
    s_waitcnt lgkmcnt(0)
    s_barrier
    ds_read_b64_tr_b16 v[132:133], v143
    ds_read_b64_tr_b16 v[134:135], v143 offset:448
    ds_read_b64_tr_b16 v[136:137], v143 offset:896
    ds_read_b64_tr_b16 v[138:139], v143 offset:1344
    v_add_u32 v22, 0xc000, v8
    ds_read_b64_tr_b16 v[112:113], v22
    ds_read_b64_tr_b16 v[114:115], v22 offset:512
    ds_read_b64_tr_b16 v[116:117], v22 offset:2048
    ds_read_b64_tr_b16 v[118:119], v22 offset:2560
    ds_read_b64_tr_b16 v[24:25], v22 offset:4096
    ds_read_b64_tr_b16 v[26:27], v22 offset:4608
    ds_read_b64_tr_b16 v[52:53], v22 offset:6144
    ds_read_b64_tr_b16 v[54:55], v22 offset:6656
    s_waitcnt lgkmcnt(6)
    v_mfma_f32_32x32x16_bf16 v[80:95], v[112:115], a[0:3], 0
    ds_read_b128 a[16:19], v4 offset:16384
    ds_read_b128 a[20:23], v5 offset:16384
    ds_read_b128 a[24:27], v6 offset:16384
    ds_read_b128 a[28:31], v7 offset:16384
    v_lshlrev_b32 v120, 16, v32
    v_and_b32 v121, s81, v32
    v_lshlrev_b32 v122, 16, v33
    v_and_b32 v123, s81, v33
    v_lshlrev_b32 v124, 16, v34
    v_and_b32 v125, s81, v34
    v_lshlrev_b32 v126, 16, v35
    v_and_b32 v127, s81, v35
    v_fma_f32 v120, v120, v130, v128
    v_fma_f32 v121, v121, v130, v128
    v_fma_f32 v122, v122, v130, v128
    s_waitcnt lgkmcnt(8)
    v_mfma_f32_32x32x16_bf16 v[80:95], v[116:119], a[4:7], v[80:95]
    v_fma_f32 v123, v123, v130, v128
    v_fma_f32 v124, v124, v130, v128
    v_fma_f32 v125, v125, v130, v128
    v_fma_f32 v126, v126, v130, v128
    v_fma_f32 v127, v127, v130, v128
    v_cvt_pk_bf16_f32 v32, v120, v121
    v_cvt_pk_bf16_f32 v33, v122, v123
    v_cvt_pk_bf16_f32 v34, v124, v125
    v_cvt_pk_bf16_f32 v35, v126, v127
    ds_write_b128 v3, v[32:35]
    s_add_u32 m0, s87, 0x12000
    s_mul_i32 s92, s77, 0x2a000
    buffer_load_dwordx4 v9, s[32:35], s92 offen lds
    v_lshlrev_b32 v120, 16, v60
    s_waitcnt lgkmcnt(7)
    v_mfma_f32_32x32x16_bf16 v[80:95], v[24:27], a[8:11], v[80:95]
    v_and_b32 v121, s81, v60
    v_lshlrev_b32 v122, 16, v61
    v_and_b32 v123, s81, v61
    v_lshlrev_b32 v124, 16, v62
    v_and_b32 v125, s81, v62
    v_lshlrev_b32 v126, 16, v63
    v_and_b32 v127, s81, v63
    v_fma_f32 v120, v120, v131, v129
    v_fma_f32 v121, v121, v131, v129
    v_fma_f32 v122, v122, v131, v129
    s_mul_i32 s92, s74, 0x38000
    s_add_u32 m0, s87, 0x1a000
    s_add_u32 s92, s92, s88
    buffer_load_dwordx4 v10, s[36:39], s92 offen lds
    v_fma_f32 v123, v123, v131, v129
    s_waitcnt lgkmcnt(5)
    v_mfma_f32_32x32x16_bf16 v[80:95], v[52:55], a[12:15], v[80:95]
    v_fma_f32 v124, v124, v131, v129
    v_fma_f32 v125, v125, v131, v129
    v_fma_f32 v126, v126, v131, v129
    v_fma_f32 v127, v127, v131, v129
    v_cvt_pk_bf16_f32 v60, v120, v121
    v_cvt_pk_bf16_f32 v61, v122, v123
    v_cvt_pk_bf16_f32 v62, v124, v125
    v_cvt_pk_bf16_f32 v63, v126, v127
    ds_write_b128 v3, v[60:63] offset:128
    s_mul_i32 s92, s74, 0x38000
    s_add_u32 m0, s87, 0x1c000
    s_add_u32 s92, s92, s88
    buffer_load_dwordx4 v11, s[40:43], s92 offen lds
    v_and_b32 v138, v16, v138
    v_and_b32 v139, v16, v139
    s_waitcnt vmcnt(4)
    s_waitcnt vmcnt(3)
    s_waitcnt lgkmcnt(0)
    s_barrier
    v_add_u32 v23, 0xe000, v8
    ds_read_b64_tr_b16 v[112:113], v23
    ds_read_b64_tr_b16 v[114:115], v23 offset:512
    ds_read_b64_tr_b16 v[116:117], v23 offset:2048
    ds_read_b64_tr_b16 v[118:119], v23 offset:2560
    ds_read_b64_tr_b16 v[24:25], v23 offset:4096
    ds_read_b64_tr_b16 v[26:27], v23 offset:4608
    ds_read_b64_tr_b16 v[52:53], v23 offset:6144
    ds_read_b64_tr_b16 v[54:55], v23 offset:6656
    s_waitcnt lgkmcnt(6)
    v_mfma_f32_32x32x16_bf16 v[80:95], v[112:115], a[16:19], v[80:95]
    ds_read_b128 a[32:35], v4
    ds_read_b128 a[36:39], v5
    ds_read_b128 a[40:43], v6
    ds_read_b128 a[44:47], v7
    v_lshlrev_b32 v120, 16, v36
    v_and_b32 v121, s81, v36
    v_lshlrev_b32 v122, 16, v37
    v_and_b32 v123, s81, v37
    v_lshlrev_b32 v124, 16, v38
    v_and_b32 v125, s81, v38
    v_lshlrev_b32 v126, 16, v39
    v_and_b32 v127, s81, v39
    v_fma_f32 v120, v120, v130, v128
    v_fma_f32 v121, v121, v130, v128
    v_add_u32 v22, 0x10000, v8
    ds_read_b64_tr_b16 v[112:113], v22
    ds_read_b64_tr_b16 v[114:115], v22 offset:512
    s_waitcnt lgkmcnt(10)
    v_mfma_f32_32x32x16_bf16 v[80:95], v[116:119], a[20:23], v[80:95]
    v_fma_f32 v122, v122, v130, v128
    v_fma_f32 v123, v123, v130, v128
    v_fma_f32 v124, v124, v130, v128
    v_fma_f32 v125, v125, v130, v128
    v_fma_f32 v126, v126, v130, v128
    v_fma_f32 v127, v127, v130, v128
    v_cvt_pk_bf16_f32 v36, v120, v121
    v_cvt_pk_bf16_f32 v37, v122, v123
    v_cvt_pk_bf16_f32 v38, v124, v125
    v_cvt_pk_bf16_f32 v39, v126, v127
    s_add_u32 m0, s87, 0x14000
    s_mul_i32 s92, s78, 0x2a000
    buffer_load_dwordx4 v9, s[32:35], s92 offen lds
    ds_write_b128 v3, v[36:39] offset:16384
    ds_read_b64_tr_b16 v[116:117], v22 offset:2048
    ds_read_b64_tr_b16 v[118:119], v22 offset:2560
    s_waitcnt lgkmcnt(11)
    v_mfma_f32_32x32x16_bf16 v[80:95], v[24:27], a[24:27], v[80:95]
    v_lshlrev_b32 v120, 16, v64
    v_and_b32 v121, s81, v64
    v_lshlrev_b32 v122, 16, v65
    v_and_b32 v123, s81, v65
    v_lshlrev_b32 v124, 16, v66
    v_and_b32 v125, s81, v66
    v_lshlrev_b32 v126, 16, v67
    v_and_b32 v127, s81, v67
    v_fma_f32 v120, v120, v131, v129
    s_mul_i32 s92, s75, 0x38000
    s_add_u32 m0, s87, 0x1e000
    s_add_u32 s92, s92, s88
    buffer_load_dwordx4 v10, s[36:39], s92 offen lds
    v_fma_f32 v121, v121, v131, v129
    v_fma_f32 v122, v122, v131, v129
    ds_read_b64_tr_b16 v[24:25], v22 offset:4096
    ds_read_b64_tr_b16 v[26:27], v22 offset:4608
    s_waitcnt lgkmcnt(11)
    v_mfma_f32_32x32x16_bf16 v[80:95], v[52:55], a[28:31], v[80:95]
    v_fma_f32 v123, v123, v131, v129
    v_fma_f32 v124, v124, v131, v129
    v_fma_f32 v125, v125, v131, v129
    v_fma_f32 v126, v126, v131, v129
    v_fma_f32 v127, v127, v131, v129
    v_cvt_pk_bf16_f32 v64, v120, v121
    v_cvt_pk_bf16_f32 v65, v122, v123
    v_cvt_pk_bf16_f32 v66, v124, v125
    s_mul_i32 s92, s75, 0x38000
    s_add_u32 m0, s87, 0x20000
    s_add_u32 s92, s92, s88
    buffer_load_dwordx4 v11, s[40:43], s92 offen lds
    v_cvt_pk_bf16_f32 v67, v126, v127
    ds_write_b128 v3, v[64:67] offset:16512
    s_waitcnt vmcnt(5)
    s_waitcnt lgkmcnt(0)
    s_barrier
    ds_read_b64_tr_b16 v[52:53], v22 offset:6144
    ds_read_b64_tr_b16 v[54:55], v22 offset:6656
    v_mfma_f32_32x32x16_bf16 v[80:95], v[112:115], a[32:35], v[80:95]
    ds_read_b128 a[48:51], v4 offset:16384
    ds_read_b128 a[52:55], v5 offset:16384
    ds_read_b128 a[56:59], v6 offset:16384
    ds_read_b128 a[60:63], v7 offset:16384
    v_lshlrev_b32 v120, 16, v40
    v_and_b32 v121, s81, v40
    v_lshlrev_b32 v122, 16, v41
    v_and_b32 v123, s81, v41
    v_lshlrev_b32 v124, 16, v42
    v_and_b32 v125, s81, v42
    v_lshlrev_b32 v126, 16, v43
    v_and_b32 v127, s81, v43
    v_fma_f32 v120, v120, v130, v128
    v_fma_f32 v121, v121, v130, v128
    v_add_u32 v23, 0x12000, v8
    ds_read_b64_tr_b16 v[112:113], v23
    ds_read_b64_tr_b16 v[114:115], v23 offset:512
    v_mfma_f32_32x32x16_bf16 v[80:95], v[116:119], a[36:39], v[80:95]
    v_fma_f32 v122, v122, v130, v128
    v_fma_f32 v123, v123, v130, v128
    v_fma_f32 v124, v124, v130, v128
    v_fma_f32 v125, v125, v130, v128
    v_fma_f32 v126, v126, v130, v128
    v_fma_f32 v127, v127, v130, v128
    v_cvt_pk_bf16_f32 v40, v120, v121
    v_cvt_pk_bf16_f32 v41, v122, v123
    v_cvt_pk_bf16_f32 v42, v124, v125
    v_cvt_pk_bf16_f32 v43, v126, v127
    s_add_u32 m0, s87, 0x16000
    s_mul_i32 s92, s79, 0x2a000
    buffer_load_dwordx4 v9, s[32:35], s92 offen lds
    ds_write_b128 v3, v[40:43]
    ds_read_b64_tr_b16 v[116:117], v23 offset:2048
    ds_read_b64_tr_b16 v[118:119], v23 offset:2560
    v_mfma_f32_32x32x16_bf16 v[80:95], v[24:27], a[40:43], v[80:95]
    v_lshlrev_b32 v120, 16, v68
    v_and_b32 v121, s81, v68
    v_lshlrev_b32 v122, 16, v69
    v_and_b32 v123, s81, v69
    v_lshlrev_b32 v124, 16, v70
    v_and_b32 v125, s81, v70
    v_lshlrev_b32 v126, 16, v71
    v_and_b32 v127, s81, v71
    v_fma_f32 v120, v120, v131, v129
    s_mul_i32 s92, s76, 0x38000
    s_add_u32 m0, s87, 0x22000
    s_add_u32 s92, s92, s88
    buffer_load_dwordx4 v10, s[36:39], s92 offen lds
    v_fma_f32 v121, v121, v131, v129
    v_fma_f32 v122, v122, v131, v129
    ds_read_b64_tr_b16 v[24:25], v23 offset:4096
    ds_read_b64_tr_b16 v[26:27], v23 offset:4608
    s_waitcnt lgkmcnt(11)
    v_mfma_f32_32x32x16_bf16 v[80:95], v[52:55], a[44:47], v[80:95]
    v_fma_f32 v123, v123, v131, v129
    v_fma_f32 v124, v124, v131, v129
    v_fma_f32 v125, v125, v131, v129
    v_fma_f32 v126, v126, v131, v129
    v_fma_f32 v127, v127, v131, v129
    v_cvt_pk_bf16_f32 v68, v120, v121
    v_cvt_pk_bf16_f32 v69, v122, v123
    v_cvt_pk_bf16_f32 v70, v124, v125
    s_mul_i32 s92, s76, 0x38000
    s_add_u32 m0, s87, 0x24000
    s_add_u32 s92, s92, s88
    buffer_load_dwordx4 v11, s[40:43], s92 offen lds
    v_cvt_pk_bf16_f32 v71, v126, v127
    ds_write_b128 v3, v[68:71] offset:128
    s_waitcnt vmcnt(5)
    s_waitcnt lgkmcnt(0)
    s_barrier
    ds_read_b64_tr_b16 v[52:53], v23 offset:6144
    ds_read_b64_tr_b16 v[54:55], v23 offset:6656
    v_mfma_f32_32x32x16_bf16 v[80:95], v[112:115], a[48:51], v[80:95]
    ds_read_b128 a[64:67], v4
    ds_read_b128 a[68:71], v5
    ds_read_b128 a[72:75], v6
    ds_read_b128 a[76:79], v7
    v_lshlrev_b32 v120, 16, v44
    v_and_b32 v121, s81, v44
    v_lshlrev_b32 v122, 16, v45
    v_and_b32 v123, s81, v45
    v_lshlrev_b32 v124, 16, v46
    v_and_b32 v125, s81, v46
    v_lshlrev_b32 v126, 16, v47
    v_and_b32 v127, s81, v47
    v_fma_f32 v120, v120, v130, v128
    v_fma_f32 v121, v121, v130, v128
    v_add_u32 v22, 0x14000, v8
    ds_read_b64_tr_b16 v[112:113], v22
    ds_read_b64_tr_b16 v[114:115], v22 offset:512
    v_mfma_f32_32x32x16_bf16 v[80:95], v[116:119], a[52:55], v[80:95]
    v_fma_f32 v122, v122, v130, v128
    v_fma_f32 v123, v123, v130, v128
    v_fma_f32 v124, v124, v130, v128
    v_fma_f32 v125, v125, v130, v128
    v_fma_f32 v126, v126, v130, v128
    v_fma_f32 v127, v127, v130, v128
    v_cvt_pk_bf16_f32 v44, v120, v121
    v_cvt_pk_bf16_f32 v45, v122, v123
    v_cvt_pk_bf16_f32 v46, v124, v125
    v_cvt_pk_bf16_f32 v47, v126, v127
    s_add_u32 m0, s87, 0x18000
    s_mul_i32 s92, s80, 0x2a000
    buffer_load_dwordx4 v9, s[32:35], s92 offen lds
    ds_write_b128 v3, v[44:47] offset:16384
    ds_read_b64_tr_b16 v[116:117], v22 offset:2048
    ds_read_b64_tr_b16 v[118:119], v22 offset:2560
    v_mfma_f32_32x32x16_bf16 v[80:95], v[24:27], a[56:59], v[80:95]
    v_lshlrev_b32 v120, 16, v72
    v_and_b32 v121, s81, v72
    v_lshlrev_b32 v122, 16, v73
    v_and_b32 v123, s81, v73
    v_lshlrev_b32 v124, 16, v74
    v_and_b32 v125, s81, v74
    v_lshlrev_b32 v126, 16, v75
    v_and_b32 v127, s81, v75
    v_fma_f32 v120, v120, v131, v129
    s_mul_i32 s92, s77, 0x38000
    s_add_u32 m0, s87, 0xc000
    s_add_u32 s92, s92, s88
    buffer_load_dwordx4 v10, s[36:39], s92 offen lds
    v_fma_f32 v121, v121, v131, v129
    v_fma_f32 v122, v122, v131, v129
    ds_read_b64_tr_b16 v[24:25], v22 offset:4096
    ds_read_b64_tr_b16 v[26:27], v22 offset:4608
    s_waitcnt lgkmcnt(11)
    v_mfma_f32_32x32x16_bf16 v[80:95], v[52:55], a[60:63], v[80:95]
    v_fma_f32 v123, v123, v131, v129
    v_fma_f32 v124, v124, v131, v129
    v_fma_f32 v125, v125, v131, v129
    v_fma_f32 v126, v126, v131, v129
    v_fma_f32 v127, v127, v131, v129
    v_cvt_pk_bf16_f32 v72, v120, v121
    v_cvt_pk_bf16_f32 v73, v122, v123
    v_cvt_pk_bf16_f32 v74, v124, v125
    s_mul_i32 s92, s77, 0x38000
    s_add_u32 m0, s87, 0xe000
    s_add_u32 s92, s92, s88
    buffer_load_dwordx4 v11, s[40:43], s92 offen lds
    v_cvt_pk_bf16_f32 v75, v126, v127
    ds_write_b128 v3, v[72:75] offset:16512
    s_waitcnt vmcnt(5)
    s_waitcnt lgkmcnt(0)
    s_barrier
    ds_read_b64_tr_b16 v[52:53], v22 offset:6144
    ds_read_b64_tr_b16 v[54:55], v22 offset:6656
    v_mfma_f32_32x32x16_bf16 v[80:95], v[112:115], a[64:67], v[80:95]
    ds_read_b128 a[80:83], v4 offset:16384
    ds_read_b128 a[84:87], v5 offset:16384
    ds_read_b128 a[88:91], v6 offset:16384
    ds_read_b128 a[92:95], v7 offset:16384
    v_lshlrev_b32 v120, 16, v48
    v_and_b32 v121, s81, v48
    v_lshlrev_b32 v122, 16, v49
    v_and_b32 v123, s81, v49
    v_lshlrev_b32 v124, 16, v50
    v_and_b32 v125, s81, v50
    v_lshlrev_b32 v126, 16, v51
    v_and_b32 v127, s81, v51
    v_add_u32 v23, 0x16000, v8
    ds_read_b64_tr_b16 v[112:113], v23
    ds_read_b64_tr_b16 v[114:115], v23 offset:512
    v_mfma_f32_32x32x16_bf16 v[80:95], v[116:119], a[68:71], v[80:95]
    v_fma_f32 v120, v120, v130, v128
    v_fma_f32 v121, v121, v130, v128
    v_fma_f32 v122, v122, v130, v128
    v_fma_f32 v123, v123, v130, v128
    v_fma_f32 v124, v124, v130, v128
    v_fma_f32 v125, v125, v130, v128
    v_fma_f32 v126, v126, v130, v128
    v_fma_f32 v127, v127, v130, v128
    v_cvt_pk_bf16_f32 v48, v120, v121
    v_cvt_pk_bf16_f32 v49, v122, v123
    v_cvt_pk_bf16_f32 v50, v124, v125
    ds_read_b64_tr_b16 v[116:117], v23 offset:2048
    ds_read_b64_tr_b16 v[118:119], v23 offset:2560
    v_mfma_f32_32x32x16_bf16 v[80:95], v[24:27], a[72:75], v[80:95]
    v_cvt_pk_bf16_f32 v51, v126, v127
    ds_write_b128 v3, v[48:51]
    v_lshlrev_b32 v120, 16, v76
    v_and_b32 v121, s81, v76
    v_lshlrev_b32 v122, 16, v77
    v_and_b32 v123, s81, v77
    v_lshlrev_b32 v124, 16, v78
    v_and_b32 v125, s81, v78
    v_lshlrev_b32 v126, 16, v79
    v_and_b32 v127, s81, v79
    v_fma_f32 v120, v120, v131, v129
    v_fma_f32 v121, v121, v131, v129
    ds_read_b64_tr_b16 v[24:25], v23 offset:4096
    ds_read_b64_tr_b16 v[26:27], v23 offset:4608
    s_waitcnt lgkmcnt(11)
    v_mfma_f32_32x32x16_bf16 v[80:95], v[52:55], a[76:79], v[80:95]
    v_fma_f32 v122, v122, v131, v129
    v_fma_f32 v123, v123, v131, v129
    v_fma_f32 v124, v124, v131, v129
    v_fma_f32 v125, v125, v131, v129
    v_fma_f32 v126, v126, v131, v129
    v_fma_f32 v127, v127, v131, v129
    v_cvt_pk_bf16_f32 v76, v120, v121
    v_cvt_pk_bf16_f32 v77, v122, v123
    v_cvt_pk_bf16_f32 v78, v124, v125
    v_cvt_pk_bf16_f32 v79, v126, v127
    ds_write_b128 v3, v[76:79] offset:128
    s_waitcnt vmcnt(2)
    s_waitcnt lgkmcnt(0)
    s_barrier
    ds_read_b64_tr_b16 v[52:53], v23 offset:6144
    ds_read_b64_tr_b16 v[54:55], v23 offset:6656
    v_mfma_f32_32x32x16_bf16 v[80:95], v[112:115], a[80:83], v[80:95]
    ds_read_b128 a[96:99], v4
    ds_read_b128 a[100:103], v5
    ds_read_b128 a[104:107], v6
    ds_read_b128 a[108:111], v7
    v_lshrrev_b32 v20, 3, v1
    v_bfe_u32 v21, v20, 1, 1
    v_add_u32 v22, 0x18000, v8
    ds_read_b64_tr_b16 v[112:113], v22
    ds_read_b64_tr_b16 v[114:115], v22 offset:512
    v_mfma_f32_32x32x16_bf16 v[80:95], v[116:119], a[84:87], v[80:95]
    v_lshlrev_b32 v21, 2, v21
    v_and_b32 v18, 7, v1
    v_xor_b32 v21, v21, v18
    v_lshlrev_b32 v141, 6, v1
    s_lshl_b32 s93, s70, 3
    v_add_u32 v20, s93, v20
    v_mul_u32_u24 v20, 0x380, v20
    v_lshl_add_u32 v20, v21, 4, v20
    ds_read_b64_tr_b16 v[116:117], v22 offset:2048
    ds_read_b64_tr_b16 v[118:119], v22 offset:2560
    v_mfma_f32_32x32x16_bf16 v[80:95], v[24:27], a[88:91], v[80:95]
    s_lshl_b32 s93, s98, 7
    s_mul_i32 s92, s78, 0x38000
    s_add_u32 m0, s87, 0x10000
    s_add_u32 s92, s92, s88
    buffer_load_dwordx4 v10, s[36:39], s92 offen lds
    v_add_u32 v9, s93, v20
    ds_read_b64_tr_b16 v[24:25], v22 offset:4096
    ds_read_b64_tr_b16 v[26:27], v22 offset:4608
    s_waitcnt lgkmcnt(10)
    v_mfma_f32_32x32x16_bf16 v[80:95], v[52:55], a[92:95], v[80:95]
    s_and_b32 s93, s97, 3
    s_add_u32 s93, s93, s98
    s_bitcmp1_b32 s93, 0
    s_cselect_b32 s8, 20, 0
    s_cselect_b32 s9, 0, 20
    s_cselect_b32 s24, 24, 4
    s_cselect_b32 s23, 4, 24
    s_bitcmp1_b32 s93, 1
    s_cselect_b32 s19, 16, 8
    s_cselect_b32 s22, 8, 16
    s_mov_b32 s25, 12
    s_and_b32 s94, s93, 1
    s_lshl_b32 s26, s94, 1
    s_xor_b32 s27, s26, 2
    s_mul_i32 s92, s78, 0x38000
    s_add_u32 m0, s87, 0x12000
    s_add_u32 s92, s92, s88
    buffer_load_dwordx4 v11, s[40:43], s92 offen lds
    s_waitcnt lgkmcnt(6)
    s_barrier
    ds_read_b64_tr_b16 v[52:53], v22 offset:6144
    ds_read_b64_tr_b16 v[54:55], v22 offset:6656
    s_waitcnt lgkmcnt(6)
    v_mfma_f32_32x32x16_bf16 v[80:95], v[112:115], a[96:99], v[80:95]
    s_waitcnt lgkmcnt(4)
    v_mfma_f32_32x32x16_bf16 v[80:95], v[116:119], a[100:103], v[80:95]
    s_mul_i32 s92, s79, 0x38000
    s_add_u32 m0, s87, 0x14000
    s_add_u32 s92, s92, s88
    buffer_load_dwordx4 v10, s[36:39], s92 offen lds
    s_waitcnt lgkmcnt(2)
    v_mfma_f32_32x32x16_bf16 v[80:95], v[24:27], a[104:107], v[80:95]
    s_mul_i32 s92, s79, 0x38000
    s_add_u32 m0, s87, 0x16000
    s_add_u32 s92, s92, s88
    buffer_load_dwordx4 v11, s[40:43], s92 offen lds
    s_mul_i32 s92, s80, 0x38000
    s_add_u32 m0, s87, 0x4000
    s_add_u32 s92, s92, s88
    buffer_load_dwordx4 v10, s[36:39], s92 offen lds
    s_waitcnt lgkmcnt(0)
    v_mfma_f32_32x32x16_bf16 v[80:95], v[52:55], a[108:111], v[80:95]
    s_mul_i32 s92, s80, 0x38000
    s_add_u32 m0, s87, 0x6000
    s_add_u32 s92, s92, s88
    buffer_load_dwordx4 v11, s[40:43], s92 offen lds
    s_barrier
    v_add_u32 v4, 0x1a000, v12
    ds_read_b64_tr_b16 v[56:57], v4
    ds_read_b64_tr_b16 v[58:59], v4 offset:512
    v_add_u32 v6, 0x1a000, v13
    ds_read_b64_tr_b16 v[60:61], v6
    ds_read_b64_tr_b16 v[62:63], v6 offset:512
    ds_read_b64_tr_b16 v[64:65], v4 offset:2048
    ds_read_b64_tr_b16 v[66:67], v4 offset:2560
    ds_read_b64_tr_b16 v[68:69], v6 offset:2048
    ds_read_b64_tr_b16 v[70:71], v6 offset:2560
    s_waitcnt lgkmcnt(6)
    v_mfma_f32_32x32x16_bf16 v[24:39], v[56:59], a[0:3], 0
    v_cvt_pk_bf16_f32 v72, v80, v81
    v_cvt_pk_bf16_f32 v73, v82, v83
    v_cvt_pk_bf16_f32 v74, v84, v85
    v_cvt_pk_bf16_f32 v75, v86, v87
    v_cvt_pk_bf16_f32 v76, v88, v89
    ds_read_b64_tr_b16 v[56:57], v4 offset:4096
    ds_read_b64_tr_b16 v[58:59], v4 offset:4608
    s_waitcnt lgkmcnt(6)
    v_mfma_f32_32x32x16_bf16 v[40:55], v[60:63], a[0:3], 0
    v_cvt_pk_bf16_f32 v77, v90, v91
    v_cvt_pk_bf16_f32 v78, v92, v93
    v_cvt_pk_bf16_f32 v79, v94, v95
    v_mfma_f32_32x32x16_bf16 v[112:127], v[132:135], v[72:75], 0
    ds_read_b64_tr_b16 v[60:61], v6 offset:4096
    ds_read_b64_tr_b16 v[62:63], v6 offset:4608
    s_waitcnt lgkmcnt(6)
    v_mfma_f32_32x32x16_bf16 v[24:39], v[64:67], a[4:7], v[24:39]
    v_mfma_f32_32x32x16_bf16 v[112:127], v[136:139], v[76:79], v[112:127]
    ds_read_b64_tr_b16 v[64:65], v4 offset:6144
    ds_read_b64_tr_b16 v[66:67], v4 offset:6656
    s_waitcnt lgkmcnt(6)
    v_mfma_f32_32x32x16_bf16 v[40:55], v[68:71], a[4:7], v[40:55]
    ds_read_b64_tr_b16 v[68:69], v6 offset:6144
    ds_read_b64_tr_b16 v[70:71], v6 offset:6656
    s_waitcnt lgkmcnt(6)
    v_mfma_f32_32x32x16_bf16 v[24:39], v[56:59], a[8:11], v[24:39]
    s_mul_i32 s92, s80, 0x38000
    s_mov_b32 m0, s87
    s_add_u32 s92, s92, s89
    buffer_load_dwordx4 v10, s[36:39], s92 offen lds
    v_add_u32 v5, 0x1e000, v12
    ds_read_b64_tr_b16 v[56:57], v5
    ds_read_b64_tr_b16 v[58:59], v5 offset:512
    s_waitcnt lgkmcnt(6)
    v_mfma_f32_32x32x16_bf16 v[40:55], v[60:63], a[8:11], v[40:55]
    v_max3_f32 v128, v112, v113, v114
    v_min3_f32 v129, v112, v113, v114
    v_max3_f32 v128, v128, v115, v116
    v_min3_f32 v129, v129, v115, v116
    v_add_u32 v7, 0x1e000, v13
    ds_read_b64_tr_b16 v[60:61], v7
    ds_read_b64_tr_b16 v[62:63], v7 offset:512
    s_waitcnt lgkmcnt(6)
    v_mfma_f32_32x32x16_bf16 v[24:39], v[64:67], a[12:15], v[24:39]
    v_max3_f32 v128, v128, v117, v118
    v_min3_f32 v129, v129, v117, v118
    v_max3_f32 v128, v128, v119, v120
    v_min3_f32 v129, v129, v119, v120
    v_max3_f32 v128, v128, v121, v122
    ds_read_b64_tr_b16 v[64:65], v5 offset:2048
    ds_read_b64_tr_b16 v[66:67], v5 offset:2560
    s_waitcnt lgkmcnt(6)
    v_mfma_f32_32x32x16_bf16 v[40:55], v[68:71], a[12:15], v[40:55]
    s_mul_i32 s92, s80, 0x38000
    s_add_u32 m0, s87, 0x2000
    s_add_u32 s92, s92, s89
    buffer_load_dwordx4 v11, s[40:43], s92 offen lds
    v_min3_f32 v129, v129, v121, v122
    v_max3_f32 v128, v128, v123, v124
    s_barrier
    ds_read_b64_tr_b16 v[68:69], v7 offset:2048
    ds_read_b64_tr_b16 v[70:71], v7 offset:2560
    s_waitcnt lgkmcnt(6)
    v_mfma_f32_32x32x16_bf16 v[24:39], v[56:59], a[16:19], v[24:39]
    v_min3_f32 v129, v129, v123, v124
    v_max3_f32 v128, v128, v125, v126
    v_min3_f32 v129, v129, v125, v126
    v_max_f32 v128, v128, v127
    v_min_f32 v129, v129, v127
    ds_read_b64_tr_b16 v[56:57], v5 offset:4096
    ds_read_b64_tr_b16 v[58:59], v5 offset:4608
    s_waitcnt lgkmcnt(6)
    v_mfma_f32_32x32x16_bf16 v[40:55], v[60:63], a[16:19], v[40:55]
    v_mov_b32 v130, v128
    v_mov_b32 v131, v129
    s_nop 0
    v_permlane32_swap_b32 v128, v130
    v_permlane32_swap_b32 v129, v131
    v_max_f32 v128, v128, v130
    ds_read_b64_tr_b16 v[60:61], v7 offset:4096
    ds_read_b64_tr_b16 v[62:63], v7 offset:4608
    s_waitcnt lgkmcnt(6)
    v_mfma_f32_32x32x16_bf16 v[24:39], v[64:67], a[20:23], v[24:39]
    v_min_f32 v129, v129, v131
    v_sub_f32 v80, v129, v112
    v_sub_f32 v112, v112, v128
    v_sub_f32 v81, v129, v113
    v_sub_f32 v113, v113, v128
    ds_read_b64_tr_b16 v[64:65], v5 offset:6144
    ds_read_b64_tr_b16 v[66:67], v5 offset:6656
    s_waitcnt lgkmcnt(6)
    v_mfma_f32_32x32x16_bf16 v[40:55], v[68:71], a[20:23], v[40:55]
    v_sub_f32 v82, v129, v114
    v_sub_f32 v114, v114, v128
    v_sub_f32 v83, v129, v115
    s_mul_i32 s92, s74, 0x38000
    s_add_u32 m0, s87, 0x1a000
    s_add_u32 s92, s92, s89
    buffer_load_dwordx4 v10, s[36:39], s92 offen lds
    ds_read_b64_tr_b16 v[68:69], v7 offset:6144
    ds_read_b64_tr_b16 v[70:71], v7 offset:6656
    s_waitcnt lgkmcnt(6)
    v_mfma_f32_32x32x16_bf16 v[24:39], v[56:59], a[24:27], v[24:39]
    v_sub_f32 v115, v115, v128
    v_exp_f32 v80, v80
    v_add_u32 v4, 0x22000, v12
    ds_read_b64_tr_b16 v[56:57], v4
    ds_read_b64_tr_b16 v[58:59], v4 offset:512
    s_waitcnt lgkmcnt(6)
    v_mfma_f32_32x32x16_bf16 v[40:55], v[60:63], a[24:27], v[40:55]
    v_exp_f32 v112, v112
    v_exp_f32 v81, v81
    v_exp_f32 v113, v113
    v_add_u32 v6, 0x22000, v13
    ds_read_b64_tr_b16 v[60:61], v6
    ds_read_b64_tr_b16 v[62:63], v6 offset:512
    s_waitcnt lgkmcnt(6)
    v_mfma_f32_32x32x16_bf16 v[24:39], v[64:67], a[28:31], v[24:39]
    v_exp_f32 v82, v82
    v_exp_f32 v114, v114
    ds_read_b64_tr_b16 v[64:65], v4 offset:2048
    ds_read_b64_tr_b16 v[66:67], v4 offset:2560
    s_waitcnt lgkmcnt(6)
    v_mfma_f32_32x32x16_bf16 v[40:55], v[68:71], a[28:31], v[40:55]
    v_exp_f32 v83, v83
    s_mul_i32 s92, s74, 0x38000
    s_add_u32 m0, s87, 0x1c000
    s_add_u32 s92, s92, s89
    buffer_load_dwordx4 v11, s[40:43], s92 offen lds
    s_waitcnt vmcnt(10)
    s_barrier
    ds_read_b64_tr_b16 v[68:69], v6 offset:2048
    ds_read_b64_tr_b16 v[70:71], v6 offset:2560
    s_waitcnt lgkmcnt(6)
    v_mfma_f32_32x32x16_bf16 v[24:39], v[56:59], a[32:35], v[24:39]
    v_exp_f32 v115, v115
    v_sub_f32 v84, v129, v116
    v_sub_f32 v116, v116, v128
    v_sub_f32 v85, v129, v117
    v_sub_f32 v117, v117, v128
    ds_read_b64_tr_b16 v[56:57], v4 offset:4096
    ds_read_b64_tr_b16 v[58:59], v4 offset:4608
    s_waitcnt lgkmcnt(6)
    v_mfma_f32_32x32x16_bf16 v[40:55], v[60:63], a[32:35], v[40:55]
    v_sub_f32 v86, v129, v118
    v_sub_f32 v118, v118, v128
    v_sub_f32 v87, v129, v119
    v_sub_f32 v119, v119, v128
    v_exp_f32 v84, v84
    ds_read_b64_tr_b16 v[60:61], v6 offset:4096
    ds_read_b64_tr_b16 v[62:63], v6 offset:4608
    s_waitcnt lgkmcnt(6)
    v_mfma_f32_32x32x16_bf16 v[24:39], v[64:67], a[36:39], v[24:39]
    v_exp_f32 v116, v116
    v_exp_f32 v85, v85
    ds_read_b64_tr_b16 v[64:65], v4 offset:6144
    ds_read_b64_tr_b16 v[66:67], v4 offset:6656
    s_waitcnt lgkmcnt(6)
    v_mfma_f32_32x32x16_bf16 v[40:55], v[68:71], a[36:39], v[40:55]
    v_exp_f32 v117, v117
    s_mul_i32 s92, s75, 0x38000
    s_add_u32 m0, s87, 0x1e000
    s_add_u32 s92, s92, s89
    buffer_load_dwordx4 v10, s[36:39], s92 offen lds
    ds_read_b64_tr_b16 v[68:69], v6 offset:6144
    ds_read_b64_tr_b16 v[70:71], v6 offset:6656
    s_waitcnt lgkmcnt(6)
    v_mfma_f32_32x32x16_bf16 v[24:39], v[56:59], a[40:43], v[24:39]
    v_exp_f32 v86, v86
    v_exp_f32 v118, v118
    v_exp_f32 v87, v87
    v_add_u32 v5, 0xc000, v12
    ds_read_b64_tr_b16 v[56:57], v5
    ds_read_b64_tr_b16 v[58:59], v5 offset:512
    s_waitcnt lgkmcnt(6)
    v_mfma_f32_32x32x16_bf16 v[40:55], v[60:63], a[40:43], v[40:55]
    v_exp_f32 v119, v119
    s_mul_i32 s92, s75, 0x38000
    s_add_u32 m0, s87, 0x20000
    s_add_u32 s92, s92, s89
    buffer_load_dwordx4 v11, s[40:43], s92 offen lds
    v_add_u32 v7, 0xc000, v13
    ds_read_b64_tr_b16 v[60:61], v7
    ds_read_b64_tr_b16 v[62:63], v7 offset:512
    s_waitcnt lgkmcnt(6)
    v_mfma_f32_32x32x16_bf16 v[24:39], v[64:67], a[44:47], v[24:39]
    v_sub_f32 v88, v129, v120
    v_sub_f32 v120, v120, v128
    v_sub_f32 v89, v129, v121
    v_sub_f32 v121, v121, v128
    v_sub_f32 v90, v129, v122
    v_sub_f32 v122, v122, v128
    ds_read_b64_tr_b16 v[64:65], v5 offset:2048
    ds_read_b64_tr_b16 v[66:67], v5 offset:2560
    s_waitcnt lgkmcnt(6)
    v_mfma_f32_32x32x16_bf16 v[40:55], v[68:71], a[44:47], v[40:55]
    s_mul_i32 s92, s8, 0x3800
    s_add_u32 m0, s99, 0x8000
    s_add_u32 s92, s92, s85
    buffer_load_dwordx4 v9, s[44:47], s92 offen lds
    v_sub_f32 v91, v129, v123
    v_sub_f32 v123, v123, v128
    s_waitcnt vmcnt(11)
    s_barrier
    ds_read_b64_tr_b16 v[68:69], v7 offset:2048
    ds_read_b64_tr_b16 v[70:71], v7 offset:2560
    s_waitcnt lgkmcnt(6)
    v_mfma_f32_32x32x16_bf16 v[24:39], v[56:59], a[48:51], v[24:39]
    v_exp_f32 v88, v88
    v_exp_f32 v120, v120
    v_exp_f32 v89, v89
    ds_read_b64_tr_b16 v[56:57], v5 offset:4096
    ds_read_b64_tr_b16 v[58:59], v5 offset:4608
    s_waitcnt lgkmcnt(6)
    v_mfma_f32_32x32x16_bf16 v[40:55], v[60:63], a[48:51], v[40:55]
    v_exp_f32 v121, v121
    v_exp_f32 v90, v90
    v_exp_f32 v122, v122
    ds_read_b64_tr_b16 v[60:61], v7 offset:4096
    ds_read_b64_tr_b16 v[62:63], v7 offset:4608
    s_waitcnt lgkmcnt(6)
    v_mfma_f32_32x32x16_bf16 v[24:39], v[64:67], a[52:55], v[24:39]
    v_exp_f32 v91, v91
    v_exp_f32 v123, v123
    v_sub_f32 v92, v129, v124
    ds_read_b64_tr_b16 v[64:65], v5 offset:6144
    ds_read_b64_tr_b16 v[66:67], v5 offset:6656
    s_waitcnt lgkmcnt(6)
    v_mfma_f32_32x32x16_bf16 v[40:55], v[68:71], a[52:55], v[40:55]
    v_sub_f32 v124, v124, v128
    s_mul_i32 s92, s76, 0x38000
    s_add_u32 m0, s87, 0x22000
    s_add_u32 s92, s92, s89
    buffer_load_dwordx4 v10, s[36:39], s92 offen lds
    v_sub_f32 v93, v129, v125
    ds_read_b64_tr_b16 v[68:69], v7 offset:6144
    ds_read_b64_tr_b16 v[70:71], v7 offset:6656
    s_waitcnt lgkmcnt(6)
    v_mfma_f32_32x32x16_bf16 v[24:39], v[56:59], a[56:59], v[24:39]
    v_sub_f32 v125, v125, v128
    v_sub_f32 v94, v129, v126
    v_sub_f32 v126, v126, v128
    v_sub_f32 v95, v129, v127
    v_sub_f32 v127, v127, v128
    v_add_u32 v4, 0x10000, v12
    ds_read_b64_tr_b16 v[56:57], v4
    ds_read_b64_tr_b16 v[58:59], v4 offset:512
    s_waitcnt lgkmcnt(6)
    v_mfma_f32_32x32x16_bf16 v[40:55], v[60:63], a[56:59], v[40:55]
    v_exp_f32 v92, v92
    s_mul_i32 s92, s76, 0x38000
    s_add_u32 m0, s87, 0x24000
    s_add_u32 s92, s92, s89
    buffer_load_dwordx4 v11, s[40:43], s92 offen lds
    v_add_u32 v6, 0x10000, v13
    ds_read_b64_tr_b16 v[60:61], v6
    ds_read_b64_tr_b16 v[62:63], v6 offset:512
    s_waitcnt lgkmcnt(6)
    v_mfma_f32_32x32x16_bf16 v[24:39], v[64:67], a[60:63], v[24:39]
    v_exp_f32 v124, v124
    v_exp_f32 v93, v93
    v_exp_f32 v125, v125
    ds_read_b64_tr_b16 v[64:65], v4 offset:2048
    ds_read_b64_tr_b16 v[66:67], v4 offset:2560
    s_waitcnt lgkmcnt(6)
    v_mfma_f32_32x32x16_bf16 v[40:55], v[68:71], a[60:63], v[40:55]
    s_mul_i32 s92, s8, 0x3800
    s_add_u32 s92, s92, s85
    s_add_u32 m0, s99, 0xa000
    s_add_u32 s92, s92, 0x3800
    buffer_load_dwordx4 v9, s[44:47], s92 offen lds
    v_exp_f32 v94, v94
    s_waitcnt vmcnt(12)
    s_barrier
    ds_read_b64_tr_b16 v[68:69], v6 offset:2048
    ds_read_b64_tr_b16 v[70:71], v6 offset:2560
    s_waitcnt lgkmcnt(6)
    v_mfma_f32_32x32x16_bf16 v[24:39], v[56:59], a[64:67], v[24:39]
    v_exp_f32 v126, v126
    v_exp_f32 v95, v95
    v_exp_f32 v127, v127
    v_add_f32 v140, v92, v93
    ds_read_b64_tr_b16 v[56:57], v4 offset:4096
    ds_read_b64_tr_b16 v[58:59], v4 offset:4608
    s_waitcnt lgkmcnt(6)
    v_mfma_f32_32x32x16_bf16 v[40:55], v[60:63], a[64:67], v[40:55]
    v_add_f32 v141, v124, v125
    v_add_f32 v130, v94, v95
    v_add_f32 v131, v126, v127
    v_add_f32 v140, v140, v130
    v_add_f32 v141, v141, v131
    v_add_f32 v130, v81, v82
    v_add_f32 v131, v113, v114
    ds_read_b64_tr_b16 v[60:61], v6 offset:4096
    ds_read_b64_tr_b16 v[62:63], v6 offset:4608
    s_waitcnt lgkmcnt(6)
    v_mfma_f32_32x32x16_bf16 v[24:39], v[64:67], a[68:71], v[24:39]
    v_fma_f32 v140, v140, v17, v80
    v_fma_f32 v141, v141, v17, v112
    v_add_f32 v130, v130, v84
    v_add_f32 v131, v131, v116
    s_mul_i32 s92, s77, 0x38000
    s_add_u32 m0, s87, 0xc000
    s_add_u32 s92, s92, s89
    buffer_load_dwordx4 v10, s[36:39], s92 offen lds
    ds_read_b64_tr_b16 v[64:65], v4 offset:6144
    ds_read_b64_tr_b16 v[66:67], v4 offset:6656
    s_waitcnt lgkmcnt(6)
    v_mfma_f32_32x32x16_bf16 v[40:55], v[68:71], a[68:71], v[40:55]
    v_add_f32 v140, v140, v83
    v_add_f32 v141, v141, v115
    v_add_f32 v130, v130, v86
    v_add_f32 v131, v131, v118
    v_add_f32 v140, v140, v85
    ds_read_b64_tr_b16 v[68:69], v6 offset:6144
    ds_read_b64_tr_b16 v[70:71], v6 offset:6656
    s_waitcnt lgkmcnt(6)
    v_mfma_f32_32x32x16_bf16 v[24:39], v[56:59], a[72:75], v[24:39]
    v_add_f32 v141, v141, v117
    v_add_f32 v130, v130, v88
    s_mul_i32 s92, s77, 0x38000
    s_add_u32 m0, s87, 0xe000
    s_add_u32 s92, s92, s89
    buffer_load_dwordx4 v11, s[40:43], s92 offen lds
    v_add_f32 v131, v131, v120
    v_add_u32 v5, 0x14000, v12
    ds_read_b64_tr_b16 v[56:57], v5
    ds_read_b64_tr_b16 v[58:59], v5 offset:512
    s_waitcnt lgkmcnt(6)
    v_mfma_f32_32x32x16_bf16 v[40:55], v[60:63], a[72:75], v[40:55]
    v_add_f32 v140, v140, v87
    v_add_f32 v141, v141, v119
    v_add_f32 v130, v130, v90
    v_add_f32 v131, v131, v122
    v_add_f32 v140, v140, v89
    v_add_f32 v141, v141, v121
    v_add_u32 v7, 0x14000, v13
    ds_read_b64_tr_b16 v[60:61], v7
    ds_read_b64_tr_b16 v[62:63], v7 offset:512
    s_waitcnt lgkmcnt(6)
    v_mfma_f32_32x32x16_bf16 v[24:39], v[64:67], a[76:79], v[24:39]
    s_and_b32 s93, s97, 3
    s_xor_b32 s93, s93, 1
    s_add_u32 s94, s93, 12
    s_mul_i32 s94, s94, 0x3800
    s_mul_i32 s93, s93, 0x6200
    s_cmp_ge_u32 s69, 2
    s_cselect_b32 s95, 0x3800, 0
    s_add_u32 s93, s93, s95
    s_mov_b32 s95, 0x70
    s_cmp_eq_u32 s69, 0
    s_cselect_b32 s93, s94, s93
    s_cselect_b32 s95, 0x1c0, s95
    s_cselect_b32 s4, s44, s48
    s_cselect_b32 s5, s45, s49
    s_cselect_b32 s6, s46, s50
    s_mov_b32 s7, 0x20000
    s_lshl_b32 s94, s98, 7
    s_add_u32 s93, s93, s94
    v_lshrrev_b32 v20, 4, v1
    v_mul_u32_u24 v20, s95, v20
    v_and_b32 v21, 15, v1
    v_add_u32 v20, v20, v21
    v_mul_u32_u24 v20, 0x380, v20
    buffer_load_dword v18, v20, s[4:7], s93 offen
    ds_read_b64_tr_b16 v[64:65], v5 offset:2048
    ds_read_b64_tr_b16 v[66:67], v5 offset:2560
    s_waitcnt lgkmcnt(6)
    v_mfma_f32_32x32x16_bf16 v[40:55], v[68:71], a[76:79], v[40:55]
    v_add_f32 v140, v140, v91
    v_add_f32 v141, v141, v123
    s_waitcnt vmcnt(13)
    s_barrier
    ds_read_b64_tr_b16 v[68:69], v7 offset:2048
    ds_read_b64_tr_b16 v[70:71], v7 offset:2560
    s_waitcnt lgkmcnt(6)
    v_mfma_f32_32x32x16_bf16 v[24:39], v[56:59], a[80:83], v[24:39]
    v_add_f32 v140, v140, v130
    v_add_f32 v141, v141, v131
    v_mov_b32 v130, v140
    v_mov_b32 v131, v141
    s_nop 0
    v_permlane32_swap_b32 v140, v130
    ds_read_b64_tr_b16 v[56:57], v5 offset:4096
    ds_read_b64_tr_b16 v[58:59], v5 offset:4608
    s_waitcnt lgkmcnt(6)
    v_mfma_f32_32x32x16_bf16 v[40:55], v[60:63], a[80:83], v[40:55]
    v_permlane32_swap_b32 v141, v131
    v_add_f32 v140, v140, v130
    v_add_f32 v141, v141, v131
    v_rcp_f32 v140, v140
    ds_read_b64_tr_b16 v[60:61], v7 offset:4096
    ds_read_b64_tr_b16 v[62:63], v7 offset:4608
    s_waitcnt lgkmcnt(6)
    v_mfma_f32_32x32x16_bf16 v[24:39], v[64:67], a[84:87], v[24:39]
    v_rcp_f32 v141, v141
    s_nop 0
    v_mul_f32 v142, v140, v17
    v_mul_f32 v143, v141, v17
    v_mul_f32 v80, v80, v140
    ds_read_b64_tr_b16 v[64:65], v5 offset:6144
    ds_read_b64_tr_b16 v[66:67], v5 offset:6656
    s_waitcnt lgkmcnt(6)
    v_mfma_f32_32x32x16_bf16 v[40:55], v[68:71], a[84:87], v[40:55]
    v_mul_f32 v112, v112, v141
    v_mul_f32 v81, v81, v140
    v_mul_f32 v113, v113, v141
    s_mul_i32 s92, s78, 0x38000
    s_add_u32 m0, s87, 0x10000
    s_add_u32 s92, s92, s89
    buffer_load_dwordx4 v10, s[36:39], s92 offen lds
    ds_read_b64_tr_b16 v[68:69], v7 offset:6144
    ds_read_b64_tr_b16 v[70:71], v7 offset:6656
    s_waitcnt lgkmcnt(6)
    v_mfma_f32_32x32x16_bf16 v[24:39], v[56:59], a[88:91], v[24:39]
    v_mul_f32 v82, v82, v140
    v_mul_f32 v114, v114, v141
    v_mul_f32 v83, v83, v140
    v_mul_f32 v115, v115, v141
    v_add_u32 v4, 0x4000, v12
    ds_read_b64_tr_b16 v[56:57], v4
    ds_read_b64_tr_b16 v[58:59], v4 offset:512
    s_waitcnt lgkmcnt(6)
    v_mfma_f32_32x32x16_bf16 v[40:55], v[60:63], a[88:91], v[40:55]
    v_mul_f32 v84, v84, v140
    v_mul_f32 v116, v116, v141
    v_mul_f32 v85, v85, v140
    v_mul_f32 v117, v117, v141
    v_mul_f32 v86, v86, v140
    v_add_u32 v6, 0x4000, v13
    ds_read_b64_tr_b16 v[60:61], v6
    ds_read_b64_tr_b16 v[62:63], v6 offset:512
    s_waitcnt lgkmcnt(6)
    v_mfma_f32_32x32x16_bf16 v[24:39], v[64:67], a[92:95], v[24:39]
    v_mul_f32 v118, v118, v141
    v_mul_f32 v87, v87, v140
    v_mul_f32 v119, v119, v141
    v_mul_f32 v88, v88, v140
    v_mul_f32 v120, v120, v141
    ds_read_b64_tr_b16 v[64:65], v4 offset:2048
    ds_read_b64_tr_b16 v[66:67], v4 offset:2560
    s_waitcnt lgkmcnt(6)
    v_mfma_f32_32x32x16_bf16 v[40:55], v[68:71], a[92:95], v[40:55]
    s_mul_i32 s92, s78, 0x38000
    s_add_u32 m0, s87, 0x12000
    s_add_u32 s92, s92, s89
    buffer_load_dwordx4 v11, s[40:43], s92 offen lds
    v_mul_f32 v89, v89, v140
    v_mul_f32 v121, v121, v141
    s_barrier
    ds_read_b64_tr_b16 v[68:69], v6 offset:2048
    ds_read_b64_tr_b16 v[70:71], v6 offset:2560
    s_waitcnt lgkmcnt(6)
    v_mfma_f32_32x32x16_bf16 v[24:39], v[56:59], a[96:99], v[24:39]
    v_mul_f32 v90, v90, v140
    v_mul_f32 v122, v122, v141
    v_mul_f32 v91, v91, v140
    v_mul_f32 v123, v123, v141
    ds_read_b64_tr_b16 v[56:57], v4 offset:4096
    ds_read_b64_tr_b16 v[58:59], v4 offset:4608
    s_waitcnt lgkmcnt(6)
    v_mfma_f32_32x32x16_bf16 v[40:55], v[60:63], a[96:99], v[40:55]
    v_mul_f32 v92, v92, v142
    v_mul_f32 v124, v124, v143
    v_mul_f32 v93, v93, v142
    v_mul_f32 v125, v125, v143
    v_mul_f32 v94, v94, v142
    ds_read_b64_tr_b16 v[60:61], v6 offset:4096
    ds_read_b64_tr_b16 v[62:63], v6 offset:4608
    s_waitcnt lgkmcnt(6)
    v_mfma_f32_32x32x16_bf16 v[24:39], v[64:67], a[100:103], v[24:39]
    v_mul_f32 v126, v126, v143
    v_mul_f32 v95, v95, v142
    v_mul_f32 v127, v127, v143
    v_cvt_pk_bf16_f32 v96, v80, v81
    ds_read_b64_tr_b16 v[64:65], v4 offset:6144
    ds_read_b64_tr_b16 v[66:67], v4 offset:6656
    s_waitcnt lgkmcnt(6)
    v_mfma_f32_32x32x16_bf16 v[40:55], v[68:71], a[100:103], v[40:55]
    v_cvt_pk_bf16_f32 v97, v82, v83
    v_cvt_pk_bf16_f32 v98, v84, v85
    s_mul_i32 s92, s79, 0x38000
    s_add_u32 m0, s87, 0x14000
    s_add_u32 s92, s92, s89
    buffer_load_dwordx4 v10, s[36:39], s92 offen lds
    ds_read_b64_tr_b16 v[68:69], v6 offset:6144
    ds_read_b64_tr_b16 v[70:71], v6 offset:6656
    s_waitcnt lgkmcnt(6)
    v_mfma_f32_32x32x16_bf16 v[24:39], v[56:59], a[104:107], v[24:39]
    v_cvt_pk_bf16_f32 v99, v86, v87
    v_cvt_pk_bf16_f32 v100, v88, v89
    v_cvt_pk_bf16_f32 v101, v90, v91
    s_waitcnt lgkmcnt(4)
    v_mfma_f32_32x32x16_bf16 v[40:55], v[60:63], a[104:107], v[40:55]
    v_cvt_pk_bf16_f32 v102, v92, v93
    v_cvt_pk_bf16_f32 v103, v94, v95
    v_cvt_pk_bf16_f32 v104, v112, v113
    v_cvt_pk_bf16_f32 v105, v114, v115
    v_cvt_pk_bf16_f32 v106, v116, v117
    s_waitcnt lgkmcnt(2)
    v_mfma_f32_32x32x16_bf16 v[24:39], v[64:67], a[108:111], v[24:39]
    v_cvt_pk_bf16_f32 v107, v118, v119
    v_cvt_pk_bf16_f32 v108, v120, v121
    v_cvt_pk_bf16_f32 v109, v122, v123
    v_cvt_pk_bf16_f32 v110, v124, v125
    s_waitcnt lgkmcnt(0)
    v_mfma_f32_32x32x16_bf16 v[40:55], v[68:71], a[108:111], v[40:55]
    s_mul_i32 s92, s79, 0x38000
    s_add_u32 m0, s87, 0x16000
    s_add_u32 s92, s92, s89
    buffer_load_dwordx4 v11, s[40:43], s92 offen lds
    v_cvt_pk_bf16_f32 v111, v126, v127
    s_waitcnt vmcnt(11)
    s_barrier
    v_add_u32 v4, 0x1a000, v12
    ds_read_b64_tr_b16 v[56:57], v4
    ds_read_b64_tr_b16 v[58:59], v4 offset:512
    v_add_u32 v6, 0x1a000, v13
    ds_read_b64_tr_b16 v[60:61], v6
    ds_read_b64_tr_b16 v[62:63], v6 offset:512
    ds_read_b64_tr_b16 v[64:65], v4 offset:2048
    ds_read_b64_tr_b16 v[66:67], v4 offset:2560
    ds_read_b64_tr_b16 v[68:69], v6 offset:2048
    ds_read_b64_tr_b16 v[70:71], v6 offset:2560
    s_waitcnt lgkmcnt(6)
    v_mfma_f32_32x32x16_bf16 v[80:95], v[56:59], a[0:3], 0
    v_exp_f32 v72, v24
    v_exp_f32 v73, v25
    ds_read_b64_tr_b16 v[56:57], v4 offset:4096
    ds_read_b64_tr_b16 v[58:59], v4 offset:4608
    s_waitcnt lgkmcnt(6)
    v_mfma_f32_32x32x16_bf16 v[112:127], v[60:63], a[0:3], 0
    v_exp_f32 v74, v26
    v_exp_f32 v75, v27
    ds_read_b64_tr_b16 v[60:61], v6 offset:4096
    ds_read_b64_tr_b16 v[62:63], v6 offset:4608
    s_waitcnt lgkmcnt(6)
    v_mfma_f32_32x32x16_bf16 v[80:95], v[64:67], a[4:7], v[80:95]
    v_exp_f32 v76, v28
    v_exp_f32 v77, v29
    v_exp_f32 v78, v30
    ds_read_b64_tr_b16 v[64:65], v4 offset:6144
    ds_read_b64_tr_b16 v[66:67], v4 offset:6656
    s_waitcnt lgkmcnt(6)
    v_mfma_f32_32x32x16_bf16 v[112:127], v[68:71], a[4:7], v[112:127]
    v_exp_f32 v79, v31
    s_mul_i32 s92, s8, 0x3800
    s_add_u32 s92, s92, s85
    s_add_u32 m0, s99, 0x4000
    s_add_u32 s92, s92, 0x7000
    buffer_load_dwordx4 v9, s[44:47], s92 offen lds
    ds_read_b64_tr_b16 v[68:69], v6 offset:6144
    ds_read_b64_tr_b16 v[70:71], v6 offset:6656
    s_waitcnt lgkmcnt(6)
    v_mfma_f32_32x32x16_bf16 v[80:95], v[56:59], a[8:11], v[80:95]
    v_mul_f32 v24, v24, v32
    v_mul_f32 v25, v25, v33
    v_mul_f32 v26, v26, v34
    v_mul_f32 v27, v27, v35
    v_add_u32 v5, 0x1e000, v12
    ds_read_b64_tr_b16 v[56:57], v5
    ds_read_b64_tr_b16 v[58:59], v5 offset:512
    s_waitcnt lgkmcnt(6)
    v_mfma_f32_32x32x16_bf16 v[112:127], v[60:63], a[8:11], v[112:127]
    v_mul_f32 v28, v28, v36
    v_mul_f32 v29, v29, v37
    v_mul_f32 v30, v30, v38
    v_mul_f32 v31, v31, v39
    v_add_f32 v72, 1.0, v72
    v_add_f32 v73, 1.0, v73
    v_add_u32 v7, 0x1e000, v13
    ds_read_b64_tr_b16 v[60:61], v7
    ds_read_b64_tr_b16 v[62:63], v7 offset:512
    s_waitcnt lgkmcnt(6)
    v_mfma_f32_32x32x16_bf16 v[80:95], v[64:67], a[12:15], v[80:95]
    v_add_f32 v74, 1.0, v74
    v_add_f32 v75, 1.0, v75
    v_add_f32 v76, 1.0, v76
    v_add_f32 v77, 1.0, v77
    ds_read_b64_tr_b16 v[64:65], v5 offset:2048
    ds_read_b64_tr_b16 v[66:67], v5 offset:2560
    s_waitcnt lgkmcnt(6)
    v_mfma_f32_32x32x16_bf16 v[112:127], v[68:71], a[12:15], v[112:127]
    s_mul_i32 s92, s8, 0x3800
    s_add_u32 s92, s92, s85
    s_add_u32 m0, s99, 0x6000
    s_add_u32 s92, s92, 0xa800
    buffer_load_dwordx4 v9, s[44:47], s92 offen lds
    v_add_f32 v78, 1.0, v78
    v_add_f32 v79, 1.0, v79
    s_waitcnt vmcnt(10)
    s_barrier
    ds_read_b64_tr_b16 v[68:69], v7 offset:2048
    ds_read_b64_tr_b16 v[70:71], v7 offset:2560
    s_waitcnt lgkmcnt(6)
    v_mfma_f32_32x32x16_bf16 v[80:95], v[56:59], a[16:19], v[80:95]
    v_rcp_f32 v72, v72
    v_rcp_f32 v73, v73
    v_rcp_f32 v74, v74
    ds_read_b64_tr_b16 v[56:57], v5 offset:4096
    ds_read_b64_tr_b16 v[58:59], v5 offset:4608
    s_waitcnt lgkmcnt(6)
    v_mfma_f32_32x32x16_bf16 v[112:127], v[60:63], a[16:19], v[112:127]
    v_rcp_f32 v75, v75
    v_rcp_f32 v76, v76
    ds_read_b64_tr_b16 v[60:61], v7 offset:4096
    ds_read_b64_tr_b16 v[62:63], v7 offset:4608
    s_waitcnt lgkmcnt(6)
    v_mfma_f32_32x32x16_bf16 v[80:95], v[64:67], a[20:23], v[80:95]
    v_rcp_f32 v77, v77
    v_rcp_f32 v78, v78
    v_rcp_f32 v79, v79
    ds_read_b64_tr_b16 v[64:65], v5 offset:6144
    ds_read_b64_tr_b16 v[66:67], v5 offset:6656
    s_waitcnt lgkmcnt(6)
    v_mfma_f32_32x32x16_bf16 v[112:127], v[68:71], a[20:23], v[112:127]
    v_mul_f32 v24, v24, v72
    v_mul_f32 v25, v25, v73
    s_mul_i32 s92, s9, 0x3800
    s_add_u32 m0, s99, 0x1a000
    s_add_u32 s92, s92, s85
    buffer_load_dwordx4 v9, s[44:47], s92 offen lds
    ds_read_b64_tr_b16 v[68:69], v7 offset:6144
    ds_read_b64_tr_b16 v[70:71], v7 offset:6656
    s_waitcnt lgkmcnt(6)
    v_mfma_f32_32x32x16_bf16 v[80:95], v[56:59], a[24:27], v[80:95]
    v_mul_f32 v26, v26, v74
    v_mul_f32 v27, v27, v75
    v_mul_f32 v28, v28, v76
    v_mul_f32 v29, v29, v77
    v_add_u32 v4, 0x22000, v12
    ds_read_b64_tr_b16 v[56:57], v4
    ds_read_b64_tr_b16 v[58:59], v4 offset:512
    s_waitcnt lgkmcnt(6)
    v_mfma_f32_32x32x16_bf16 v[112:127], v[60:63], a[24:27], v[112:127]
    v_mul_f32 v30, v30, v78
    v_mul_f32 v31, v31, v79
    v_cvt_pk_bf16_f32 v132, v24, v25
    v_cvt_pk_bf16_f32 v133, v26, v27
    v_cvt_pk_bf16_f32 v134, v28, v29
    v_cvt_pk_bf16_f32 v135, v30, v31
    v_add_u32 v6, 0x22000, v13
    ds_read_b64_tr_b16 v[60:61], v6
    ds_read_b64_tr_b16 v[62:63], v6 offset:512
    s_waitcnt lgkmcnt(6)
    v_mfma_f32_32x32x16_bf16 v[80:95], v[64:67], a[28:31], v[80:95]
    s_lshl_b32 s93, s88, 5
    s_add_u32 s93, s93, s90
    s_mul_i32 s94, s70, 0x800
    s_add_u32 s93, s93, s94
    buffer_store_dwordx4 v[132:135], v2, s[60:63], s93 offen sc1
    ds_read_b64_tr_b16 v[64:65], v4 offset:2048
    ds_read_b64_tr_b16 v[66:67], v4 offset:2560
    s_waitcnt lgkmcnt(6)
    v_mfma_f32_32x32x16_bf16 v[112:127], v[68:71], a[28:31], v[112:127]
    s_mul_i32 s92, s9, 0x3800
    s_add_u32 s92, s92, s85
    s_add_u32 m0, s99, 0x1c000
    s_add_u32 s92, s92, 0x3800
    buffer_load_dwordx4 v9, s[44:47], s92 offen lds
    v_exp_f32 v72, v40
    s_waitcnt vmcnt(10)
    s_barrier
    ds_read_b64_tr_b16 v[68:69], v6 offset:2048
    ds_read_b64_tr_b16 v[70:71], v6 offset:2560
    s_waitcnt lgkmcnt(6)
    v_mfma_f32_32x32x16_bf16 v[80:95], v[56:59], a[32:35], v[80:95]
    v_exp_f32 v73, v41
    v_exp_f32 v74, v42
    v_exp_f32 v75, v43
    ds_read_b64_tr_b16 v[56:57], v4 offset:4096
    ds_read_b64_tr_b16 v[58:59], v4 offset:4608
    s_waitcnt lgkmcnt(6)
    v_mfma_f32_32x32x16_bf16 v[112:127], v[60:63], a[32:35], v[112:127]
    v_exp_f32 v76, v44
    v_exp_f32 v77, v45
    ds_read_b64_tr_b16 v[60:61], v6 offset:4096
    ds_read_b64_tr_b16 v[62:63], v6 offset:4608
    s_waitcnt lgkmcnt(6)
    v_mfma_f32_32x32x16_bf16 v[80:95], v[64:67], a[36:39], v[80:95]
    v_exp_f32 v78, v46
    v_exp_f32 v79, v47
    v_mul_f32 v40, v40, v48
    v_mul_f32 v41, v41, v49
    ds_read_b64_tr_b16 v[64:65], v4 offset:6144
    ds_read_b64_tr_b16 v[66:67], v4 offset:6656
    s_waitcnt lgkmcnt(6)
    v_mfma_f32_32x32x16_bf16 v[112:127], v[68:71], a[36:39], v[112:127]
    v_mul_f32 v42, v42, v50
    v_mul_f32 v43, v43, v51
    s_mul_i32 s92, s9, 0x3800
    s_add_u32 s92, s92, s85
    s_add_u32 m0, s99, 0x1e000
    s_add_u32 s92, s92, 0x7000
    buffer_load_dwordx4 v9, s[44:47], s92 offen lds
    ds_read_b64_tr_b16 v[68:69], v6 offset:6144
    ds_read_b64_tr_b16 v[70:71], v6 offset:6656
    s_waitcnt lgkmcnt(6)
    v_mfma_f32_32x32x16_bf16 v[80:95], v[56:59], a[40:43], v[80:95]
    v_mul_f32 v44, v44, v52
    v_mul_f32 v45, v45, v53
    v_mul_f32 v46, v46, v54
    v_mul_f32 v47, v47, v55
    v_add_u32 v5, 0xc000, v12
    ds_read_b64_tr_b16 v[56:57], v5
    ds_read_b64_tr_b16 v[58:59], v5 offset:512
    s_waitcnt lgkmcnt(6)
    v_mfma_f32_32x32x16_bf16 v[112:127], v[60:63], a[40:43], v[112:127]
    v_add_f32 v72, 1.0, v72
    v_add_f32 v73, 1.0, v73
    v_add_f32 v74, 1.0, v74
    v_add_f32 v75, 1.0, v75
    v_add_f32 v76, 1.0, v76
    v_add_f32 v77, 1.0, v77
    v_add_u32 v7, 0xc000, v13
    ds_read_b64_tr_b16 v[60:61], v7
    ds_read_b64_tr_b16 v[62:63], v7 offset:512
    s_waitcnt lgkmcnt(6)
    v_mfma_f32_32x32x16_bf16 v[80:95], v[64:67], a[44:47], v[80:95]
    v_add_f32 v78, 1.0, v78
    v_add_f32 v79, 1.0, v79
    v_rcp_f32 v72, v72
    ds_read_b64_tr_b16 v[64:65], v5 offset:2048
    ds_read_b64_tr_b16 v[66:67], v5 offset:2560
    s_waitcnt lgkmcnt(6)
    v_mfma_f32_32x32x16_bf16 v[112:127], v[68:71], a[44:47], v[112:127]
    s_mul_i32 s92, s9, 0x3800
    s_add_u32 s92, s92, s85
    s_add_u32 m0, s99, 0x20000
    s_add_u32 s92, s92, 0xa800
    buffer_load_dwordx4 v9, s[44:47], s92 offen lds
    v_rcp_f32 v73, v73
    s_waitcnt vmcnt(9)
    s_barrier
    ds_read_b64_tr_b16 v[68:69], v7 offset:2048
    ds_read_b64_tr_b16 v[70:71], v7 offset:2560
    s_waitcnt lgkmcnt(6)
    v_mfma_f32_32x32x16_bf16 v[80:95], v[56:59], a[48:51], v[80:95]
    v_rcp_f32 v74, v74
    v_rcp_f32 v75, v75
    v_rcp_f32 v76, v76
    ds_read_b64_tr_b16 v[56:57], v5 offset:4096
    ds_read_b64_tr_b16 v[58:59], v5 offset:4608
    s_waitcnt lgkmcnt(6)
    v_mfma_f32_32x32x16_bf16 v[112:127], v[60:63], a[48:51], v[112:127]
    v_rcp_f32 v77, v77
    v_rcp_f32 v78, v78
    v_rcp_f32 v79, v79
    v_mul_f32 v40, v40, v72
    ds_read_b64_tr_b16 v[60:61], v7 offset:4096
    ds_read_b64_tr_b16 v[62:63], v7 offset:4608
    s_waitcnt lgkmcnt(6)
    v_mfma_f32_32x32x16_bf16 v[80:95], v[64:67], a[52:55], v[80:95]
    v_mul_f32 v41, v41, v73
    v_mul_f32 v42, v42, v74
    v_mul_f32 v43, v43, v75
    v_mul_f32 v44, v44, v76
    v_mul_f32 v45, v45, v77
    v_mul_f32 v46, v46, v78
    v_mul_f32 v47, v47, v79
    ds_read_b64_tr_b16 v[64:65], v5 offset:6144
    ds_read_b64_tr_b16 v[66:67], v5 offset:6656
    s_waitcnt lgkmcnt(6)
    v_mfma_f32_32x32x16_bf16 v[112:127], v[68:71], a[52:55], v[112:127]
    v_cvt_pk_bf16_f32 v136, v40, v41
    v_cvt_pk_bf16_f32 v137, v42, v43
    v_cvt_pk_bf16_f32 v138, v44, v45
    v_cvt_pk_bf16_f32 v139, v46, v47
    s_mul_i32 s92, s19, 0x3800
    s_add_u32 m0, s99, 0x22000
    s_add_u32 s92, s92, s85
    buffer_load_dwordx4 v9, s[44:47], s92 offen lds
    ds_read_b64_tr_b16 v[68:69], v7 offset:6144
    ds_read_b64_tr_b16 v[70:71], v7 offset:6656
    s_waitcnt lgkmcnt(6)
    v_mfma_f32_32x32x16_bf16 v[80:95], v[56:59], a[56:59], v[80:95]
    s_lshl_b32 s93, s88, 5
    s_add_u32 s93, s93, s90
    s_mul_i32 s94, s70, 0x800
    s_add_u32 s93, s93, s94
    buffer_store_dwordx4 v[136:139], v2, s[60:63], s93 offen offset:1024 sc1
    v_add_u32 v4, 0x10000, v12
    ds_read_b64_tr_b16 v[56:57], v4
    ds_read_b64_tr_b16 v[58:59], v4 offset:512
    s_waitcnt lgkmcnt(6)
    v_mfma_f32_32x32x16_bf16 v[112:127], v[60:63], a[56:59], v[112:127]
    s_lshr_b32 s93, s97, 1
    s_lshl_b32 s93, s93, 2
    s_and_b32 s94, s97, 1
    s_lshl_b32 s94, s94, 1
    s_add_u32 s93, s93, s94
    s_add_u32 s93, s93, s70
    s_mul_i32 s10, s93, 0x1c000
    s_mul_i32 s94, s69, 0x7000
    s_add_u32 s10, s10, s94
    s_lshl_b32 s11, s93, 15
    s_lshl_b32 s94, s69, 13
    s_add_u32 s11, s11, s94
    s_add_u32 s11, s11, 0x700000
    s_lshr_b32 s93, s97, 1
    s_lshl_b32 s93, s93, 13
    s_add_u32 s13, s93, 0x930000
    v_and_b32 v142, 15, v1
    v_lshlrev_b32 v142, 9, v142
    v_add_u32 v6, 0x10000, v13
    ds_read_b64_tr_b16 v[60:61], v6
    ds_read_b64_tr_b16 v[62:63], v6 offset:512
    s_waitcnt lgkmcnt(6)
    v_mfma_f32_32x32x16_bf16 v[80:95], v[64:67], a[60:63], v[80:95]
    v_bfe_u32 v20, v1, 2, 2
    v_lshrrev_b32 v21, 5, v1
    v_lshl_add_u32 v21, v21, 2, v20
    v_lshrrev_b32 v20, 1, v20
    v_lshlrev_b32 v20, 6, v20
    v_lshl_add_u32 v20, v21, 7, v20
    v_bfe_u32 v21, v1, 4, 1
    v_lshl_add_u32 v20, v21, 5, v20
    v_and_b32 v21, 3, v1
    v_lshl_add_u32 v20, v21, 3, v20
    s_lshl_b32 s93, s69, 11
    v_add_u32 v128, s93, v20
    ds_read_b64_tr_b16 v[64:65], v4 offset:2048
    ds_read_b64_tr_b16 v[66:67], v4 offset:2560
    s_waitcnt lgkmcnt(6)
    v_mfma_f32_32x32x16_bf16 v[112:127], v[68:71], a[60:63], v[112:127]
    s_mul_i32 s92, s19, 0x3800
    s_add_u32 s92, s92, s85
    s_add_u32 m0, s99, 0x24000
    s_add_u32 s92, s92, 0x3800
    buffer_load_dwordx4 v9, s[44:47], s92 offen lds
    s_waitcnt vmcnt(10)
    s_barrier
    ds_read_b64_tr_b16 v[68:69], v6 offset:2048
    ds_read_b64_tr_b16 v[70:71], v6 offset:2560
    s_waitcnt lgkmcnt(6)
    v_mfma_f32_32x32x16_bf16 v[80:95], v[56:59], a[64:67], v[80:95]
    v_xor_b32 v129, 64, v128
    v_add_u32 v130, 0x10000, v128
    v_add_u32 v131, 0x10000, v129
    ds_read_b64_tr_b16 v[56:57], v4 offset:4096
    ds_read_b64_tr_b16 v[58:59], v4 offset:4608
    s_waitcnt lgkmcnt(6)
    v_mfma_f32_32x32x16_bf16 v[112:127], v[60:63], a[64:67], v[112:127]
    v_add_u32 v140, 0x20000, v128
    v_add_u32 v141, 0x20000, v129
    ds_read_b64_tr_b16 v[60:61], v6 offset:4096
    ds_read_b64_tr_b16 v[62:63], v6 offset:4608
    s_waitcnt lgkmcnt(6)
    v_mfma_f32_32x32x16_bf16 v[80:95], v[64:67], a[68:71], v[80:95]
    ds_read_b64_tr_b16 v[64:65], v4 offset:6144
    ds_read_b64_tr_b16 v[66:67], v4 offset:6656
    s_waitcnt lgkmcnt(6)
    v_mfma_f32_32x32x16_bf16 v[112:127], v[68:71], a[68:71], v[112:127]
    v_lshrrev_b32 v20, 3, v1
    s_lshl_b32 s93, s97, 6
    s_lshl_b32 s94, s70, 5
    s_add_u32 s93, s93, s94
    s_lshl_b32 s94, s69, 3
    s_add_u32 s93, s93, s94
    v_add_u32 v20, s93, v20
    v_mul_u32_u24 v20, 0x380, v20
    v_and_b32 v21, 7, v1
    v_lshl_add_u32 v20, v21, 4, v20
    s_lshl_b32 s93, s98, 7
    v_add_u32 v8, s93, v20
    ds_read_b64_tr_b16 v[68:69], v6 offset:6144
    ds_read_b64_tr_b16 v[70:71], v6 offset:6656
    s_waitcnt lgkmcnt(6)
    v_mfma_f32_32x32x16_bf16 v[80:95], v[56:59], a[72:75], v[80:95]
    v_and_b32 v10, 15, v1
    v_lshlrev_b32 v10, 13, v10
    s_lshl_b32 s93, s72, 10
    s_add_u32 s12, s93, 0x930000
    v_add_u32 v5, 0x14000, v12
    ds_read_b64_tr_b16 v[56:57], v5
    ds_read_b64_tr_b16 v[58:59], v5 offset:512
    s_waitcnt lgkmcnt(6)
    v_mfma_f32_32x32x16_bf16 v[112:127], v[60:63], a[72:75], v[112:127]
    s_mul_i32 s92, s19, 0x3800
    s_add_u32 s92, s92, s85
    s_add_u32 m0, s99, 0xc000
    s_add_u32 s92, s92, 0x7000
    buffer_load_dwordx4 v9, s[44:47], s92 offen lds
    v_add_u32 v7, 0x14000, v13
    ds_read_b64_tr_b16 v[60:61], v7
    ds_read_b64_tr_b16 v[62:63], v7 offset:512
    s_waitcnt lgkmcnt(6)
    v_mfma_f32_32x32x16_bf16 v[80:95], v[64:67], a[76:79], v[80:95]
    ds_read_b64_tr_b16 v[64:65], v5 offset:2048
    ds_read_b64_tr_b16 v[66:67], v5 offset:2560
    s_waitcnt lgkmcnt(6)
    v_mfma_f32_32x32x16_bf16 v[112:127], v[68:71], a[76:79], v[112:127]
    s_mul_i32 s92, s19, 0x3800
    s_add_u32 s92, s92, s85
    s_add_u32 m0, s99, 0xe000
    s_add_u32 s92, s92, 0xa800
    buffer_load_dwordx4 v9, s[44:47], s92 offen lds
    s_waitcnt vmcnt(3)
    s_barrier
    ds_read_b64_tr_b16 v[68:69], v7 offset:2048
    ds_read_b64_tr_b16 v[70:71], v7 offset:2560
    s_waitcnt lgkmcnt(6)
    v_mfma_f32_32x32x16_bf16 v[80:95], v[56:59], a[80:83], v[80:95]
    ds_read_b64_tr_b16 v[56:57], v5 offset:4096
    ds_read_b64_tr_b16 v[58:59], v5 offset:4608
    s_waitcnt lgkmcnt(6)
    v_mfma_f32_32x32x16_bf16 v[112:127], v[60:63], a[80:83], v[112:127]
    ds_read_b64_tr_b16 v[60:61], v7 offset:4096
    ds_read_b64_tr_b16 v[62:63], v7 offset:4608
    s_waitcnt lgkmcnt(6)
    v_mfma_f32_32x32x16_bf16 v[80:95], v[64:67], a[84:87], v[80:95]
    s_add_u32 s14, s13, 0x80
    ds_read_b64_tr_b16 v[64:65], v5 offset:6144
    ds_read_b64_tr_b16 v[66:67], v5 offset:6656
    s_waitcnt lgkmcnt(6)
    v_mfma_f32_32x32x16_bf16 v[112:127], v[68:71], a[84:87], v[112:127]
    ds_read_b64_tr_b16 v[68:69], v7 offset:6144
    ds_read_b64_tr_b16 v[70:71], v7 offset:6656
    s_waitcnt lgkmcnt(6)
    v_mfma_f32_32x32x16_bf16 v[80:95], v[56:59], a[88:91], v[80:95]
    s_mul_i32 s92, s22, 0x3800
    s_add_u32 m0, s99, 0x10000
    s_add_u32 s92, s92, s85
    buffer_load_dwordx4 v9, s[44:47], s92 offen lds
    v_add_u32 v4, 0, v12
    ds_read_b64_tr_b16 v[56:57], v4
    ds_read_b64_tr_b16 v[58:59], v4 offset:512
    s_waitcnt lgkmcnt(6)
    v_mfma_f32_32x32x16_bf16 v[112:127], v[60:63], a[88:91], v[112:127]
    v_add_u32 v6, 0, v13
    ds_read_b64_tr_b16 v[60:61], v6
    ds_read_b64_tr_b16 v[62:63], v6 offset:512
    s_waitcnt lgkmcnt(6)
    v_mfma_f32_32x32x16_bf16 v[80:95], v[64:67], a[92:95], v[80:95]
    ds_read_b64_tr_b16 v[64:65], v4 offset:2048
    ds_read_b64_tr_b16 v[66:67], v4 offset:2560
    s_waitcnt lgkmcnt(6)
    v_mfma_f32_32x32x16_bf16 v[112:127], v[68:71], a[92:95], v[112:127]
    s_mul_i32 s92, s22, 0x3800
    s_add_u32 s92, s92, s85
    s_add_u32 m0, s99, 0x12000
    s_add_u32 s92, s92, 0x3800
    buffer_load_dwordx4 v9, s[44:47], s92 offen lds
    s_barrier
    ds_read_b64_tr_b16 v[68:69], v6 offset:2048
    ds_read_b64_tr_b16 v[70:71], v6 offset:2560
    s_waitcnt lgkmcnt(6)
    v_mfma_f32_32x32x16_bf16 v[80:95], v[56:59], a[96:99], v[80:95]
    ds_read_b64_tr_b16 v[56:57], v4 offset:4096
    ds_read_b64_tr_b16 v[58:59], v4 offset:4608
    s_waitcnt lgkmcnt(6)
    v_mfma_f32_32x32x16_bf16 v[112:127], v[60:63], a[96:99], v[112:127]
    ds_read_b64_tr_b16 v[60:61], v6 offset:4096
    ds_read_b64_tr_b16 v[62:63], v6 offset:4608
    s_waitcnt lgkmcnt(6)
    v_mfma_f32_32x32x16_bf16 v[80:95], v[64:67], a[100:103], v[80:95]
    ds_read_b64_tr_b16 v[64:65], v4 offset:6144
    ds_read_b64_tr_b16 v[66:67], v4 offset:6656
    s_waitcnt lgkmcnt(6)
    v_mfma_f32_32x32x16_bf16 v[112:127], v[68:71], a[100:103], v[112:127]
    ds_read_b64_tr_b16 v[68:69], v6 offset:6144
    ds_read_b64_tr_b16 v[70:71], v6 offset:6656
    s_waitcnt lgkmcnt(6)
    v_mfma_f32_32x32x16_bf16 v[80:95], v[56:59], a[104:107], v[80:95]
    s_lshl_b32 s92, s72, 1
    s_add_u32 s92, s92, s70
    s_lshl_b32 s92, s92, 13
    s_lshl_b32 s93, s69, 11
    s_add_u32 s92, s92, s93
    s_add_u32 s92, s92, 0x900000
    s_add_u32 m0, s93, 0x26000
    s_nop 0
    buffer_load_dwordx4 v2, s[60:63], s92 offen sc1 lds
    buffer_load_dwordx4 v2, s[60:63], s92 offen offset:1024 sc1 lds
    s_waitcnt lgkmcnt(4)
    v_mfma_f32_32x32x16_bf16 v[112:127], v[60:63], a[104:107], v[112:127]
    s_waitcnt lgkmcnt(2)
    v_mfma_f32_32x32x16_bf16 v[80:95], v[64:67], a[108:111], v[80:95]
    s_waitcnt lgkmcnt(0)
    v_mfma_f32_32x32x16_bf16 v[112:127], v[68:71], a[108:111], v[112:127]
    s_waitcnt vmcnt(0)
    s_barrier
    s_lshl_b32 s92, s8, 10
    s_add_u32 s92, s92, s10
    buffer_load_dwordx4 a[0:3], v2, s[60:63], s92 offen sc1
    s_lshl_b32 s92, s8, 10
    s_add_u32 s92, s92, s10
    buffer_load_dwordx4 a[4:7], v2, s[60:63], s92 offen offset:1024 sc1
    s_lshl_b32 s92, s8, 10
    s_add_u32 s92, s92, s10
    buffer_load_dwordx4 a[8:11], v2, s[60:63], s92 offen offset:2048 sc1
    s_lshl_b32 s92, s8, 10
    s_add_u32 s92, s92, s10
    buffer_load_dwordx4 a[12:15], v2, s[60:63], s92 offen offset:3072 sc1
    s_lshl_b32 s92, s9, 10
    s_add_u32 s92, s92, s10
    buffer_load_dwordx4 a[16:19], v2, s[60:63], s92 offen sc1
    s_lshl_b32 s92, s9, 10
    s_add_u32 s92, s92, s10
    buffer_load_dwordx4 a[20:23], v2, s[60:63], s92 offen offset:1024 sc1
    s_lshl_b32 s92, s9, 10
    s_add_u32 s92, s92, s10
    buffer_load_dwordx4 a[24:27], v2, s[60:63], s92 offen offset:2048 sc1
    s_lshl_b32 s92, s9, 10
    s_add_u32 s92, s92, s10
    buffer_load_dwordx4 a[28:31], v2, s[60:63], s92 offen offset:3072 sc1
    v_bfe_u32 v22, v1, 4, 1
    v_lshlrev_b32 v22, 10, v22
    v_lshrrev_b32 v23, 5, v1
    v_lshl_add_u32 v22, v23, 6, v22
    v_and_b32 v23, 15, v1
    v_lshl_add_u32 v22, v23, 2, v22
    v_add_u32 v22, 0x26000, v22
    v_add_u32 v23, 0x80, v22
    ds_read2st64_b32 v[24:25], v22 offset0:0 offset1:1
    ds_read2st64_b32 v[26:27], v22 offset0:2 offset1:3
    ds_read2st64_b32 v[28:29], v23 offset0:0 offset1:1
    ds_read2st64_b32 v[30:31], v23 offset0:2 offset1:3
    ds_read2st64_b32 v[32:33], v22 offset0:8 offset1:9
    ds_read2st64_b32 v[34:35], v22 offset0:10 offset1:11
    ds_read2st64_b32 v[36:37], v23 offset0:8 offset1:9
    ds_read2st64_b32 v[38:39], v23 offset0:10 offset1:11
    ds_read2st64_b32 v[40:41], v22 offset0:16 offset1:17
    ds_read2st64_b32 v[42:43], v22 offset0:18 offset1:19
    ds_read2st64_b32 v[44:45], v23 offset0:16 offset1:17
    ds_read2st64_b32 v[46:47], v23 offset0:18 offset1:19
    ds_read2st64_b32 v[48:49], v22 offset0:24 offset1:25
    ds_read2st64_b32 v[50:51], v22 offset0:26 offset1:27
    ds_read2st64_b32 v[52:53], v23 offset0:24 offset1:25
    ds_read2st64_b32 v[54:55], v23 offset0:26 offset1:27
    v_exp_f32 v72, v80
    v_exp_f32 v73, v81
    v_exp_f32 v74, v82
    v_exp_f32 v75, v83
    v_exp_f32 v76, v84
    v_exp_f32 v77, v85
    v_exp_f32 v78, v86
    v_exp_f32 v79, v87
    s_mul_i32 s92, s22, 0x3800
    s_add_u32 s92, s92, s85
    s_add_u32 m0, s99, 0x14000
    s_add_u32 s92, s92, 0x7000
    buffer_load_dwordx4 v9, s[44:47], s92 offen lds
    v_mul_f32 v80, v80, v88
    v_mul_f32 v81, v81, v89
    v_mul_f32 v82, v82, v90
    v_mul_f32 v83, v83, v91
    v_mul_f32 v84, v84, v92
    v_mul_f32 v85, v85, v93
    v_mul_f32 v86, v86, v94
    v_mul_f32 v87, v87, v95
    v_add_f32 v72, 1.0, v72
    v_add_f32 v73, 1.0, v73
    v_add_f32 v74, 1.0, v74
    v_add_f32 v75, 1.0, v75
    v_add_f32 v76, 1.0, v76
    v_add_f32 v77, 1.0, v77
    v_add_f32 v78, 1.0, v78
    v_add_f32 v79, 1.0, v79
    v_rcp_f32 v72, v72
    v_rcp_f32 v73, v73
    v_rcp_f32 v74, v74
    v_rcp_f32 v75, v75
    v_rcp_f32 v76, v76
    v_rcp_f32 v77, v77
    v_rcp_f32 v78, v78
    s_mul_i32 s92, s22, 0x3800
    s_add_u32 s92, s92, s85
    s_add_u32 m0, s99, 0x16000
    s_add_u32 s92, s92, 0xa800
    buffer_load_dwordx4 v9, s[44:47], s92 offen lds
    v_rcp_f32 v79, v79
    v_mul_f32 v80, v80, v72
    v_mul_f32 v81, v81, v73
    v_mul_f32 v82, v82, v74
    v_mul_f32 v83, v83, v75
    v_mul_f32 v84, v84, v76
    v_mul_f32 v85, v85, v77
    v_mul_f32 v86, v86, v78
    v_mul_f32 v87, v87, v79
    v_cvt_pk_bf16_f32 v132, v80, v81
    v_cvt_pk_bf16_f32 v133, v82, v83
    v_cvt_pk_bf16_f32 v134, v84, v85
    v_cvt_pk_bf16_f32 v135, v86, v87
    s_lshl_b32 s93, s89, 5
    s_add_u32 s93, s93, s90
    s_mul_i32 s94, s70, 0x800
    s_add_u32 s93, s93, s94
    buffer_store_dwordx4 v[132:135], v2, s[60:63], s93 offen sc1
    s_waitcnt lgkmcnt(15)
    v_cvt_pk_bf16_f32 v56, v24, v25
    s_waitcnt lgkmcnt(14)
    v_cvt_pk_bf16_f32 v57, v26, v27
    s_waitcnt lgkmcnt(13)
    v_cvt_pk_bf16_f32 v58, v28, v29
    s_waitcnt lgkmcnt(12)
    v_cvt_pk_bf16_f32 v59, v30, v31
    s_waitcnt lgkmcnt(11)
    v_cvt_pk_bf16_f32 v60, v32, v33
    s_waitcnt lgkmcnt(10)
    v_cvt_pk_bf16_f32 v61, v34, v35
    s_waitcnt lgkmcnt(9)
    v_cvt_pk_bf16_f32 v62, v36, v37
    s_waitcnt lgkmcnt(8)
    v_cvt_pk_bf16_f32 v63, v38, v39
    s_waitcnt lgkmcnt(7)
    v_cvt_pk_bf16_f32 v64, v40, v41
    s_waitcnt lgkmcnt(6)
    v_cvt_pk_bf16_f32 v65, v42, v43
    s_waitcnt lgkmcnt(5)
    v_cvt_pk_bf16_f32 v66, v44, v45
    s_waitcnt lgkmcnt(4)
    v_cvt_pk_bf16_f32 v67, v46, v47
    s_waitcnt lgkmcnt(3)
    v_cvt_pk_bf16_f32 v68, v48, v49
    s_waitcnt lgkmcnt(2)
    v_cvt_pk_bf16_f32 v69, v50, v51
    s_waitcnt lgkmcnt(1)
    v_cvt_pk_bf16_f32 v70, v52, v53
    s_waitcnt lgkmcnt(0)
    v_cvt_pk_bf16_f32 v71, v54, v55
    v_mfma_f32_32x32x16_bf16 v[80:95], v[56:59], v[96:99], 0
    v_mfma_f32_32x32x16_bf16 v[80:95], v[60:63], v[100:103], v[80:95]
    v_mfma_f32_32x32x16_bf16 v[80:95], v[64:67], v[104:107], v[80:95]
    v_mfma_f32_32x32x16_bf16 v[80:95], v[68:71], v[108:111], v[80:95]
    s_lshl_b32 s93, s71, 2
    s_add_u32 s93, s93, s69
    s_lshl_b32 s93, s93, 4
    s_lshl_b32 s94, s72, 1
    s_add_u32 s93, s93, s94
    s_add_u32 s93, s93, s70
    s_lshl_b32 s93, s93, 11
    s_add_u32 s15, s93, 0x700000
    v_exp_f32 v72, v112
    v_exp_f32 v73, v113
    v_exp_f32 v74, v114
    v_exp_f32 v75, v115
    v_exp_f32 v76, v116
    v_exp_f32 v77, v117
    v_exp_f32 v78, v118
    v_exp_f32 v79, v119
    s_mul_i32 s92, s23, 0x3800
    s_mov_b32 m0, s99
    s_add_u32 s92, s92, s85
    buffer_load_dwordx4 v9, s[44:47], s92 offen lds
    v_mul_f32 v112, v112, v120
    v_mul_f32 v113, v113, v121
    v_mul_f32 v114, v114, v122
    v_mul_f32 v115, v115, v123
    v_mul_f32 v116, v116, v124
    v_mul_f32 v117, v117, v125
    v_mul_f32 v118, v118, v126
    v_mul_f32 v119, v119, v127
    v_add_f32 v72, 1.0, v72
    v_add_f32 v73, 1.0, v73
    v_add_f32 v74, 1.0, v74
    v_add_f32 v75, 1.0, v75
    v_add_f32 v76, 1.0, v76
    v_add_f32 v77, 1.0, v77
    v_add_f32 v78, 1.0, v78
    v_add_f32 v79, 1.0, v79
    v_rcp_f32 v72, v72
    v_rcp_f32 v73, v73
    v_rcp_f32 v74, v74
    v_rcp_f32 v75, v75
    v_rcp_f32 v76, v76
    v_rcp_f32 v77, v77
    v_rcp_f32 v78, v78
    s_mul_i32 s92, s23, 0x3800
    s_add_u32 s92, s92, s85
    s_add_u32 m0, s99, 0x2000
    s_add_u32 s92, s92, 0x3800
    buffer_load_dwordx4 v9, s[44:47], s92 offen lds
    v_rcp_f32 v79, v79
    v_mul_f32 v112, v112, v72
    v_mul_f32 v113, v113, v73
    v_mul_f32 v114, v114, v74
    v_mul_f32 v115, v115, v75
    v_mul_f32 v116, v116, v76
    v_mul_f32 v117, v117, v77
    v_mul_f32 v118, v118, v78
    v_mul_f32 v119, v119, v79
    v_cvt_pk_bf16_f32 v136, v112, v113
    v_cvt_pk_bf16_f32 v137, v114, v115
    v_cvt_pk_bf16_f32 v138, v116, v117
    v_cvt_pk_bf16_f32 v139, v118, v119
    s_lshl_b32 s93, s89, 5
    s_add_u32 s93, s93, s90
    s_mul_i32 s94, s70, 0x800
    s_add_u32 s93, s93, s94
    buffer_store_dwordx4 v[136:139], v2, s[60:63], s93 offen offset:1024 sc1
    v_mov_b32 v20, v92
    v_mov_b32 v21, v92
    s_nop 0
    s_nop 0
    v_permlane32_swap_b32 v20, v21
    v_add_f32 v21, 0x358637bd, v21
    v_rcp_f32 v21, v21
    s_nop 0
    v_mul_f32 v80, v80, v21
    v_mul_f32 v81, v81, v21
    v_mul_f32 v82, v82, v21
    v_mul_f32 v83, v83, v21
    v_mul_f32 v84, v84, v21
    v_mul_f32 v85, v85, v21
    v_mul_f32 v86, v86, v21
    v_mul_f32 v87, v87, v21
    v_mul_f32 v88, v88, v21
    v_mul_f32 v89, v89, v21
    v_mul_f32 v90, v90, v21
    v_mul_f32 v91, v91, v21
    v_mul_f32 v92, v92, v21
    v_mul_f32 v93, v93, v21
    v_mul_f32 v94, v94, v21
    v_mul_f32 v95, v95, v21
    v_and_b32 v92, v16, v92
    v_and_b32 v93, v16, v93
    v_and_b32 v94, v16, v94
    v_and_b32 v95, v16, v95
    v_cvt_pk_bf16_f32 v24, v80, v81
    v_cvt_pk_bf16_f32 v25, v82, v83
    v_cvt_pk_bf16_f32 v26, v84, v85
    v_cvt_pk_bf16_f32 v27, v86, v87
    v_cvt_pk_bf16_f32 v28, v88, v89
    v_cvt_pk_bf16_f32 v29, v90, v91
    v_cvt_pk_bf16_f32 v30, v92, v93
    v_cvt_pk_bf16_f32 v31, v94, v95
    buffer_store_dwordx4 v[24:27], v2, s[60:63], s15 offen sc1
    buffer_store_dwordx4 v[28:31], v2, s[60:63], s15 offen offset:1024 sc1
    s_waitcnt lgkmcnt(0)
    s_barrier
    s_cmp_lg_u32 s96, 0
    s_cbranch_scc1 L_nop2_4002
    s_waitcnt vmcnt(0)
    s_barrier
    s_branch L_fin_4001
L_nop2_4002:
    ds_read_b64_tr_b16 v[96:97], v128 offset:32768
    ds_read_b64_tr_b16 v[98:99], v128 offset:33792
    ds_read_b64_tr_b16 v[100:101], v129 offset:32768
    ds_read_b64_tr_b16 v[102:103], v129 offset:33792
    ds_read_b64_tr_b16 v[104:105], v128 offset:40960
    ds_read_b64_tr_b16 v[106:107], v128 offset:41984
    ds_read_b64_tr_b16 v[108:109], v129 offset:40960
    ds_read_b64_tr_b16 v[110:111], v129 offset:41984
    ds_read_b64_tr_b16 v[112:113], v128 offset:16384
    ds_read_b64_tr_b16 v[114:115], v128 offset:17408
    ds_read_b64_tr_b16 v[116:117], v129 offset:16384
    ds_read_b64_tr_b16 v[118:119], v129 offset:17408
    s_waitcnt vmcnt(15) lgkmcnt(10)
    v_mfma_f32_32x32x16_bf16 v[32:47], v[96:99], a[0:3], 0
    s_add_u32 s14, s13, 0x80
    ds_read_b64_tr_b16 v[120:121], v128 offset:24576
    ds_read_b64_tr_b16 v[122:123], v128 offset:25600
    s_waitcnt lgkmcnt(10)
    v_mfma_f32_32x32x16_bf16 v[48:63], v[100:103], a[0:3], 0
    ds_read_b64_tr_b16 v[124:125], v129 offset:24576
    ds_read_b64_tr_b16 v[126:127], v129 offset:25600
    s_waitcnt vmcnt(14) lgkmcnt(10)
    v_mfma_f32_32x32x16_bf16 v[32:47], v[104:107], a[4:7], v[32:47]
    ds_read_b64_tr_b16 v[96:97], v130 offset:40960
    ds_read_b64_tr_b16 v[98:99], v130 offset:41984
    s_waitcnt lgkmcnt(10)
    v_mfma_f32_32x32x16_bf16 v[48:63], v[108:111], a[4:7], v[48:63]
    s_mul_i32 s92, s23, 0x3800
    s_add_u32 s92, s92, s85
    s_add_u32 m0, s99, 0x18000
    s_add_u32 s92, s92, 0x7000
    buffer_load_dwordx4 v9, s[44:47], s92 offen lds
    ds_read_b64_tr_b16 v[100:101], v131 offset:40960
    ds_read_b64_tr_b16 v[102:103], v131 offset:41984
    s_waitcnt vmcnt(14) lgkmcnt(10)
    v_mfma_f32_32x32x16_bf16 v[32:47], v[112:115], a[8:11], v[32:47]
    ds_read_b64_tr_b16 v[104:105], v130 offset:49152
    ds_read_b64_tr_b16 v[106:107], v130 offset:50176
    s_waitcnt lgkmcnt(10)
    v_mfma_f32_32x32x16_bf16 v[48:63], v[116:119], a[8:11], v[48:63]
    ds_read_b64_tr_b16 v[108:109], v131 offset:49152
    ds_read_b64_tr_b16 v[110:111], v131 offset:50176
    s_waitcnt vmcnt(13) lgkmcnt(10)
    v_mfma_f32_32x32x16_bf16 v[32:47], v[120:123], a[12:15], v[32:47]
    s_waitcnt lgkmcnt(8)
    v_mfma_f32_32x32x16_bf16 v[48:63], v[124:127], a[12:15], v[48:63]
    s_mul_i32 s92, s23, 0x3800
    s_add_u32 s92, s92, s85
    s_add_u32 m0, s99, 0x26000
    s_add_u32 s92, s92, 0xa800
    buffer_load_dwordx4 v9, s[44:47], s92 offen lds
    s_waitcnt vmcnt(2)
    s_barrier
    ds_read_b64_tr_b16 v[112:113], v130 offset:57344
    ds_read_b64_tr_b16 v[114:115], v130 offset:58368
    ds_read_b64_tr_b16 v[116:117], v131 offset:57344
    ds_read_b64_tr_b16 v[118:119], v131 offset:58368
    s_waitcnt lgkmcnt(10)
    v_mfma_f32_32x32x16_bf16 v[32:47], v[96:99], a[16:19], v[32:47]
    ds_read_b64_tr_b16 v[120:121], v140
    ds_read_b64_tr_b16 v[122:123], v140 offset:1024
    s_waitcnt lgkmcnt(10)
    v_mfma_f32_32x32x16_bf16 v[48:63], v[100:103], a[16:19], v[48:63]
    s_lshl_b32 s92, s19, 10
    s_add_u32 s92, s92, s10
    buffer_load_dwordx4 a[32:35], v2, s[60:63], s92 offen sc1
    ds_read_b64_tr_b16 v[124:125], v141
    ds_read_b64_tr_b16 v[126:127], v141 offset:1024
    s_waitcnt lgkmcnt(10)
    v_mfma_f32_32x32x16_bf16 v[32:47], v[104:107], a[20:23], v[32:47]
    s_lshl_b32 s92, s19, 10
    s_add_u32 s92, s92, s10
    buffer_load_dwordx4 a[36:39], v2, s[60:63], s92 offen offset:1024 sc1
    ds_read_b64_tr_b16 v[96:97], v140 offset:8192
    ds_read_b64_tr_b16 v[98:99], v140 offset:9216
    s_waitcnt lgkmcnt(10)
    v_mfma_f32_32x32x16_bf16 v[48:63], v[108:111], a[20:23], v[48:63]
    s_lshl_b32 s92, s19, 10
    s_add_u32 s92, s92, s10
    buffer_load_dwordx4 a[40:43], v2, s[60:63], s92 offen offset:2048 sc1
    ds_read_b64_tr_b16 v[100:101], v141 offset:8192
    ds_read_b64_tr_b16 v[102:103], v141 offset:9216
    s_waitcnt lgkmcnt(10)
    v_mfma_f32_32x32x16_bf16 v[32:47], v[112:115], a[24:27], v[32:47]
    s_lshl_b32 s92, s19, 10
    s_add_u32 s92, s92, s10
    buffer_load_dwordx4 a[44:47], v2, s[60:63], s92 offen offset:3072 sc1
    ds_read_b64_tr_b16 v[104:105], v140 offset:16384
    ds_read_b64_tr_b16 v[106:107], v140 offset:17408
    s_waitcnt lgkmcnt(10)
    v_mfma_f32_32x32x16_bf16 v[48:63], v[116:119], a[24:27], v[48:63]
    s_lshl_b32 s92, s22, 10
    s_add_u32 s92, s92, s10
    buffer_load_dwordx4 a[48:51], v2, s[60:63], s92 offen sc1
    s_lshl_b32 s92, s22, 10
    s_add_u32 s92, s92, s10
    buffer_load_dwordx4 a[52:55], v2, s[60:63], s92 offen offset:1024 sc1
    ds_read_b64_tr_b16 v[108:109], v141 offset:16384
    ds_read_b64_tr_b16 v[110:111], v141 offset:17408
    s_waitcnt lgkmcnt(10)
    v_mfma_f32_32x32x16_bf16 v[32:47], v[120:123], a[28:31], v[32:47]
    s_lshl_b32 s92, s22, 10
    s_add_u32 s92, s92, s10
    buffer_load_dwordx4 a[56:59], v2, s[60:63], s92 offen offset:2048 sc1
    s_waitcnt lgkmcnt(8)
    v_mfma_f32_32x32x16_bf16 v[48:63], v[124:127], a[28:31], v[48:63]
    s_lshl_b32 s92, s22, 10
    s_add_u32 s92, s92, s10
    buffer_load_dwordx4 a[60:63], v2, s[60:63], s92 offen offset:3072 sc1
    s_barrier
    ds_read_b64_tr_b16 v[112:113], v128 offset:49152
    ds_read_b64_tr_b16 v[114:115], v128 offset:50176
    ds_read_b64_tr_b16 v[116:117], v129 offset:49152
    ds_read_b64_tr_b16 v[118:119], v129 offset:50176
    s_waitcnt vmcnt(7) lgkmcnt(10)
    v_mfma_f32_32x32x16_bf16 v[32:47], v[96:99], a[32:35], v[32:47]
    s_add_u32 s14, s13, 0x100
    ds_read_b64_tr_b16 v[120:121], v128 offset:57344
    ds_read_b64_tr_b16 v[122:123], v128 offset:58368
    s_waitcnt lgkmcnt(10)
    v_mfma_f32_32x32x16_bf16 v[48:63], v[100:103], a[32:35], v[48:63]
    ds_read_b64_tr_b16 v[124:125], v129 offset:57344
    ds_read_b64_tr_b16 v[126:127], v129 offset:58368
    s_waitcnt vmcnt(6) lgkmcnt(10)
    v_mfma_f32_32x32x16_bf16 v[32:47], v[104:107], a[36:39], v[32:47]
    s_mul_i32 s92, s24, 0x3800
    s_add_u32 m0, s99, 0x8000
    s_add_u32 s92, s92, s85
    buffer_load_dwordx4 v9, s[44:47], s92 offen lds
    ds_read_b64_tr_b16 v[96:97], v130
    ds_read_b64_tr_b16 v[98:99], v130 offset:1024
    s_waitcnt lgkmcnt(10)
    v_mfma_f32_32x32x16_bf16 v[48:63], v[108:111], a[36:39], v[48:63]
    s_mul_i32 s92, s24, 0x3800
    s_add_u32 s92, s92, s85
    s_add_u32 m0, s99, 0xa000
    s_add_u32 s92, s92, 0x3800
    buffer_load_dwordx4 v9, s[44:47], s92 offen lds
    ds_read_b64_tr_b16 v[100:101], v131
    ds_read_b64_tr_b16 v[102:103], v131 offset:1024
    s_waitcnt vmcnt(7) lgkmcnt(10)
    v_mfma_f32_32x32x16_bf16 v[32:47], v[112:115], a[40:43], v[32:47]
    ds_read_b64_tr_b16 v[104:105], v130 offset:8192
    ds_read_b64_tr_b16 v[106:107], v130 offset:9216
    s_waitcnt lgkmcnt(10)
    v_mfma_f32_32x32x16_bf16 v[48:63], v[116:119], a[40:43], v[48:63]
    s_mul_i32 s92, s24, 0x3800
    s_add_u32 s92, s92, s85
    s_add_u32 m0, s99, 0x4000
    s_add_u32 s92, s92, 0x7000
    buffer_load_dwordx4 v9, s[44:47], s92 offen lds
    ds_read_b64_tr_b16 v[108:109], v131 offset:8192
    ds_read_b64_tr_b16 v[110:111], v131 offset:9216
    s_waitcnt vmcnt(7) lgkmcnt(10)
    v_mfma_f32_32x32x16_bf16 v[32:47], v[120:123], a[44:47], v[32:47]
    s_waitcnt lgkmcnt(8)
    v_mfma_f32_32x32x16_bf16 v[48:63], v[124:127], a[44:47], v[48:63]
    s_mul_i32 s92, s24, 0x3800
    s_add_u32 s92, s92, s85
    s_add_u32 m0, s99, 0x6000
    s_add_u32 s92, s92, 0xa800
    buffer_load_dwordx4 v9, s[44:47], s92 offen lds
    s_barrier
    ds_read_b64_tr_b16 v[112:113], v130 offset:16384
    ds_read_b64_tr_b16 v[114:115], v130 offset:17408
    ds_read_b64_tr_b16 v[116:117], v131 offset:16384
    ds_read_b64_tr_b16 v[118:119], v131 offset:17408
    s_waitcnt vmcnt(7) lgkmcnt(10)
    v_mfma_f32_32x32x16_bf16 v[32:47], v[96:99], a[48:51], v[32:47]
    s_lshl_b32 s92, s23, 10
    s_add_u32 s92, s92, s10
    buffer_load_dwordx4 a[64:67], v2, s[60:63], s92 offen sc1
    ds_read_b64_tr_b16 v[120:121], v130 offset:24576
    ds_read_b64_tr_b16 v[122:123], v130 offset:25600
    s_waitcnt lgkmcnt(10)
    v_mfma_f32_32x32x16_bf16 v[48:63], v[100:103], a[48:51], v[48:63]
    s_lshl_b32 s92, s23, 10
    s_add_u32 s92, s92, s10
    buffer_load_dwordx4 a[68:71], v2, s[60:63], s92 offen offset:1024 sc1
    s_lshl_b32 s92, s23, 10
    s_add_u32 s92, s92, s10
    buffer_load_dwordx4 a[72:75], v2, s[60:63], s92 offen offset:2048 sc1
    ds_read_b64_tr_b16 v[124:125], v131 offset:24576
    ds_read_b64_tr_b16 v[126:127], v131 offset:25600
    s_waitcnt vmcnt(9) lgkmcnt(10)
    v_mfma_f32_32x32x16_bf16 v[32:47], v[104:107], a[52:55], v[32:47]
    s_lshl_b32 s92, s23, 10
    s_add_u32 s92, s92, s10
    buffer_load_dwordx4 a[76:79], v2, s[60:63], s92 offen offset:3072 sc1
    s_lshl_b32 s92, s24, 10
    s_add_u32 s92, s92, s10
    buffer_load_dwordx4 a[80:83], v2, s[60:63], s92 offen sc1
    ds_read_b64_tr_b16 v[96:97], v128
    ds_read_b64_tr_b16 v[98:99], v128 offset:1024
    s_waitcnt lgkmcnt(10)
    v_mfma_f32_32x32x16_bf16 v[48:63], v[108:111], a[52:55], v[48:63]
    s_lshl_b32 s92, s24, 10
    s_add_u32 s92, s92, s10
    buffer_load_dwordx4 a[84:87], v2, s[60:63], s92 offen offset:1024 sc1
    ds_read_b64_tr_b16 v[100:101], v129
    ds_read_b64_tr_b16 v[102:103], v129 offset:1024
    s_waitcnt vmcnt(11) lgkmcnt(10)
    v_mfma_f32_32x32x16_bf16 v[32:47], v[112:115], a[56:59], v[32:47]
    s_lshl_b32 s92, s24, 10
    s_add_u32 s92, s92, s10
    buffer_load_dwordx4 a[88:91], v2, s[60:63], s92 offen offset:2048 sc1
    s_lshl_b32 s92, s24, 10
    s_add_u32 s92, s92, s10
    buffer_load_dwordx4 a[92:95], v2, s[60:63], s92 offen offset:3072 sc1
    ds_read_b64_tr_b16 v[104:105], v128 offset:8192
    ds_read_b64_tr_b16 v[106:107], v128 offset:9216
    s_waitcnt lgkmcnt(10)
    v_mfma_f32_32x32x16_bf16 v[48:63], v[116:119], a[56:59], v[48:63]
    s_mul_i32 s92, s25, 0x3800
    s_add_u32 m0, s99, 0x1a000
    s_add_u32 s92, s92, s85
    buffer_load_dwordx4 v9, s[44:47], s92 offen lds
    ds_read_b64_tr_b16 v[108:109], v129 offset:8192
    ds_read_b64_tr_b16 v[110:111], v129 offset:9216
    s_waitcnt vmcnt(13) lgkmcnt(10)
    v_mfma_f32_32x32x16_bf16 v[32:47], v[120:123], a[60:63], v[32:47]
    s_mul_i32 s92, s25, 0x3800
    s_add_u32 s92, s92, s85
    s_add_u32 m0, s99, 0x1c000
    s_add_u32 s92, s92, 0x3800
    buffer_load_dwordx4 v9, s[44:47], s92 offen lds
    s_mul_i32 s92, s25, 0x3800
    s_add_u32 s92, s92, s85
    s_add_u32 m0, s99, 0x1e000
    s_add_u32 s92, s92, 0x7000
    buffer_load_dwordx4 v9, s[44:47], s92 offen lds
    s_waitcnt lgkmcnt(8)
    v_mfma_f32_32x32x16_bf16 v[48:63], v[124:127], a[60:63], v[48:63]
    s_mul_i32 s92, s25, 0x3800
    s_add_u32 s92, s92, s85
    s_add_u32 m0, s99, 0x20000
    s_add_u32 s92, s92, 0xa800
    buffer_load_dwordx4 v9, s[44:47], s92 offen lds
    s_waitcnt vmcnt(14)
    s_barrier
    ds_read_b64_tr_b16 v[112:113], v130 offset:32768
    ds_read_b64_tr_b16 v[114:115], v130 offset:33792
    ds_read_b64_tr_b16 v[116:117], v131 offset:32768
    ds_read_b64_tr_b16 v[118:119], v131 offset:33792
    s_waitcnt vmcnt(11) lgkmcnt(10)
    v_mfma_f32_32x32x16_bf16 v[32:47], v[96:99], a[64:67], v[32:47]
    s_add_u32 s14, s13, 0x100
    ds_read_b64_tr_b16 v[120:121], v140 offset:24576
    ds_read_b64_tr_b16 v[122:123], v140 offset:25600
    s_waitcnt lgkmcnt(10)
    v_mfma_f32_32x32x16_bf16 v[48:63], v[100:103], a[64:67], v[48:63]
    ds_read_b64_tr_b16 v[124:125], v141 offset:24576
    ds_read_b64_tr_b16 v[126:127], v141 offset:25600
    s_waitcnt vmcnt(10) lgkmcnt(10)
    v_mfma_f32_32x32x16_bf16 v[32:47], v[104:107], a[68:71], v[32:47]
    s_mul_i32 s92, s26, 0x6200
    s_add_u32 m0, s99, 0x22000
    s_add_u32 s92, s92, s86
    buffer_load_dwordx4 v9, s[48:51], s92 offen lds
    ds_read_b64_tr_b16 v[96:97], v128 offset:32768
    ds_read_b64_tr_b16 v[98:99], v128 offset:33792
    s_waitcnt lgkmcnt(10)
    v_mfma_f32_32x32x16_bf16 v[48:63], v[108:111], a[68:71], v[48:63]
    s_mul_i32 s92, s26, 0x6200
    s_add_u32 s92, s92, s86
    s_add_u32 m0, s99, 0x24000
    s_add_u32 s92, s92, 0x3800
    buffer_load_dwordx4 v9, s[48:51], s92 offen lds
    ds_read_b64_tr_b16 v[100:101], v129 offset:32768
    ds_read_b64_tr_b16 v[102:103], v129 offset:33792
    s_waitcnt vmcnt(11) lgkmcnt(10)
    v_mfma_f32_32x32x16_bf16 v[32:47], v[112:115], a[72:75], v[32:47]
    ds_read_b64_tr_b16 v[104:105], v128 offset:40960
    ds_read_b64_tr_b16 v[106:107], v128 offset:41984
    s_waitcnt lgkmcnt(10)
    v_mfma_f32_32x32x16_bf16 v[48:63], v[116:119], a[72:75], v[48:63]
    s_mul_i32 s92, s26, 0x6200
    s_add_u32 s92, s92, s86
    s_add_u32 m0, s99, 0xc000
    s_add_u32 s92, s92, 0x6200
    buffer_load_dwordx4 v9, s[48:51], s92 offen lds
    ds_read_b64_tr_b16 v[108:109], v129 offset:40960
    ds_read_b64_tr_b16 v[110:111], v129 offset:41984
    s_waitcnt vmcnt(11) lgkmcnt(10)
    v_mfma_f32_32x32x16_bf16 v[32:47], v[120:123], a[76:79], v[32:47]
    s_waitcnt lgkmcnt(8)
    v_mfma_f32_32x32x16_bf16 v[48:63], v[124:127], a[76:79], v[48:63]
    s_mul_i32 s92, s26, 0x6200
    s_add_u32 s92, s92, s86
    s_add_u32 m0, s99, 0xe000
    s_add_u32 s92, s92, 0x9a00
    buffer_load_dwordx4 v9, s[48:51], s92 offen lds
    s_waitcnt vmcnt(6)
    s_barrier
    ds_read_b64_tr_b16 v[112:113], v128 offset:16384
    ds_read_b64_tr_b16 v[114:115], v128 offset:17408
    ds_read_b64_tr_b16 v[116:117], v129 offset:16384
    ds_read_b64_tr_b16 v[118:119], v129 offset:17408
    s_waitcnt lgkmcnt(10)
    v_mfma_f32_32x32x16_bf16 v[32:47], v[96:99], a[80:83], v[32:47]
    s_add_u32 s14, s13, 0x180
    s_lshl_b32 s92, s25, 10
    s_add_u32 s92, s92, s10
    buffer_load_dwordx4 a[96:99], v2, s[60:63], s92 offen sc1
    ds_read_b64_tr_b16 v[120:121], v128 offset:24576
    ds_read_b64_tr_b16 v[122:123], v128 offset:25600
    s_waitcnt lgkmcnt(10)
    v_mfma_f32_32x32x16_bf16 v[48:63], v[100:103], a[80:83], v[48:63]
    s_lshl_b32 s92, s25, 10
    s_add_u32 s92, s92, s10
    buffer_load_dwordx4 a[100:103], v2, s[60:63], s92 offen offset:1024 sc1
    s_lshl_b32 s92, s25, 10
    s_add_u32 s92, s92, s10
    buffer_load_dwordx4 a[104:107], v2, s[60:63], s92 offen offset:2048 sc1
    ds_read_b64_tr_b16 v[124:125], v129 offset:24576
    ds_read_b64_tr_b16 v[126:127], v129 offset:25600
    s_waitcnt lgkmcnt(10)
    v_mfma_f32_32x32x16_bf16 v[32:47], v[104:107], a[84:87], v[32:47]
    s_lshl_b32 s92, s25, 10
    s_add_u32 s92, s92, s10
    buffer_load_dwordx4 a[108:111], v2, s[60:63], s92 offen offset:3072 sc1
    ds_read_b64_tr_b16 v[96:97], v130 offset:40960
    ds_read_b64_tr_b16 v[98:99], v130 offset:41984
    s_waitcnt lgkmcnt(10)
    v_mfma_f32_32x32x16_bf16 v[48:63], v[108:111], a[84:87], v[48:63]
    s_mul_i32 s92, s27, 0x6200
    s_add_u32 m0, s99, 0x10000
    s_add_u32 s92, s92, s86
    buffer_load_dwordx4 v9, s[48:51], s92 offen lds
    ds_read_b64_tr_b16 v[100:101], v131 offset:40960
    ds_read_b64_tr_b16 v[102:103], v131 offset:41984
    s_waitcnt lgkmcnt(10)
    v_mfma_f32_32x32x16_bf16 v[32:47], v[112:115], a[88:91], v[32:47]
    s_mul_i32 s92, s27, 0x6200
    s_add_u32 s92, s92, s86
    s_add_u32 m0, s99, 0x12000
    s_add_u32 s92, s92, 0x3800
    buffer_load_dwordx4 v9, s[48:51], s92 offen lds
    ds_read_b64_tr_b16 v[104:105], v130 offset:49152
    ds_read_b64_tr_b16 v[106:107], v130 offset:50176
    s_waitcnt lgkmcnt(10)
    v_mfma_f32_32x32x16_bf16 v[48:63], v[116:119], a[88:91], v[48:63]
    s_mul_i32 s92, s27, 0x6200
    s_add_u32 s92, s92, s86
    s_add_u32 m0, s99, 0x14000
    s_add_u32 s92, s92, 0x6200
    buffer_load_dwordx4 v9, s[48:51], s92 offen lds
    s_mul_i32 s92, s27, 0x6200
    s_add_u32 s92, s92, s86
    s_add_u32 m0, s99, 0x16000
    s_add_u32 s92, s92, 0x9a00
    buffer_load_dwordx4 v9, s[48:51], s92 offen lds
    ds_read_b64_tr_b16 v[108:109], v131 offset:49152
    ds_read_b64_tr_b16 v[110:111], v131 offset:50176
    s_waitcnt lgkmcnt(10)
    v_mfma_f32_32x32x16_bf16 v[32:47], v[120:123], a[92:95], v[32:47]
    s_waitcnt lgkmcnt(8)
    v_mfma_f32_32x32x16_bf16 v[48:63], v[124:127], a[92:95], v[48:63]
    v_lshrrev_b32 v20, 3, v1
    v_and_b32 v21, 7, v1
    v_xor_b32 v21, v21, v20
    s_lshl_b32 s93, s97, 6
    s_lshl_b32 s94, s68, 3
    s_add_u32 s93, s93, s94
    v_add_u32 v20, s93, v20
    v_mul_u32_u24 v20, 0x380, v20
    v_lshl_add_u32 v20, v21, 4, v20
    s_lshl_b32 s92, s98, 7
    s_add_u32 m0, s87, 0
    s_nop 0
    buffer_load_dwordx4 v20, s[28:31], s92 offen lds
    s_waitcnt vmcnt(11)
    s_barrier
    ds_read_b64_tr_b16 v[112:113], v130 offset:57344
    ds_read_b64_tr_b16 v[114:115], v130 offset:58368
    ds_read_b64_tr_b16 v[116:117], v131 offset:57344
    ds_read_b64_tr_b16 v[118:119], v131 offset:58368
    s_waitcnt vmcnt(8) lgkmcnt(10)
    v_mfma_f32_32x32x16_bf16 v[32:47], v[96:99], a[96:99], v[32:47]
    v_and_b32 v20, 7, v1
    v_lshrrev_b32 v21, 5, v1
    v_xor_b32 v21, v21, v20
    v_lshlrev_b32 v21, 4, v21
    v_and_b32 v20, 31, v1
    v_lshl_add_u32 v21, v20, 8, v21
    s_mov_b32 s94, 0x1a000
    s_cmp_eq_u32 s69, 1
    s_cselect_b32 s94, 0x1c000, s94
    s_cmp_eq_u32 s69, 2
    s_cselect_b32 s94, 0x1e000, s94
    s_cmp_eq_u32 s69, 3
    s_cselect_b32 s94, 0x20000, s94
    v_add_u32 v14, s94, v21
    ds_read_b64_tr_b16 v[120:121], v140
    ds_read_b64_tr_b16 v[122:123], v140 offset:1024
    s_waitcnt lgkmcnt(10)
    v_mfma_f32_32x32x16_bf16 v[48:63], v[100:103], a[96:99], v[48:63]
    ds_read_b64_tr_b16 v[124:125], v141
    ds_read_b64_tr_b16 v[126:127], v141 offset:1024
    s_waitcnt vmcnt(7) lgkmcnt(10)
    v_mfma_f32_32x32x16_bf16 v[32:47], v[104:107], a[100:103], v[32:47]
    v_lshrrev_b32 v20, 3, v1
    v_and_b32 v21, 7, v1
    v_lshlrev_b32 v21, 1, v21
    v_xor_b32 v21, v21, v20
    v_lshlrev_b32 v21, 4, v21
    s_lshl_b32 s93, s69, 3
    v_add_u32 v20, s93, v20
    v_lshl_add_u32 v16, v20, 8, v21
    v_xor_b32 v17, 16, v16
    ds_read_b64_tr_b16 v[96:97], v140 offset:8192
    ds_read_b64_tr_b16 v[98:99], v140 offset:9216
    s_waitcnt lgkmcnt(10)
    v_mfma_f32_32x32x16_bf16 v[48:63], v[108:111], a[100:103], v[48:63]
    s_lshl_b32 s92, s26, 11
    s_add_u32 s92, s92, s11
    buffer_load_dwordx4 a[0:3], v2, s[60:63], s92 offen sc1
    s_lshl_b32 s92, s26, 11
    s_add_u32 s92, s92, s11
    buffer_load_dwordx4 a[4:7], v2, s[60:63], s92 offen offset:1024 sc1
    ds_read_b64_tr_b16 v[100:101], v141 offset:8192
    ds_read_b64_tr_b16 v[102:103], v141 offset:9216
    s_waitcnt vmcnt(8) lgkmcnt(10)
    v_mfma_f32_32x32x16_bf16 v[32:47], v[112:115], a[104:107], v[32:47]
    s_lshl_b32 s92, s26, 11
    s_add_u32 s92, s92, s11
    buffer_load_dwordx4 a[8:11], v2, s[60:63], s92 offen offset:2048 sc1
    ds_read_b64_tr_b16 v[104:105], v140 offset:16384
    ds_read_b64_tr_b16 v[106:107], v140 offset:17408
    s_waitcnt lgkmcnt(10)
    v_mfma_f32_32x32x16_bf16 v[48:63], v[116:119], a[104:107], v[48:63]
    s_lshl_b32 s92, s26, 11
    s_add_u32 s92, s92, s11
    buffer_load_dwordx4 a[12:15], v2, s[60:63], s92 offen offset:3072 sc1
    s_lshl_b32 s92, s27, 11
    s_add_u32 s92, s92, s11
    buffer_load_dwordx4 a[16:19], v2, s[60:63], s92 offen sc1
    ds_read_b64_tr_b16 v[108:109], v141 offset:16384
    ds_read_b64_tr_b16 v[110:111], v141 offset:17408
    s_waitcnt vmcnt(10) lgkmcnt(10)
    v_mfma_f32_32x32x16_bf16 v[32:47], v[120:123], a[108:111], v[32:47]
    s_lshl_b32 s92, s27, 11
    s_add_u32 s92, s92, s11
    buffer_load_dwordx4 a[20:23], v2, s[60:63], s92 offen offset:1024 sc1
    s_waitcnt lgkmcnt(8)
    v_mfma_f32_32x32x16_bf16 v[48:63], v[124:127], a[108:111], v[48:63]
    s_lshl_b32 s92, s27, 11
    s_add_u32 s92, s92, s11
    buffer_load_dwordx4 a[24:27], v2, s[60:63], s92 offen offset:2048 sc1
    s_lshl_b32 s92, s27, 11
    s_add_u32 s92, s92, s11
    buffer_load_dwordx4 a[28:31], v2, s[60:63], s92 offen offset:3072 sc1
    s_waitcnt vmcnt(11)
    s_waitcnt vmcnt(8)
    s_barrier
    ds_read_b64_tr_b16 v[112:113], v128 offset:49152
    ds_read_b64_tr_b16 v[114:115], v128 offset:50176
    ds_read_b64_tr_b16 v[116:117], v129 offset:49152
    ds_read_b64_tr_b16 v[118:119], v129 offset:50176
    s_waitcnt vmcnt(7) lgkmcnt(10)
    v_mfma_f32_32x32x16_bf16 v[64:79], v[96:99], a[0:3], 0
    ds_read_b64_tr_b16 v[120:121], v128 offset:57344
    ds_read_b64_tr_b16 v[122:123], v128 offset:58368
    s_waitcnt lgkmcnt(10)
    v_mfma_f32_32x32x16_bf16 v[80:95], v[100:103], a[0:3], 0
    ds_write_b128 v14, v[32:35]
    v_xor_b32 v22, 32, v14
    ds_write_b128 v22, v[36:39]
    ds_read_b64_tr_b16 v[124:125], v129 offset:57344
    ds_read_b64_tr_b16 v[126:127], v129 offset:58368
    s_waitcnt vmcnt(6) lgkmcnt(12)
    v_mfma_f32_32x32x16_bf16 v[64:79], v[104:107], a[4:7], v[64:79]
    v_xor_b32 v23, 64, v14
    ds_write_b128 v23, v[40:43]
    v_xor_b32 v22, 0x60, v14
    ds_write_b128 v22, v[44:47]
    ds_read_b64_tr_b16 v[96:97], v130
    ds_read_b64_tr_b16 v[98:99], v130 offset:1024
    s_waitcnt lgkmcnt(14)
    v_mfma_f32_32x32x16_bf16 v[80:95], v[108:111], a[4:7], v[80:95]
    v_xor_b32 v23, 0x80, v14
    ds_write_b128 v23, v[48:51]
    ds_read_b64_tr_b16 v[100:101], v131
    ds_read_b64_tr_b16 v[102:103], v131 offset:1024
    s_waitcnt vmcnt(5) lgkmcnt(15)
    v_mfma_f32_32x32x16_bf16 v[64:79], v[112:115], a[8:11], v[64:79]
    v_xor_b32 v22, 0xa0, v14
    ds_write_b128 v22, v[52:55]
    v_xor_b32 v23, 0xc0, v14
    ds_write_b128 v23, v[56:59]
    ds_read_b64_tr_b16 v[104:105], v130 offset:8192
    ds_read_b64_tr_b16 v[106:107], v130 offset:9216
    s_waitcnt lgkmcnt(15)
    v_mfma_f32_32x32x16_bf16 v[80:95], v[116:119], a[8:11], v[80:95]
    v_xor_b32 v22, 0xe0, v14
    ds_write_b128 v22, v[60:63]
    ds_read_b64_tr_b16 v[108:109], v131 offset:8192
    ds_read_b64_tr_b16 v[110:111], v131 offset:9216
    s_waitcnt vmcnt(4) lgkmcnt(15)
    v_mfma_f32_32x32x16_bf16 v[64:79], v[120:123], a[12:15], v[64:79]
    v_lshrrev_b32 v20, 3, v1
    v_and_b32 v21, 7, v1
    v_xor_b32 v21, v21, v20
    v_lshlrev_b32 v21, 4, v21
    v_lshl_add_u32 v21, v20, 7, v21
    s_lshl_b32 s93, s69, 10
    s_add_u32 s93, s93, 0x1000
    v_add_u32 v21, s93, v21
    ds_read_b128 v[24:27], v21
    s_waitcnt lgkmcnt(15)
    v_mfma_f32_32x32x16_bf16 v[80:95], v[124:127], a[12:15], v[80:95]
    s_waitcnt lgkmcnt(0)
    s_barrier
    ds_read_b64_tr_b16 v[112:113], v130 offset:16384
    ds_read_b64_tr_b16 v[114:115], v130 offset:17408
    ds_read_b64_tr_b16 v[116:117], v131 offset:16384
    ds_read_b64_tr_b16 v[118:119], v131 offset:17408
    s_waitcnt vmcnt(3)
    v_mfma_f32_32x32x16_bf16 v[64:79], v[96:99], a[16:19], v[64:79]
    v_add_u32 v20, 0x1a000, v16
    ds_read_b128 v[32:35], v20
    v_add_u32 v21, 0x1a000, v17
    ds_read_b128 v[36:39], v21
    v_add_u32 v20, 0x1c000, v16
    ds_read_b128 v[40:43], v20
    v_add_u32 v21, 0x1c000, v17
    ds_read_b128 v[44:47], v21
    v_add_u32 v20, 0x1e000, v16
    ds_read_b128 v[48:51], v20
    v_add_u32 v21, 0x1e000, v17
    ds_read_b128 v[52:55], v21
    v_add_u32 v20, 0x20000, v16
    ds_read_b128 v[56:59], v20
    v_add_u32 v21, 0x20000, v17
    ds_read_b128 v[60:63], v21
    ds_read_b64_tr_b16 v[120:121], v130 offset:24576
    ds_read_b64_tr_b16 v[122:123], v130 offset:25600
    v_mfma_f32_32x32x16_bf16 v[80:95], v[100:103], a[16:19], v[80:95]
    s_waitcnt lgkmcnt(7)
    v_add_f32 v32, v32, v40
    v_add_f32 v33, v33, v41
    v_add_f32 v34, v34, v42
    v_add_f32 v35, v35, v43
    s_waitcnt lgkmcnt(6)
    v_add_f32 v36, v36, v44
    v_add_f32 v37, v37, v45
    v_add_f32 v38, v38, v46
    v_add_f32 v39, v39, v47
    s_waitcnt lgkmcnt(3)
    v_add_f32 v48, v48, v56
    v_add_f32 v49, v49, v57
    v_add_f32 v50, v50, v58
    v_add_f32 v51, v51, v59
    ds_read_b64_tr_b16 v[124:125], v131 offset:24576
    ds_read_b64_tr_b16 v[126:127], v131 offset:25600
    s_waitcnt vmcnt(2)
    v_mfma_f32_32x32x16_bf16 v[64:79], v[104:107], a[20:23], v[64:79]
    s_waitcnt lgkmcnt(4)
    v_add_f32 v52, v52, v60
    v_add_f32 v53, v53, v61
    v_add_f32 v54, v54, v62
    v_add_f32 v55, v55, v63
    v_add_f32 v32, v32, v48
    v_add_f32 v33, v33, v49
    v_add_f32 v34, v34, v50
    v_add_f32 v35, v35, v51
    v_add_f32 v36, v36, v52
    v_add_f32 v37, v37, v53
    v_add_f32 v38, v38, v54
    v_add_f32 v39, v39, v55
    v_mul_f32 v40, s82, v32
    v_mul_f32 v41, s82, v33
    v_mfma_f32_32x32x16_bf16 v[80:95], v[108:111], a[20:23], v[80:95]
    v_mul_f32 v42, s82, v34
    v_mul_f32 v43, s82, v35
    v_mul_f32 v44, s82, v36
    v_mul_f32 v45, s82, v37
    v_mul_f32 v46, s82, v38
    v_mul_f32 v47, s82, v39
    v_exp_f32 v40, v40
    v_exp_f32 v41, v41
    v_exp_f32 v42, v42
    v_exp_f32 v43, v43
    s_waitcnt vmcnt(1)
    v_mfma_f32_32x32x16_bf16 v[64:79], v[112:115], a[24:27], v[64:79]
    v_exp_f32 v44, v44
    v_exp_f32 v45, v45
    v_exp_f32 v46, v46
    v_exp_f32 v47, v47
    v_fma_f32 v40, v40, s83, s83
    v_fma_f32 v41, v41, s83, s83
    v_fma_f32 v42, v42, s83, s83
    v_fma_f32 v43, v43, s83, s83
    v_fma_f32 v44, v44, s83, s83
    v_fma_f32 v45, v45, s83, s83
    v_mfma_f32_32x32x16_bf16 v[80:95], v[116:119], a[24:27], v[80:95]
    v_fma_f32 v46, v46, s83, s83
    v_fma_f32 v47, v47, s83, s83
    v_rcp_f32 v40, v40
    v_rcp_f32 v41, v41
    v_rcp_f32 v42, v42
    v_rcp_f32 v43, v43
    v_rcp_f32 v44, v44
    v_rcp_f32 v45, v45
    s_waitcnt vmcnt(0) lgkmcnt(2)
    v_mfma_f32_32x32x16_bf16 v[64:79], v[120:123], a[28:31], v[64:79]
    v_rcp_f32 v46, v46
    v_rcp_f32 v47, v47
    v_mul_f32 v32, v32, v40
    v_mul_f32 v33, v33, v41
    v_mul_f32 v34, v34, v42
    v_mul_f32 v35, v35, v43
    v_mul_f32 v36, v36, v44
    v_mul_f32 v37, v37, v45
    v_mul_f32 v38, v38, v46
    v_mul_f32 v39, v39, v47
    v_lshlrev_b32 v48, 16, v24
    v_and_b32 v49, s81, v24
    v_lshlrev_b32 v50, 16, v25
    s_waitcnt lgkmcnt(0)
    v_mfma_f32_32x32x16_bf16 v[80:95], v[124:127], a[28:31], v[80:95]
    v_and_b32 v51, s81, v25
    v_lshlrev_b32 v52, 16, v26
    v_and_b32 v53, s81, v26
    v_lshlrev_b32 v54, 16, v27
    v_and_b32 v55, s81, v27
    v_and_b32 v20, 7, v1
    v_lshrrev_b32 v21, 5, v1
    v_xor_b32 v21, v21, v20
    v_lshlrev_b32 v21, 4, v21
    v_and_b32 v20, 31, v1
    v_lshl_add_u32 v21, v20, 8, v21
    s_mov_b32 s94, 0x22000
    s_cmp_eq_u32 s69, 1
    s_cselect_b32 s94, 0x24000, s94
    s_cmp_eq_u32 s69, 2
    s_cselect_b32 s94, 0xc000, s94
    s_cmp_eq_u32 s69, 3
    s_cselect_b32 s94, 0xe000, s94
    v_add_u32 v15, s94, v21
    ds_write_b128 v15, v[64:67]
    v_xor_b32 v22, 32, v15
    ds_write_b128 v22, v[68:71]
    v_xor_b32 v23, 64, v15
    ds_write_b128 v23, v[72:75]
    v_xor_b32 v22, 0x60, v15
    ds_write_b128 v22, v[76:79]
    v_xor_b32 v23, 0x80, v15
    ds_write_b128 v23, v[80:83]
    v_xor_b32 v22, 0xa0, v15
    ds_write_b128 v22, v[84:87]
    v_xor_b32 v23, 0xc0, v15
    ds_write_b128 v23, v[88:91]
    v_xor_b32 v22, 0xe0, v15
    ds_write_b128 v22, v[92:95]
    s_waitcnt lgkmcnt(0)
    s_barrier
    v_add_u32 v20, 0x22000, v16
    ds_read_b128 v[96:99], v20
    v_add_u32 v21, 0x22000, v17
    ds_read_b128 v[100:103], v21
    v_add_u32 v20, 0x24000, v16
    ds_read_b128 v[104:107], v20
    v_add_u32 v21, 0x24000, v17
    ds_read_b128 v[108:111], v21
    v_add_u32 v20, 0xc000, v16
    ds_read_b128 v[112:115], v20
    v_add_u32 v21, 0xc000, v17
    ds_read_b128 v[116:119], v21
    v_add_u32 v20, 0xe000, v16
    ds_read_b128 v[120:123], v20
    v_add_u32 v21, 0xe000, v17
    ds_read_b128 v[124:127], v21
    s_waitcnt lgkmcnt(5)
    v_add_f32 v96, v96, v104
    v_add_f32 v97, v97, v105
    v_add_f32 v98, v98, v106
    v_add_f32 v99, v99, v107
    s_waitcnt lgkmcnt(4)
    v_add_f32 v100, v100, v108
    v_add_f32 v101, v101, v109
    v_add_f32 v102, v102, v110
    v_add_f32 v103, v103, v111
    s_waitcnt lgkmcnt(1)
    v_add_f32 v112, v112, v120
    v_add_f32 v113, v113, v121
    v_add_f32 v114, v114, v122
    v_add_f32 v115, v115, v123
    s_waitcnt lgkmcnt(0)
    v_add_f32 v116, v116, v124
    v_add_f32 v117, v117, v125
    v_add_f32 v118, v118, v126
    v_add_f32 v119, v119, v127
    v_add_f32 v96, v96, v112
    v_add_f32 v97, v97, v113
    v_add_f32 v98, v98, v114
    v_add_f32 v99, v99, v115
    v_add_f32 v100, v100, v116
    v_add_f32 v101, v101, v117
    v_add_f32 v102, v102, v118
    v_add_f32 v103, v103, v119
    v_fma_f32 v96, v96, v32, v48
    v_fma_f32 v97, v97, v33, v49
    v_fma_f32 v98, v98, v34, v50
    v_fma_f32 v99, v99, v35, v51
    v_fma_f32 v100, v100, v36, v52
    v_fma_f32 v101, v101, v37, v53
    v_fma_f32 v102, v102, v38, v54
    v_fma_f32 v103, v103, v39, v55
    v_cvt_pk_bf16_f32 v64, v96, v97
    v_cvt_pk_bf16_f32 v65, v98, v99
    v_cvt_pk_bf16_f32 v66, v100, v101
    v_cvt_pk_bf16_f32 v67, v102, v103
    buffer_store_dwordx4 v[64:67], v8, s[56:59], 0 offen
L_fin_4001:
    s_endpgm
L_END:
    s_endpgm
L_CODE_END:
.section .rodata,"a"
.p2align 6
.amdhsa_kernel recurrent_scan__linear_kernel_hedgehog__glu_gated_swiglu__prompt_kernel
  .amdhsa_next_free_vgpr 256
  .amdhsa_next_free_sgpr 102
  .amdhsa_accum_offset 144
  .amdhsa_group_segment_fixed_size 0
  .amdhsa_kernarg_size 88
  .amdhsa_user_sgpr_count 2
  .amdhsa_user_sgpr_kernarg_segment_ptr 1
  .amdhsa_system_sgpr_workgroup_id_x 1
  .amdhsa_float_denorm_mode_32 3
  .amdhsa_float_denorm_mode_16_64 3
.end_amdhsa_kernel
```
